```python
import torch

def _softmax(x, axis=-1):
    return torch.softmax(x, dim=axis)
def _gelu(x):
    return torch.nn.functional.gelu(x, approximate="tanh")
def _silu(x):
    return torch.nn.functional.silu(x)
def _sigmoid(x):
    return torch.sigmoid(x)
def _layernorm(x, axis=-1, eps=1e-5):
    m = x.mean(dim=axis, keepdim=True)
    v = x.var(dim=axis, keepdim=True, unbiased=False)
    return (x - m) / torch.sqrt(v + eps)
def _scatter_add(tgt, idx, src, axis=0):
    return tgt.clone().index_add_(axis, idx, src)
def _segment_sum(src, seg, n):
    out = torch.zeros((n,) + src.shape[1:], dtype=src.dtype)
    return out.index_add_(0, seg, src)
def _pad(x, pw):
    flat = tuple(v for pair in reversed(pw) for v in pair)
    return torch.nn.functional.pad(x, flat)

kernel_name = 'recurrent_scan__gqa_block_cached__mixer_channel_mlp__prompt'

def setup_inputs():

    _w = (lambda a: (lambda t: t.to(torch.bfloat16) if t.is_floating_point() else t)(torch.as_tensor(a)))
    def _A_setup():
        B, Sq, D = 1, 2048, 640
        Hq, Hkv, Sk, Dh = 32, 32, 2048, 128
        assert Hq % Hkv == 0, (Hq, Hkv)
        return {
            "x": _w((lambda *s: torch.randn(*s, dtype=torch.bfloat16) * 0.05)(B, Sq, D)),
            "k_cache": _w((lambda *s: torch.randn(*s, dtype=torch.bfloat16) * 1.6)(B, Hkv, Sk, Dh)),
            "v_cache": _w((lambda *s: torch.randn(*s, dtype=torch.bfloat16) * 0.8)(B, Hkv, Sk, Dh)),
            "wq": _w((lambda *s: torch.randn(*s, dtype=torch.bfloat16) * 1.6)(D, Hq * Dh) * (D ** -0.5)),
            "wo": _w((lambda *s: torch.randn(*s, dtype=torch.bfloat16) * 0.8)(Hq * Dh, D) * ((Hq * Dh) ** -0.5)),
        }
    _A_in = _A_setup()

    def _B_setup():
        B, S, D, F = 1, 2048, 640, 1728
        return {
            "x": _w((lambda *s: torch.randn(*s, dtype=torch.bfloat16) * 0.05)(B, S, D)),
            "w1": _w((lambda *s: torch.randn(*s, dtype=torch.bfloat16) * 3.2)(D, F) * (D ** -0.5)),
            "b1": _w((lambda *s: torch.randn(*s, dtype=torch.bfloat16) * 1.6)(F)),
            "w2": _w((lambda *s: torch.randn(*s, dtype=torch.bfloat16) * 0.2)(F, D) * (F ** -0.5)),
            "b2": _w((lambda *s: torch.randn(*s, dtype=torch.bfloat16) * 0.2)(D)),
        }
    _B_in = _B_setup()

    return {
        "A_x": _A_in["x"],
        "A_k_cache": _A_in["k_cache"],
        "A_v_cache": _A_in["v_cache"],
        "A_wq": _A_in["wq"],
        "A_wo": _A_in["wo"],
        "B_x": _B_in["x"],
        "B_w1": _B_in["w1"],
        "B_b1": _B_in["b1"],
        "B_w2": _B_in["w2"],
        "B_b2": _B_in["b2"],
    }

def reference(A_x, A_k_cache, A_v_cache, A_wq, A_wo, B_x, B_w1, B_b1, B_w2, B_b2):
    def _A_ref(x, k_cache, v_cache, wq, wo):
        B, Sq, D = x.shape
        Hq, Dh = 32, 128
        Hkv = k_cache.shape[1]
        rep = Hq // Hkv
        q = (lambda x, *d: x.permute(*d))((x @ wq).reshape(B, Sq, Hq, Dh), 0, 2, 1, 3)
        k = (lambda x, n, axis: torch.repeat_interleave(x, n, dim=axis))(k_cache, rep, axis=1)
        v = (lambda x, n, axis: torch.repeat_interleave(x, n, dim=axis))(v_cache, rep, axis=1)
        scores = torch.einsum("bhqd,bhkd->bhqk", q, k) * (Dh ** -0.5)
        p = _softmax(scores, axis=-1)
        o = torch.einsum("bhqk,bhkd->bhqd", p, v)
        return (lambda x, *d: x.permute(*d))(o, 0, 2, 1, 3).reshape(B, Sq, Hq * Dh) @ wo

    def _B_ref(x, w1, b1, w2, b2):
        y = _layernorm(x, axis=-1)
        h = _gelu(torch.einsum("bsd,df->bsf", y, w1) + b1)
        return torch.einsum("bsf,fd->bsd", h, w2) + b2

    x = A_x
    xn = _layernorm(x, axis=-1)
    s = _A_ref(xn, A_k_cache, A_v_cache, A_wq, A_wo)
    g = _silu(_B_ref(xn, B_w1, B_b1, B_w2, B_b2))
    return x + s * g
```

```asm
; @launch kernel=attn_kernel grid=(256,1,1) block=(256,1,1) lds=163840
.amdgcn_target "amdgcn-amd-amdhsa--gfx950"
.text
.globl attn_kernel
.p2align 8
.type attn_kernel,@function
attn_kernel:
    s_cmp_ge_u32 s2, 256
    s_cbranch_scc1 attn_kernel_end
    s_load_dwordx4 s[84:87], s[0:1], 8
    s_load_dwordx2 s[88:89], s[0:1], 24
    s_load_dwordx4 s[92:95], s[0:1], 48
    s_load_dwordx2 s[90:91], s[0:1], 96
    s_load_dwordx2 s[96:97], s[0:1], 0
    s_and_b32 s40, s2, 7
    s_lshl_b32 s40, s40, 2
    s_lshr_b32 s52, s2, 3
    s_and_b32 s52, s52, 3
    s_add_u32 s40, s40, s52
    s_lshr_b32 s41, s2, 5
    v_lshrrev_b32 v48, 6, v0
    v_and_b32 v1, 63, v0
    v_readfirstlane_b32 s42, v48
    v_and_b32 v97, 15, v0
    v_lshrrev_b32 v98, 4, v0
    s_lshl_b32 s52, s2, 3
    v_add_u32 v98, s52, v98
    s_movk_i32 s53, 1280
    v_mul_lo_u32 v99, v98, s53
    v_lshl_add_u32 v99, v97, 4, v99
    s_mov_b32 s54, 0x18040
    s_waitcnt lgkmcnt(0)
    s_mov_b32 s24, s96
    s_and_b32 s25, s97, 0xffff
    s_mov_b32 s26, 0x280000
    s_mov_b32 s27, 0x20000
    s_add_u32 s28, s90, 0x290000
    s_addc_u32 s29, s91, 0
    s_and_b32 s29, s29, 0xffff
    s_mov_b32 s30, 0x20000
    s_mov_b32 s31, 0x20000
    buffer_load_dword v180, off, s[28:31], s54 sc1
    s_cmp_ge_u32 s42, 2
    s_cbranch_scc1 attn_kernel_lnl
    buffer_load_dwordx4 v[104:107], v99, s[24:27], 0 offen offset:0
    buffer_load_dwordx4 v[108:111], v99, s[24:27], 0 offen offset:256
    buffer_load_dwordx4 v[112:115], v99, s[24:27], 0 offen offset:512
    buffer_load_dwordx4 v[116:119], v99, s[24:27], 0 offen offset:768
    buffer_load_dwordx4 v[120:123], v99, s[24:27], 0 offen offset:1024
attn_kernel_lnl:
    v_lshlrev_b32 v32, 4, v1
    v_lshrrev_b32 v48, 4, v1
    v_and_b32 v49, 15, v1
    v_lshrrev_b32 v50, 2, v49
    v_and_b32 v51, 3, v1
    v_lshl_add_u32 v52, v50, 3, v51
    v_lshlrev_b32 v52, 8, v52
    v_xor_b32 v53, v48, v51
    v_lshl_add_u32 v52, v53, 4, v52
    v_xor_b32 v54, 0, v50
    v_lshl_add_u32 v2, v54, 6, v52
    v_xor_b32 v54, 1, v50
    v_lshl_add_u32 v3, v54, 6, v52
    v_xor_b32 v54, 2, v50
    v_lshl_add_u32 v4, v54, 6, v52
    v_xor_b32 v54, 3, v50
    v_lshl_add_u32 v5, v54, 6, v52
    v_lshl_add_u32 v52, v48, 3, v50
    v_and_b32 v53, 1, v48
    v_lshlrev_b32 v54, 8, v52
    v_lshl_add_u32 v54, v51, 3, v54
    v_add_u32 v54, 65536, v54
    v_lshl_or_b32 v55, v53, 2, v50
    v_xor_b32 v56, 0, v55
    v_lshl_add_u32 v6, v56, 5, v54
    v_xor_b32 v56, 1, v55
    v_lshl_add_u32 v7, v56, 5, v54
    v_xor_b32 v56, 2, v55
    v_lshl_add_u32 v8, v56, 5, v54
    v_xor_b32 v56, 3, v55
    v_lshl_add_u32 v9, v56, 5, v54
    v_xor_b32 v56, 4, v55
    v_lshl_add_u32 v10, v56, 5, v54
    v_xor_b32 v56, 5, v55
    v_lshl_add_u32 v11, v56, 5, v54
    v_xor_b32 v56, 6, v55
    v_lshl_add_u32 v12, v56, 5, v54
    v_xor_b32 v56, 7, v55
    v_lshl_add_u32 v13, v56, 5, v54
    v_lshlrev_b32 v54, 8, v52
    v_lshl_add_u32 v54, v51, 4, v54
    v_add_u32 v54, 65536, v54
    v_xor_b32 v56, 0, v50
    v_lshl_add_u32 v14, v56, 6, v54
    v_xor_b32 v56, 1, v50
    v_lshl_add_u32 v15, v56, 6, v54
    v_xor_b32 v56, 2, v50
    v_lshl_add_u32 v16, v56, 6, v54
    v_xor_b32 v56, 3, v50
    v_lshl_add_u32 v17, v56, 6, v54
    v_lshlrev_b32 v54, 7, v52
    v_lshl_add_u32 v54, v51, 3, v54
    v_add_u32 v54, 131072, v54
    v_lshrrev_b32 v55, 1, v50
    v_lshl_or_b32 v55, v53, 1, v55
    v_xor_b32 v56, 0, v55
    v_lshl_add_u32 v18, v56, 5, v54
    v_xor_b32 v56, 1, v55
    v_lshl_add_u32 v19, v56, 5, v54
    v_xor_b32 v56, 2, v55
    v_lshl_add_u32 v20, v56, 5, v54
    v_xor_b32 v56, 3, v55
    v_lshl_add_u32 v21, v56, 5, v54
    s_lshl_b32 s43, s42, 12
    v_lshlrev_b32 v55, 8, v48
    v_add_u32 v55, s43, v55
    s_lshl_b32 s52, s42, 1
    s_add_u32 s53, s52, 0
    s_and_b32 s53, s53, 3
    s_lshl_b32 s53, s53, 2
    v_or_b32 v56, s53, v48
    v_xor_b32 v56, v56, v49
    v_lshl_add_u32 v22, v56, 4, v55
    s_add_u32 s53, s52, 1
    s_and_b32 s53, s53, 3
    s_lshl_b32 s53, s53, 2
    v_or_b32 v56, s53, v48
    v_xor_b32 v56, v56, v49
    v_lshl_add_u32 v23, v56, 4, v55
    v_or_b32 v56, 0, v48
    v_lshlrev_b32 v56, 1, v56
    v_xor_b32 v56, v56, v49
    v_lshl_add_u32 v24, v56, 4, v55
    v_or_b32 v56, 4, v48
    v_lshlrev_b32 v56, 1, v56
    v_xor_b32 v56, v56, v49
    v_lshl_add_u32 v25, v56, 4, v55
    v_lshlrev_b32 v56, 2, v48
    v_xor_b32 v56, v56, v49
    s_lshl_b32 s52, s42, 4
    v_add_u32 v57, s52, v48
    v_lshlrev_b32 v57, 13, v57
    v_lshl_add_u32 v57, v56, 4, v57
    v_mov_b32 v26, v57
    v_add_u32 v27, 31744, v57
    v_add_u32 v28, 63488, v57
    v_add_u32 v29, 95232, v57
    v_lshrrev_b32 v57, 3, v1
    v_add_u32 v57, s52, v57
    s_movk_i32 s53, 3456
    v_mul_lo_u32 v57, v57, s53
    v_and_b32 v59, 7, v1
    v_or_b32 v58, 0, v53
    v_lshlrev_b32 v58, 1, v58
    v_xor_b32 v58, v58, v59
    v_lshl_add_u32 v58, v58, 4, v57
    v_add_u32 v30, 0, v58
    v_or_b32 v58, 2, v53
    v_lshlrev_b32 v58, 1, v58
    v_xor_b32 v58, v58, v59
    v_lshl_add_u32 v58, v58, 4, v57
    v_add_u32 v31, 26624, v58
    s_lshl_b32 s52, s41, 4
    s_lshl_b32 s53, s42, 2
    s_add_u32 s52, s52, s53
    s_mul_i32 s56, s52, 20480
    s_add_u32 s57, s56, 20480
    s_add_u32 s58, s56, 40960
    s_add_u32 s59, s56, 61440
    s_lshl_b32 s44, s40, 8
    s_min_u32 s54, s40, 26
    s_lshl_b32 s45, s54, 7
    s_mul_i32 s60, s52, 55296
    s_lshl_b32 s55, s54, 11
    s_add_u32 s60, s60, s55
    s_lshl_b32 s61, s52, 17
    s_lshl_b32 s55, s40, 12
    s_add_u32 s61, s61, s55
    s_lshl_b32 s50, s42, 11
    s_add_u32 s50, s50, 131072
    s_add_u32 s51, s43, 65536
    s_mov_b32 s46, 0
    s_mov_b32 s47, 0
    s_mov_b32 s49, 0
    s_lshl_b32 s55, s54, 7
    v_lshlrev_b32 v62, 3, v48
    v_add_u32 v62, s55, v62
    s_lshl_b32 s55, s52, 6
    v_lshlrev_b32 v63, 2, v49
    v_add_u32 v63, s55, v63
    s_lshl_b32 s55, s41, 2
    s_add_u32 s55, s55, s42
    s_mul_i32 s55, s55, 20
    v_lshrrev_b32 v59, 2, v1
    v_add_u32 v59, s55, v59
    v_lshlrev_b32 v59, 13, v59
    v_and_b32 v60, 3, v1
    v_lshl_add_u32 v59, v60, 6, v59
    v_lshrrev_b32 v60, 1, v1
    v_add_u32 v60, s55, v60
    s_movk_i32 s55, 3456
    v_mul_lo_u32 v60, v60, s55
    v_and_b32 v61, 1, v1
    v_lshl_add_u32 v60, v61, 6, v60
    v_add_u32 v61, 0x20000, v59
    s_waitcnt lgkmcnt(0)
    s_lshl_b32 s52, s40, 19
    s_mov_b32 s12, s88
    s_and_b32 s13, s89, 0xffff
    s_mov_b32 s14, 0x500000
    s_mov_b32 s15, 0x20000
    s_mov_b32 s16, s92
    s_and_b32 s17, s93, 0xffff
    s_mov_b32 s18, 0x21c000
    s_mov_b32 s19, 0x20000
    s_add_u32 s20, s90, 0x0
    s_addc_u32 s21, s91, 0
    s_and_b32 s21, s21, 0xffff
    s_mov_b32 s22, 0x280000
    s_mov_b32 s23, 0x20000
    s_add_u32 s4, s84, s52
    s_addc_u32 s5, s85, 0
    s_and_b32 s5, s5, 0xffff
    s_mov_b32 s6, 0x80000
    s_mov_b32 s7, 0x20000
    s_add_u32 s8, s86, s52
    s_addc_u32 s9, s87, 0
    s_and_b32 s9, s9, 0xffff
    s_mov_b32 s10, 0x80000
    s_mov_b32 s11, 0x20000
    s_mov_b32 s32, s94
    s_and_b32 s33, s95, 0xffff
    s_mov_b32 s34, 0xd80
    s_mov_b32 s35, 0x20000
    s_add_u32 s36, s90, 0x280000
    s_addc_u32 s37, s91, 0
    s_and_b32 s37, s37, 0xffff
    s_mov_b32 s38, 0x2000
    s_mov_b32 s39, 0x20000
    s_mov_b32 s54, s44
    s_mov_b32 s55, s45
    s_cmp_ge_u32 s42, 2
    s_cbranch_scc1 attn_kernel_lnw
    v_lshrrev_b32 v100, 4, v98
    s_movk_i32 s52, 20480
    v_mul_lo_u32 v100, v100, s52
    v_lshrrev_b32 v101, 2, v97
    v_lshl_add_u32 v100, v101, 10, v100
    v_and_b32 v101, 3, v97
    v_lshl_add_u32 v100, v101, 8, v100
    v_and_b32 v101, 15, v98
    v_lshl_add_u32 v100, v101, 4, v100
    v_lshlrev_b32 v101, 2, v98
    v_add_u32 v176, 4096, v100
    v_add_u32 v177, 8192, v100
    v_add_u32 v178, 12288, v100
    v_add_u32 v179, 16384, v100
    s_waitcnt vmcnt(4)
    v_lshlrev_b32 v128, 16, v104
    v_and_b32 v129, 0xffff0000, v104
    v_lshlrev_b32 v130, 16, v105
    v_and_b32 v131, 0xffff0000, v105
    v_lshlrev_b32 v132, 16, v106
    v_and_b32 v133, 0xffff0000, v106
    v_lshlrev_b32 v134, 16, v107
    v_and_b32 v135, 0xffff0000, v107
    s_waitcnt vmcnt(3)
    v_lshlrev_b32 v136, 16, v108
    v_and_b32 v137, 0xffff0000, v108
    v_lshlrev_b32 v138, 16, v109
    v_and_b32 v139, 0xffff0000, v109
    v_lshlrev_b32 v140, 16, v110
    v_and_b32 v141, 0xffff0000, v110
    v_lshlrev_b32 v142, 16, v111
    v_and_b32 v143, 0xffff0000, v111
    s_waitcnt vmcnt(2)
    v_lshlrev_b32 v144, 16, v112
    v_and_b32 v145, 0xffff0000, v112
    v_lshlrev_b32 v146, 16, v113
    v_and_b32 v147, 0xffff0000, v113
    v_lshlrev_b32 v148, 16, v114
    v_and_b32 v149, 0xffff0000, v114
    v_lshlrev_b32 v150, 16, v115
    v_and_b32 v151, 0xffff0000, v115
    s_waitcnt vmcnt(1)
    v_lshlrev_b32 v152, 16, v116
    v_and_b32 v153, 0xffff0000, v116
    v_lshlrev_b32 v154, 16, v117
    v_and_b32 v155, 0xffff0000, v117
    v_lshlrev_b32 v156, 16, v118
    v_and_b32 v157, 0xffff0000, v118
    v_lshlrev_b32 v158, 16, v119
    v_and_b32 v159, 0xffff0000, v119
    s_waitcnt vmcnt(0)
    v_lshlrev_b32 v160, 16, v120
    v_and_b32 v161, 0xffff0000, v120
    v_lshlrev_b32 v162, 16, v121
    v_and_b32 v163, 0xffff0000, v121
    v_lshlrev_b32 v164, 16, v122
    v_and_b32 v165, 0xffff0000, v122
    v_lshlrev_b32 v166, 16, v123
    v_and_b32 v167, 0xffff0000, v123
    v_pk_add_f32 v[168:169], v[128:129], v[130:131]
    v_pk_add_f32 v[170:171], v[132:133], v[134:135]
    v_pk_add_f32 v[168:169], v[168:169], v[136:137]
    v_pk_add_f32 v[170:171], v[170:171], v[138:139]
    v_pk_add_f32 v[168:169], v[168:169], v[140:141]
    v_pk_add_f32 v[170:171], v[170:171], v[142:143]
    v_pk_add_f32 v[168:169], v[168:169], v[144:145]
    v_pk_add_f32 v[170:171], v[170:171], v[146:147]
    v_pk_add_f32 v[168:169], v[168:169], v[148:149]
    v_pk_add_f32 v[170:171], v[170:171], v[150:151]
    v_pk_add_f32 v[168:169], v[168:169], v[152:153]
    v_pk_add_f32 v[170:171], v[170:171], v[154:155]
    v_pk_add_f32 v[168:169], v[168:169], v[156:157]
    v_pk_add_f32 v[170:171], v[170:171], v[158:159]
    v_pk_add_f32 v[168:169], v[168:169], v[160:161]
    v_pk_add_f32 v[170:171], v[170:171], v[162:163]
    v_pk_add_f32 v[168:169], v[168:169], v[164:165]
    v_pk_add_f32 v[170:171], v[170:171], v[166:167]
    v_pk_add_f32 v[168:169], v[168:169], v[170:171]
    v_add_f32 v168, v168, v169
    s_nop 1
    v_add_f32_dpp v168, v168, v168 row_ror:8 row_mask:0xf bank_mask:0xf
    s_nop 1
    v_add_f32_dpp v168, v168, v168 row_ror:4 row_mask:0xf bank_mask:0xf
    s_nop 1
    v_add_f32_dpp v168, v168, v168 row_ror:2 row_mask:0xf bank_mask:0xf
    s_nop 1
    v_add_f32_dpp v168, v168, v168 row_ror:1 row_mask:0xf bank_mask:0xf
    v_mul_f32 v168, 0xbacccccd, v168
    v_pk_add_f32 v[128:129], v[128:129], v[168:169] op_sel_hi:[1,0]
    v_pk_add_f32 v[130:131], v[130:131], v[168:169] op_sel_hi:[1,0]
    v_pk_add_f32 v[132:133], v[132:133], v[168:169] op_sel_hi:[1,0]
    v_pk_add_f32 v[134:135], v[134:135], v[168:169] op_sel_hi:[1,0]
    v_pk_add_f32 v[136:137], v[136:137], v[168:169] op_sel_hi:[1,0]
    v_pk_add_f32 v[138:139], v[138:139], v[168:169] op_sel_hi:[1,0]
    v_pk_add_f32 v[140:141], v[140:141], v[168:169] op_sel_hi:[1,0]
    v_pk_add_f32 v[142:143], v[142:143], v[168:169] op_sel_hi:[1,0]
    v_pk_add_f32 v[144:145], v[144:145], v[168:169] op_sel_hi:[1,0]
    v_pk_add_f32 v[146:147], v[146:147], v[168:169] op_sel_hi:[1,0]
    v_pk_add_f32 v[148:149], v[148:149], v[168:169] op_sel_hi:[1,0]
    v_pk_add_f32 v[150:151], v[150:151], v[168:169] op_sel_hi:[1,0]
    v_pk_add_f32 v[152:153], v[152:153], v[168:169] op_sel_hi:[1,0]
    v_pk_add_f32 v[154:155], v[154:155], v[168:169] op_sel_hi:[1,0]
    v_pk_add_f32 v[156:157], v[156:157], v[168:169] op_sel_hi:[1,0]
    v_pk_add_f32 v[158:159], v[158:159], v[168:169] op_sel_hi:[1,0]
    v_pk_add_f32 v[160:161], v[160:161], v[168:169] op_sel_hi:[1,0]
    v_pk_add_f32 v[162:163], v[162:163], v[168:169] op_sel_hi:[1,0]
    v_pk_add_f32 v[164:165], v[164:165], v[168:169] op_sel_hi:[1,0]
    v_pk_add_f32 v[166:167], v[166:167], v[168:169] op_sel_hi:[1,0]
    v_pk_mul_f32 v[172:173], v[128:129], v[128:129]
    v_pk_mul_f32 v[174:175], v[130:131], v[130:131]
    v_pk_fma_f32 v[172:173], v[132:133], v[132:133], v[172:173]
    v_pk_fma_f32 v[174:175], v[134:135], v[134:135], v[174:175]
    v_pk_fma_f32 v[172:173], v[136:137], v[136:137], v[172:173]
    v_pk_fma_f32 v[174:175], v[138:139], v[138:139], v[174:175]
    v_pk_fma_f32 v[172:173], v[140:141], v[140:141], v[172:173]
    v_pk_fma_f32 v[174:175], v[142:143], v[142:143], v[174:175]
    v_pk_fma_f32 v[172:173], v[144:145], v[144:145], v[172:173]
    v_pk_fma_f32 v[174:175], v[146:147], v[146:147], v[174:175]
    v_pk_fma_f32 v[172:173], v[148:149], v[148:149], v[172:173]
    v_pk_fma_f32 v[174:175], v[150:151], v[150:151], v[174:175]
    v_pk_fma_f32 v[172:173], v[152:153], v[152:153], v[172:173]
    v_pk_fma_f32 v[174:175], v[154:155], v[154:155], v[174:175]
    v_pk_fma_f32 v[172:173], v[156:157], v[156:157], v[172:173]
    v_pk_fma_f32 v[174:175], v[158:159], v[158:159], v[174:175]
    v_pk_fma_f32 v[172:173], v[160:161], v[160:161], v[172:173]
    v_pk_fma_f32 v[174:175], v[162:163], v[162:163], v[174:175]
    v_pk_fma_f32 v[172:173], v[164:165], v[164:165], v[172:173]
    v_pk_fma_f32 v[174:175], v[166:167], v[166:167], v[174:175]
    v_pk_add_f32 v[172:173], v[172:173], v[174:175]
    v_add_f32 v172, v172, v173
    s_nop 1
    v_add_f32_dpp v172, v172, v172 row_ror:8 row_mask:0xf bank_mask:0xf
    s_nop 1
    v_add_f32_dpp v172, v172, v172 row_ror:4 row_mask:0xf bank_mask:0xf
    s_nop 1
    v_add_f32_dpp v172, v172, v172 row_ror:2 row_mask:0xf bank_mask:0xf
    s_nop 1
    v_add_f32_dpp v172, v172, v172 row_ror:1 row_mask:0xf bank_mask:0xf
    v_mul_f32 v172, 0x3acccccd, v172
    v_add_f32 v173, 0x3727c5ac, v172
    v_rsq_f32 v173, v173
    s_nop 0
    v_mul_f32 v174, v173, v173
    v_mov_b32 v175, 0x3727c5ac
    v_fmac_f32 v175, v174, v172
    v_rsq_f32 v175, v175
    v_mul_f32 v170, 0x3e0293ee, v173
    v_mul_f32 v175, 0x40faf233, v175
    buffer_store_dword v175, v101, s[36:39], 0 offen sc1
    v_pk_mul_f32 v[128:129], v[128:129], v[170:171] op_sel_hi:[1,0]
    v_pk_mul_f32 v[130:131], v[130:131], v[170:171] op_sel_hi:[1,0]
    v_pk_mul_f32 v[132:133], v[132:133], v[170:171] op_sel_hi:[1,0]
    v_pk_mul_f32 v[134:135], v[134:135], v[170:171] op_sel_hi:[1,0]
    v_cvt_pk_bf16_f32 v104, v128, v129
    v_cvt_pk_bf16_f32 v105, v130, v131
    v_cvt_pk_bf16_f32 v106, v132, v133
    v_cvt_pk_bf16_f32 v107, v134, v135
    buffer_store_dwordx4 v[104:107], v100, s[20:23], 0 offen sc1
    v_pk_mul_f32 v[136:137], v[136:137], v[170:171] op_sel_hi:[1,0]
    v_pk_mul_f32 v[138:139], v[138:139], v[170:171] op_sel_hi:[1,0]
    v_pk_mul_f32 v[140:141], v[140:141], v[170:171] op_sel_hi:[1,0]
    v_pk_mul_f32 v[142:143], v[142:143], v[170:171] op_sel_hi:[1,0]
    v_cvt_pk_bf16_f32 v108, v136, v137
    v_cvt_pk_bf16_f32 v109, v138, v139
    v_cvt_pk_bf16_f32 v110, v140, v141
    v_cvt_pk_bf16_f32 v111, v142, v143
    buffer_store_dwordx4 v[108:111], v176, s[20:23], 0 offen sc1
    v_pk_mul_f32 v[144:145], v[144:145], v[170:171] op_sel_hi:[1,0]
    v_pk_mul_f32 v[146:147], v[146:147], v[170:171] op_sel_hi:[1,0]
    v_pk_mul_f32 v[148:149], v[148:149], v[170:171] op_sel_hi:[1,0]
    v_pk_mul_f32 v[150:151], v[150:151], v[170:171] op_sel_hi:[1,0]
    v_cvt_pk_bf16_f32 v112, v144, v145
    v_cvt_pk_bf16_f32 v113, v146, v147
    v_cvt_pk_bf16_f32 v114, v148, v149
    v_cvt_pk_bf16_f32 v115, v150, v151
    buffer_store_dwordx4 v[112:115], v177, s[20:23], 0 offen sc1
    v_pk_mul_f32 v[152:153], v[152:153], v[170:171] op_sel_hi:[1,0]
    v_pk_mul_f32 v[154:155], v[154:155], v[170:171] op_sel_hi:[1,0]
    v_pk_mul_f32 v[156:157], v[156:157], v[170:171] op_sel_hi:[1,0]
    v_pk_mul_f32 v[158:159], v[158:159], v[170:171] op_sel_hi:[1,0]
    v_cvt_pk_bf16_f32 v116, v152, v153
    v_cvt_pk_bf16_f32 v117, v154, v155
    v_cvt_pk_bf16_f32 v118, v156, v157
    v_cvt_pk_bf16_f32 v119, v158, v159
    buffer_store_dwordx4 v[116:119], v178, s[20:23], 0 offen sc1
    v_pk_mul_f32 v[160:161], v[160:161], v[170:171] op_sel_hi:[1,0]
    v_pk_mul_f32 v[162:163], v[162:163], v[170:171] op_sel_hi:[1,0]
    v_pk_mul_f32 v[164:165], v[164:165], v[170:171] op_sel_hi:[1,0]
    v_pk_mul_f32 v[166:167], v[166:167], v[170:171] op_sel_hi:[1,0]
    v_cvt_pk_bf16_f32 v120, v160, v161
    v_cvt_pk_bf16_f32 v121, v162, v163
    v_cvt_pk_bf16_f32 v122, v164, v165
    v_cvt_pk_bf16_f32 v123, v166, v167
    buffer_store_dwordx4 v[120:123], v179, s[20:23], 0 offen sc1
    s_branch attn_kernel_lns
attn_kernel_lnw:
    s_add_u32 m0, s51, 0
    s_nop 0
    buffer_load_dwordx4 v26, s[12:15], s44 offen offset:0 lds
    buffer_load_dwordx4 v27, s[12:15], s44 offen offset:1024 lds
    buffer_load_dwordx4 v28, s[12:15], s44 offen offset:2048 lds
    buffer_load_dwordx4 v29, s[12:15], s44 offen offset:3072 lds
    s_add_u32 s44, s44, 524288
    s_add_u32 m0, s50, 0
    s_nop 0
    buffer_load_dwordx4 v30, s[16:19], s45 offen offset:0 lds
    buffer_load_dwordx4 v31, s[16:19], s45 offen offset:1024 lds
    s_add_u32 s45, s45, 221184
    s_add_u32 m0, s51, 16384
    s_nop 0
    buffer_load_dwordx4 v26, s[12:15], s44 offen offset:0 lds
    buffer_load_dwordx4 v27, s[12:15], s44 offen offset:1024 lds
    buffer_load_dwordx4 v28, s[12:15], s44 offen offset:2048 lds
    buffer_load_dwordx4 v29, s[12:15], s44 offen offset:3072 lds
    s_add_u32 s44, s44, 524288
    s_add_u32 m0, s50, 8192
    s_nop 0
    buffer_load_dwordx4 v30, s[16:19], s45 offen offset:0 lds
    buffer_load_dwordx4 v31, s[16:19], s45 offen offset:1024 lds
    s_add_u32 s45, s45, 221184
    s_add_u32 m0, s51, 32768
    s_nop 0
    buffer_load_dwordx4 v26, s[12:15], s44 offen offset:0 lds
    buffer_load_dwordx4 v27, s[12:15], s44 offen offset:1024 lds
    buffer_load_dwordx4 v28, s[12:15], s44 offen offset:2048 lds
    buffer_load_dwordx4 v29, s[12:15], s44 offen offset:3072 lds
    s_add_u32 s44, s44, 524288
    s_add_u32 m0, s50, 16384
    s_nop 0
    buffer_load_dwordx4 v30, s[16:19], s45 offen offset:0 lds
    buffer_load_dwordx4 v31, s[16:19], s45 offen offset:1024 lds
    s_add_u32 s45, s45, 221184
attn_kernel_lns:
    v_and_b32 v181, 31, v1
    s_lshl_b32 s52, s41, 5
    v_add_u32 v181, s52, v181
    v_lshlrev_b32 v181, 7, v181
    v_add_u32 v181, 0x10000, v181
    s_lshl_b32 s53, s2, 7
    s_add_u32 s53, s53, 0x10000
    s_waitcnt vmcnt(0)
    v_readfirstlane_b32 s3, v180
    s_add_u32 s3, s3, 0x9e3779b1
    s_barrier
    s_cmp_ge_u32 s42, 2
    s_cbranch_scc1 attn_kernel_lnq
    s_add_u32 m0, s51, 0
    s_nop 0
    buffer_load_dwordx4 v26, s[12:15], s44 offen offset:0 lds
    buffer_load_dwordx4 v27, s[12:15], s44 offen offset:1024 lds
    buffer_load_dwordx4 v28, s[12:15], s44 offen offset:2048 lds
    buffer_load_dwordx4 v29, s[12:15], s44 offen offset:3072 lds
    s_add_u32 s44, s44, 524288
    s_add_u32 m0, s50, 0
    s_nop 0
    buffer_load_dwordx4 v30, s[16:19], s45 offen offset:0 lds
    buffer_load_dwordx4 v31, s[16:19], s45 offen offset:1024 lds
    s_add_u32 s45, s45, 221184
    s_add_u32 m0, s51, 16384
    s_nop 0
    buffer_load_dwordx4 v26, s[12:15], s44 offen offset:0 lds
    buffer_load_dwordx4 v27, s[12:15], s44 offen offset:1024 lds
    buffer_load_dwordx4 v28, s[12:15], s44 offen offset:2048 lds
    buffer_load_dwordx4 v29, s[12:15], s44 offen offset:3072 lds
    s_add_u32 s44, s44, 524288
    s_add_u32 m0, s50, 8192
    s_nop 0
    buffer_load_dwordx4 v30, s[16:19], s45 offen offset:0 lds
    buffer_load_dwordx4 v31, s[16:19], s45 offen offset:1024 lds
    s_add_u32 s45, s45, 221184
    s_add_u32 m0, s51, 32768
    s_nop 0
    buffer_load_dwordx4 v26, s[12:15], s44 offen offset:0 lds
    buffer_load_dwordx4 v27, s[12:15], s44 offen offset:1024 lds
    buffer_load_dwordx4 v28, s[12:15], s44 offen offset:2048 lds
    buffer_load_dwordx4 v29, s[12:15], s44 offen offset:3072 lds
    s_add_u32 s44, s44, 524288
    s_add_u32 m0, s50, 16384
    s_nop 0
    buffer_load_dwordx4 v30, s[16:19], s45 offen offset:0 lds
    buffer_load_dwordx4 v31, s[16:19], s45 offen offset:1024 lds
    s_add_u32 s45, s45, 221184
    s_branch attn_kernel_lnr
attn_kernel_lnq:
    s_cmp_lg_u32 s42, 3
    s_cbranch_scc1 attn_kernel_lnr
    v_mov_b32 v182, s3
    s_mov_b64 exec, 1
    buffer_store_dword v182, off, s[28:31], s53 sc1
    s_mov_b64 exec, -1
    s_mov_b32 s48, 0x4000
attn_kernel_lnp:
    buffer_load_dword v183, v181, s[28:31], 0 offen sc1
    s_sub_u32 s48, s48, 1
    s_waitcnt vmcnt(0)
    v_cmp_ne_u32 vcc, s3, v183
    s_nop 1
    s_cmp_eq_u64 vcc, 0
    s_cbranch_scc1 attn_kernel_lnr
    s_cmp_lg_u32 s48, 0
    s_cbranch_scc1 attn_kernel_lnp
attn_kernel_lnr:
    s_barrier
    s_add_u32 s24, s90, 0x300000
    s_addc_u32 s25, s91, 0
    s_and_b32 s25, s25, 0xffff
    s_mov_b32 s26, 0x6c0000
    s_mov_b32 s27, 0x20000
    s_add_u32 s28, s90, 0xa00000
    s_addc_u32 s29, s91, 0
    s_and_b32 s29, s29, 0xffff
    s_mov_b32 s30, 0x1000000
    s_mov_b32 s31, 0x20000
    buffer_load_dwordx4 a[0:3], v32, s[20:23], s56 offen offset:0 sc1
    buffer_load_dwordx4 a[4:7], v32, s[20:23], s57 offen offset:0 sc1
    buffer_load_dwordx4 a[8:11], v32, s[20:23], s58 offen offset:0 sc1
    buffer_load_dwordx4 a[12:15], v32, s[20:23], s59 offen offset:0 sc1
    buffer_load_dwordx4 a[16:19], v32, s[20:23], s56 offen offset:1024 sc1
    buffer_load_dwordx4 a[20:23], v32, s[20:23], s57 offen offset:1024 sc1
    buffer_load_dwordx4 a[24:27], v32, s[20:23], s58 offen offset:1024 sc1
    buffer_load_dwordx4 a[28:31], v32, s[20:23], s59 offen offset:1024 sc1
    buffer_load_dwordx4 a[32:35], v32, s[20:23], s56 offen offset:2048 sc1
    buffer_load_dwordx4 a[36:39], v32, s[20:23], s57 offen offset:2048 sc1
    buffer_load_dwordx4 a[40:43], v32, s[20:23], s58 offen offset:2048 sc1
    buffer_load_dwordx4 a[44:47], v32, s[20:23], s59 offen offset:2048 sc1
    buffer_load_dwordx4 a[48:51], v32, s[20:23], s56 offen offset:3072 sc1
    buffer_load_dwordx4 a[52:55], v32, s[20:23], s57 offen offset:3072 sc1
    buffer_load_dwordx4 a[56:59], v32, s[20:23], s58 offen offset:3072 sc1
    buffer_load_dwordx4 a[60:63], v32, s[20:23], s59 offen offset:3072 sc1
    s_add_u32 s56, s56, 4096
    s_add_u32 s57, s57, 4096
    s_add_u32 s58, s58, 4096
    s_add_u32 s59, s59, 4096
    s_waitcnt vmcnt(8)
    s_barrier
    ds_read_b64_tr_b16 a[96:97], v14 offset:0
    ds_read_b64_tr_b16 a[98:99], v14 offset:1024
    ds_read_b64_tr_b16 a[100:101], v14 offset:8
    ds_read_b64_tr_b16 a[102:103], v14 offset:1032
    ds_read_b64_tr_b16 a[104:105], v15 offset:0
    ds_read_b64_tr_b16 a[106:107], v15 offset:1024
    ds_read_b64_tr_b16 a[108:109], v15 offset:8
    ds_read_b64_tr_b16 a[110:111], v15 offset:1032
    ds_read_b64_tr_b16 a[112:113], v16 offset:0
    ds_read_b64_tr_b16 a[114:115], v16 offset:1024
    ds_read_b64_tr_b16 a[116:117], v16 offset:8
    ds_read_b64_tr_b16 a[118:119], v16 offset:1032
    ds_read_b64_tr_b16 a[120:121], v17 offset:0
    ds_read_b64_tr_b16 a[122:123], v17 offset:1024
    ds_read_b64_tr_b16 a[124:125], v17 offset:8
    ds_read_b64_tr_b16 a[126:127], v17 offset:1032
    ds_read_b64_tr_b16 a[128:129], v18 offset:0
    ds_read_b64_tr_b16 a[130:131], v18 offset:512
    ds_read_b64_tr_b16 a[132:133], v19 offset:0
    ds_read_b64_tr_b16 a[134:135], v19 offset:512
    ds_read_b64_tr_b16 a[136:137], v20 offset:0
    ds_read_b64_tr_b16 a[138:139], v20 offset:512
    ds_read_b64_tr_b16 a[140:141], v21 offset:0
    ds_read_b64_tr_b16 a[142:143], v21 offset:512
    s_waitcnt lgkmcnt(0)
    v_mfma_f32_16x16x32_bf16 v[64:67], a[96:99], a[0:3], 0
    v_mfma_f32_16x16x32_bf16 v[96:99], a[96:99], a[4:7], 0
    ds_read_b64_tr_b16 a[144:145], v14 offset:8192
    v_mfma_f32_16x16x32_bf16 v[128:131], a[96:99], a[8:11], 0
    ds_read_b64_tr_b16 a[146:147], v14 offset:9216
    v_mfma_f32_16x16x32_bf16 v[160:163], a[96:99], a[12:15], 0
    ds_read_b64_tr_b16 a[148:149], v14 offset:8200
    v_mfma_f32_16x16x32_bf16 v[68:71], a[100:103], a[0:3], 0
    ds_read_b64_tr_b16 a[150:151], v14 offset:9224
    v_mfma_f32_16x16x32_bf16 v[100:103], a[100:103], a[4:7], 0
    ds_read_b64_tr_b16 a[152:153], v15 offset:8192
    v_mfma_f32_16x16x32_bf16 v[132:135], a[100:103], a[8:11], 0
    ds_read_b64_tr_b16 a[154:155], v15 offset:9216
    v_mfma_f32_16x16x32_bf16 v[164:167], a[100:103], a[12:15], 0
    ds_read_b64_tr_b16 a[156:157], v15 offset:8200
    v_mfma_f32_16x16x32_bf16 v[72:75], a[104:107], a[0:3], 0
    ds_read_b64_tr_b16 a[158:159], v15 offset:9224
    buffer_load_dwordx4 a[64:67], v32, s[20:23], s56 offen offset:0 sc1
    v_mfma_f32_16x16x32_bf16 v[104:107], a[104:107], a[4:7], 0
    ds_read_b64_tr_b16 a[160:161], v16 offset:8192
    v_mfma_f32_16x16x32_bf16 v[136:139], a[104:107], a[8:11], 0
    ds_read_b64_tr_b16 a[162:163], v16 offset:9216
    v_mfma_f32_16x16x32_bf16 v[168:171], a[104:107], a[12:15], 0
    ds_read_b64_tr_b16 a[164:165], v16 offset:8200
    v_mfma_f32_16x16x32_bf16 v[76:79], a[108:111], a[0:3], 0
    ds_read_b64_tr_b16 a[166:167], v16 offset:9224
    v_mfma_f32_16x16x32_bf16 v[108:111], a[108:111], a[4:7], 0
    ds_read_b64_tr_b16 a[168:169], v17 offset:8192
    buffer_load_dwordx4 a[68:71], v32, s[20:23], s57 offen offset:0 sc1
    v_mfma_f32_16x16x32_bf16 v[140:143], a[108:111], a[8:11], 0
    ds_read_b64_tr_b16 a[170:171], v17 offset:9216
    v_mfma_f32_16x16x32_bf16 v[172:175], a[108:111], a[12:15], 0
    ds_read_b64_tr_b16 a[172:173], v17 offset:8200
    v_mfma_f32_16x16x32_bf16 v[80:83], a[112:115], a[0:3], 0
    ds_read_b64_tr_b16 a[174:175], v17 offset:9224
    v_mfma_f32_16x16x32_bf16 v[112:115], a[112:115], a[4:7], 0
    ds_read_b64_tr_b16 a[176:177], v18 offset:4096
    v_mfma_f32_16x16x32_bf16 v[144:147], a[112:115], a[8:11], 0
    ds_read_b64_tr_b16 a[178:179], v18 offset:4608
    buffer_load_dwordx4 a[72:75], v32, s[20:23], s58 offen offset:0 sc1
    v_mfma_f32_16x16x32_bf16 v[176:179], a[112:115], a[12:15], 0
    ds_read_b64_tr_b16 a[180:181], v19 offset:4096
    v_mfma_f32_16x16x32_bf16 v[84:87], a[116:119], a[0:3], 0
    ds_read_b64_tr_b16 a[182:183], v19 offset:4608
    v_mfma_f32_16x16x32_bf16 v[116:119], a[116:119], a[4:7], 0
    ds_read_b64_tr_b16 a[184:185], v20 offset:4096
    v_mfma_f32_16x16x32_bf16 v[148:151], a[116:119], a[8:11], 0
    ds_read_b64_tr_b16 a[186:187], v20 offset:4608
    v_mfma_f32_16x16x32_bf16 v[180:183], a[116:119], a[12:15], 0
    ds_read_b64_tr_b16 a[188:189], v21 offset:4096
    buffer_load_dwordx4 a[76:79], v32, s[20:23], s59 offen offset:0 sc1
    v_mfma_f32_16x16x32_bf16 v[88:91], a[120:123], a[0:3], 0
    ds_read_b64_tr_b16 a[190:191], v21 offset:4608
    v_mfma_f32_16x16x32_bf16 v[120:123], a[120:123], a[4:7], 0
    v_mfma_f32_16x16x32_bf16 v[152:155], a[120:123], a[8:11], 0
    v_mfma_f32_16x16x32_bf16 v[184:187], a[120:123], a[12:15], 0
    v_mfma_f32_16x16x32_bf16 v[92:95], a[124:127], a[0:3], 0
    buffer_load_dwordx4 a[80:83], v32, s[20:23], s56 offen offset:1024 sc1
    v_mfma_f32_16x16x32_bf16 v[124:127], a[124:127], a[4:7], 0
    v_mfma_f32_16x16x32_bf16 v[156:159], a[124:127], a[8:11], 0
    v_mfma_f32_16x16x32_bf16 v[188:191], a[124:127], a[12:15], 0
    v_mfma_f32_16x16x32_bf16 v[192:195], a[128:131], a[0:3], 0
    v_mfma_f32_16x16x32_bf16 v[208:211], a[128:131], a[4:7], 0
    buffer_load_dwordx4 a[84:87], v32, s[20:23], s57 offen offset:1024 sc1
    v_mfma_f32_16x16x32_bf16 v[224:227], a[128:131], a[8:11], 0
    v_mfma_f32_16x16x32_bf16 v[240:243], a[128:131], a[12:15], 0
    v_mfma_f32_16x16x32_bf16 v[196:199], a[132:135], a[0:3], 0
    v_mfma_f32_16x16x32_bf16 v[212:215], a[132:135], a[4:7], 0
    v_mfma_f32_16x16x32_bf16 v[228:231], a[132:135], a[8:11], 0
    buffer_load_dwordx4 a[88:91], v32, s[20:23], s58 offen offset:1024 sc1
    v_mfma_f32_16x16x32_bf16 v[244:247], a[132:135], a[12:15], 0
    v_mfma_f32_16x16x32_bf16 v[200:203], a[136:139], a[0:3], 0
    v_mfma_f32_16x16x32_bf16 v[216:219], a[136:139], a[4:7], 0
    v_mfma_f32_16x16x32_bf16 v[232:235], a[136:139], a[8:11], 0
    v_mfma_f32_16x16x32_bf16 v[248:251], a[136:139], a[12:15], 0
    buffer_load_dwordx4 a[92:95], v32, s[20:23], s59 offen offset:1024 sc1
    v_mfma_f32_16x16x32_bf16 v[204:207], a[140:143], a[0:3], 0
    v_mfma_f32_16x16x32_bf16 v[220:223], a[140:143], a[4:7], 0
    v_mfma_f32_16x16x32_bf16 v[236:239], a[140:143], a[8:11], 0
    v_mfma_f32_16x16x32_bf16 v[252:255], a[140:143], a[12:15], 0
    s_waitcnt lgkmcnt(0)
    v_mfma_f32_16x16x32_bf16 v[64:67], a[144:147], a[16:19], v[64:67]
    s_barrier
    v_mfma_f32_16x16x32_bf16 v[96:99], a[144:147], a[20:23], v[96:99]
    ds_read_b64_tr_b16 a[96:97], v14 offset:16384
    v_mfma_f32_16x16x32_bf16 v[128:131], a[144:147], a[24:27], v[128:131]
    ds_read_b64_tr_b16 a[98:99], v14 offset:17408
    v_mfma_f32_16x16x32_bf16 v[160:163], a[144:147], a[28:31], v[160:163]
    ds_read_b64_tr_b16 a[100:101], v14 offset:16392
    v_mfma_f32_16x16x32_bf16 v[68:71], a[148:151], a[16:19], v[68:71]
    ds_read_b64_tr_b16 a[102:103], v14 offset:17416
    v_mfma_f32_16x16x32_bf16 v[100:103], a[148:151], a[20:23], v[100:103]
    ds_read_b64_tr_b16 a[104:105], v15 offset:16384
    v_mfma_f32_16x16x32_bf16 v[132:135], a[148:151], a[24:27], v[132:135]
    ds_read_b64_tr_b16 a[106:107], v15 offset:17408
    v_mfma_f32_16x16x32_bf16 v[164:167], a[148:151], a[28:31], v[164:167]
    ds_read_b64_tr_b16 a[108:109], v15 offset:16392
    v_mfma_f32_16x16x32_bf16 v[72:75], a[152:155], a[16:19], v[72:75]
    ds_read_b64_tr_b16 a[110:111], v15 offset:17416
    s_add_u32 m0, s51, 49152
    s_nop 0
    v_mfma_f32_16x16x32_bf16 v[104:107], a[152:155], a[20:23], v[104:107]
    ds_read_b64_tr_b16 a[112:113], v16 offset:16384
    v_mfma_f32_16x16x32_bf16 v[136:139], a[152:155], a[24:27], v[136:139]
    ds_read_b64_tr_b16 a[114:115], v16 offset:17408
    v_mfma_f32_16x16x32_bf16 v[168:171], a[152:155], a[28:31], v[168:171]
    ds_read_b64_tr_b16 a[116:117], v16 offset:16392
    v_mfma_f32_16x16x32_bf16 v[76:79], a[156:159], a[16:19], v[76:79]
    ds_read_b64_tr_b16 a[118:119], v16 offset:17416
    buffer_load_dwordx4 v26, s[12:15], s44 offen offset:0 lds
    v_mfma_f32_16x16x32_bf16 v[108:111], a[156:159], a[20:23], v[108:111]
    ds_read_b64_tr_b16 a[120:121], v17 offset:16384
    v_mfma_f32_16x16x32_bf16 v[140:143], a[156:159], a[24:27], v[140:143]
    ds_read_b64_tr_b16 a[122:123], v17 offset:17408
    v_mfma_f32_16x16x32_bf16 v[172:175], a[156:159], a[28:31], v[172:175]
    ds_read_b64_tr_b16 a[124:125], v17 offset:16392
    v_mfma_f32_16x16x32_bf16 v[80:83], a[160:163], a[16:19], v[80:83]
    ds_read_b64_tr_b16 a[126:127], v17 offset:17416
    buffer_load_dwordx4 v27, s[12:15], s44 offen offset:1024 lds
    v_mfma_f32_16x16x32_bf16 v[112:115], a[160:163], a[20:23], v[112:115]
    ds_read_b64_tr_b16 a[128:129], v18 offset:8192
    v_mfma_f32_16x16x32_bf16 v[144:147], a[160:163], a[24:27], v[144:147]
    ds_read_b64_tr_b16 a[130:131], v18 offset:8704
    v_mfma_f32_16x16x32_bf16 v[176:179], a[160:163], a[28:31], v[176:179]
    ds_read_b64_tr_b16 a[132:133], v19 offset:8192
    v_mfma_f32_16x16x32_bf16 v[84:87], a[164:167], a[16:19], v[84:87]
    ds_read_b64_tr_b16 a[134:135], v19 offset:8704
    buffer_load_dwordx4 v28, s[12:15], s44 offen offset:2048 lds
    v_mfma_f32_16x16x32_bf16 v[116:119], a[164:167], a[20:23], v[116:119]
    ds_read_b64_tr_b16 a[136:137], v20 offset:8192
    v_mfma_f32_16x16x32_bf16 v[148:151], a[164:167], a[24:27], v[148:151]
    ds_read_b64_tr_b16 a[138:139], v20 offset:8704
    v_mfma_f32_16x16x32_bf16 v[180:183], a[164:167], a[28:31], v[180:183]
    ds_read_b64_tr_b16 a[140:141], v21 offset:8192
    v_mfma_f32_16x16x32_bf16 v[88:91], a[168:171], a[16:19], v[88:91]
    ds_read_b64_tr_b16 a[142:143], v21 offset:8704
    buffer_load_dwordx4 v29, s[12:15], s44 offen offset:3072 lds
    v_mfma_f32_16x16x32_bf16 v[120:123], a[168:171], a[20:23], v[120:123]
    v_mfma_f32_16x16x32_bf16 v[152:155], a[168:171], a[24:27], v[152:155]
    v_mfma_f32_16x16x32_bf16 v[184:187], a[168:171], a[28:31], v[184:187]
    v_mfma_f32_16x16x32_bf16 v[92:95], a[172:175], a[16:19], v[92:95]
    s_add_u32 s44, s44, 524288
    v_mfma_f32_16x16x32_bf16 v[124:127], a[172:175], a[20:23], v[124:127]
    v_mfma_f32_16x16x32_bf16 v[156:159], a[172:175], a[24:27], v[156:159]
    v_mfma_f32_16x16x32_bf16 v[188:191], a[172:175], a[28:31], v[188:191]
    v_mfma_f32_16x16x32_bf16 v[192:195], a[176:179], a[16:19], v[192:195]
    s_add_u32 m0, s50, 24576
    s_nop 0
    v_mfma_f32_16x16x32_bf16 v[208:211], a[176:179], a[20:23], v[208:211]
    v_mfma_f32_16x16x32_bf16 v[224:227], a[176:179], a[24:27], v[224:227]
    v_mfma_f32_16x16x32_bf16 v[240:243], a[176:179], a[28:31], v[240:243]
    v_mfma_f32_16x16x32_bf16 v[196:199], a[180:183], a[16:19], v[196:199]
    buffer_load_dwordx4 v30, s[16:19], s45 offen offset:0 lds
    v_mfma_f32_16x16x32_bf16 v[212:215], a[180:183], a[20:23], v[212:215]
    v_mfma_f32_16x16x32_bf16 v[228:231], a[180:183], a[24:27], v[228:231]
    v_mfma_f32_16x16x32_bf16 v[244:247], a[180:183], a[28:31], v[244:247]
    v_mfma_f32_16x16x32_bf16 v[200:203], a[184:187], a[16:19], v[200:203]
    buffer_load_dwordx4 v31, s[16:19], s45 offen offset:1024 lds
    v_mfma_f32_16x16x32_bf16 v[216:219], a[184:187], a[20:23], v[216:219]
    v_mfma_f32_16x16x32_bf16 v[232:235], a[184:187], a[24:27], v[232:235]
    v_mfma_f32_16x16x32_bf16 v[248:251], a[184:187], a[28:31], v[248:251]
    v_mfma_f32_16x16x32_bf16 v[204:207], a[188:191], a[16:19], v[204:207]
    s_add_u32 s45, s45, 221184
    v_mfma_f32_16x16x32_bf16 v[220:223], a[188:191], a[20:23], v[220:223]
    v_mfma_f32_16x16x32_bf16 v[236:239], a[188:191], a[24:27], v[236:239]
    v_mfma_f32_16x16x32_bf16 v[252:255], a[188:191], a[28:31], v[252:255]
    s_waitcnt vmcnt(14)
    s_waitcnt lgkmcnt(0)
    v_mfma_f32_16x16x32_bf16 v[64:67], a[96:99], a[32:35], v[64:67]
    v_mfma_f32_16x16x32_bf16 v[96:99], a[96:99], a[36:39], v[96:99]
    ds_read_b64_tr_b16 a[144:145], v14 offset:24576
    v_mfma_f32_16x16x32_bf16 v[128:131], a[96:99], a[40:43], v[128:131]
    ds_read_b64_tr_b16 a[146:147], v14 offset:25600
    v_mfma_f32_16x16x32_bf16 v[160:163], a[96:99], a[44:47], v[160:163]
    ds_read_b64_tr_b16 a[148:149], v14 offset:24584
    v_mfma_f32_16x16x32_bf16 v[68:71], a[100:103], a[32:35], v[68:71]
    ds_read_b64_tr_b16 a[150:151], v14 offset:25608
    v_mfma_f32_16x16x32_bf16 v[100:103], a[100:103], a[36:39], v[100:103]
    ds_read_b64_tr_b16 a[152:153], v15 offset:24576
    v_mfma_f32_16x16x32_bf16 v[132:135], a[100:103], a[40:43], v[132:135]
    ds_read_b64_tr_b16 a[154:155], v15 offset:25600
    v_mfma_f32_16x16x32_bf16 v[164:167], a[100:103], a[44:47], v[164:167]
    ds_read_b64_tr_b16 a[156:157], v15 offset:24584
    v_mfma_f32_16x16x32_bf16 v[72:75], a[104:107], a[32:35], v[72:75]
    ds_read_b64_tr_b16 a[158:159], v15 offset:25608
    buffer_load_dwordx4 a[0:3], v32, s[20:23], s56 offen offset:2048 sc1
    v_mfma_f32_16x16x32_bf16 v[104:107], a[104:107], a[36:39], v[104:107]
    ds_read_b64_tr_b16 a[160:161], v16 offset:24576
    v_mfma_f32_16x16x32_bf16 v[136:139], a[104:107], a[40:43], v[136:139]
    ds_read_b64_tr_b16 a[162:163], v16 offset:25600
    v_mfma_f32_16x16x32_bf16 v[168:171], a[104:107], a[44:47], v[168:171]
    ds_read_b64_tr_b16 a[164:165], v16 offset:24584
    v_mfma_f32_16x16x32_bf16 v[76:79], a[108:111], a[32:35], v[76:79]
    ds_read_b64_tr_b16 a[166:167], v16 offset:25608
    buffer_load_dwordx4 a[4:7], v32, s[20:23], s57 offen offset:2048 sc1
    v_mfma_f32_16x16x32_bf16 v[108:111], a[108:111], a[36:39], v[108:111]
    ds_read_b64_tr_b16 a[168:169], v17 offset:24576
    v_mfma_f32_16x16x32_bf16 v[140:143], a[108:111], a[40:43], v[140:143]
    ds_read_b64_tr_b16 a[170:171], v17 offset:25600
    v_mfma_f32_16x16x32_bf16 v[172:175], a[108:111], a[44:47], v[172:175]
    ds_read_b64_tr_b16 a[172:173], v17 offset:24584
    v_mfma_f32_16x16x32_bf16 v[80:83], a[112:115], a[32:35], v[80:83]
    ds_read_b64_tr_b16 a[174:175], v17 offset:25608
    buffer_load_dwordx4 a[8:11], v32, s[20:23], s58 offen offset:2048 sc1
    v_mfma_f32_16x16x32_bf16 v[112:115], a[112:115], a[36:39], v[112:115]
    ds_read_b64_tr_b16 a[176:177], v18 offset:12288
    v_mfma_f32_16x16x32_bf16 v[144:147], a[112:115], a[40:43], v[144:147]
    ds_read_b64_tr_b16 a[178:179], v18 offset:12800
    v_mfma_f32_16x16x32_bf16 v[176:179], a[112:115], a[44:47], v[176:179]
    ds_read_b64_tr_b16 a[180:181], v19 offset:12288
    v_mfma_f32_16x16x32_bf16 v[84:87], a[116:119], a[32:35], v[84:87]
    ds_read_b64_tr_b16 a[182:183], v19 offset:12800
    v_mfma_f32_16x16x32_bf16 v[116:119], a[116:119], a[36:39], v[116:119]
    ds_read_b64_tr_b16 a[184:185], v20 offset:12288
    buffer_load_dwordx4 a[12:15], v32, s[20:23], s59 offen offset:2048 sc1
    v_mfma_f32_16x16x32_bf16 v[148:151], a[116:119], a[40:43], v[148:151]
    ds_read_b64_tr_b16 a[186:187], v20 offset:12800
    v_mfma_f32_16x16x32_bf16 v[180:183], a[116:119], a[44:47], v[180:183]
    ds_read_b64_tr_b16 a[188:189], v21 offset:12288
    v_mfma_f32_16x16x32_bf16 v[88:91], a[120:123], a[32:35], v[88:91]
    ds_read_b64_tr_b16 a[190:191], v21 offset:12800
    v_mfma_f32_16x16x32_bf16 v[120:123], a[120:123], a[36:39], v[120:123]
    buffer_load_dwordx4 a[16:19], v32, s[20:23], s56 offen offset:3072 sc1
    v_mfma_f32_16x16x32_bf16 v[152:155], a[120:123], a[40:43], v[152:155]
    v_mfma_f32_16x16x32_bf16 v[184:187], a[120:123], a[44:47], v[184:187]
    v_mfma_f32_16x16x32_bf16 v[92:95], a[124:127], a[32:35], v[92:95]
    v_mfma_f32_16x16x32_bf16 v[124:127], a[124:127], a[36:39], v[124:127]
    v_mfma_f32_16x16x32_bf16 v[156:159], a[124:127], a[40:43], v[156:159]
    buffer_load_dwordx4 a[20:23], v32, s[20:23], s57 offen offset:3072 sc1
    v_mfma_f32_16x16x32_bf16 v[188:191], a[124:127], a[44:47], v[188:191]
    v_mfma_f32_16x16x32_bf16 v[192:195], a[128:131], a[32:35], v[192:195]
    v_mfma_f32_16x16x32_bf16 v[208:211], a[128:131], a[36:39], v[208:211]
    v_mfma_f32_16x16x32_bf16 v[224:227], a[128:131], a[40:43], v[224:227]
    buffer_load_dwordx4 a[24:27], v32, s[20:23], s58 offen offset:3072 sc1
    v_mfma_f32_16x16x32_bf16 v[240:243], a[128:131], a[44:47], v[240:243]
    v_mfma_f32_16x16x32_bf16 v[196:199], a[132:135], a[32:35], v[196:199]
    v_mfma_f32_16x16x32_bf16 v[212:215], a[132:135], a[36:39], v[212:215]
    v_mfma_f32_16x16x32_bf16 v[228:231], a[132:135], a[40:43], v[228:231]
    v_mfma_f32_16x16x32_bf16 v[244:247], a[132:135], a[44:47], v[244:247]
    buffer_load_dwordx4 a[28:31], v32, s[20:23], s59 offen offset:3072 sc1
    v_mfma_f32_16x16x32_bf16 v[200:203], a[136:139], a[32:35], v[200:203]
    v_mfma_f32_16x16x32_bf16 v[216:219], a[136:139], a[36:39], v[216:219]
    v_mfma_f32_16x16x32_bf16 v[232:235], a[136:139], a[40:43], v[232:235]
    v_mfma_f32_16x16x32_bf16 v[248:251], a[136:139], a[44:47], v[248:251]
    s_add_u32 s56, s56, 4096
    s_add_u32 s57, s57, 4096
    s_add_u32 s58, s58, 4096
    s_add_u32 s59, s59, 4096
    v_mfma_f32_16x16x32_bf16 v[204:207], a[140:143], a[32:35], v[204:207]
    v_mfma_f32_16x16x32_bf16 v[220:223], a[140:143], a[36:39], v[220:223]
    v_mfma_f32_16x16x32_bf16 v[236:239], a[140:143], a[40:43], v[236:239]
    v_mfma_f32_16x16x32_bf16 v[252:255], a[140:143], a[44:47], v[252:255]
    s_waitcnt lgkmcnt(0)
    v_mfma_f32_16x16x32_bf16 v[64:67], a[144:147], a[48:51], v[64:67]
    s_barrier
    v_mfma_f32_16x16x32_bf16 v[96:99], a[144:147], a[52:55], v[96:99]
    ds_read_b64_tr_b16 a[96:97], v14 offset:32768
    v_mfma_f32_16x16x32_bf16 v[128:131], a[144:147], a[56:59], v[128:131]
    ds_read_b64_tr_b16 a[98:99], v14 offset:33792
    v_mfma_f32_16x16x32_bf16 v[160:163], a[144:147], a[60:63], v[160:163]
    ds_read_b64_tr_b16 a[100:101], v14 offset:32776
    v_mfma_f32_16x16x32_bf16 v[68:71], a[148:151], a[48:51], v[68:71]
    ds_read_b64_tr_b16 a[102:103], v14 offset:33800
    v_mfma_f32_16x16x32_bf16 v[100:103], a[148:151], a[52:55], v[100:103]
    ds_read_b64_tr_b16 a[104:105], v15 offset:32768
    v_mfma_f32_16x16x32_bf16 v[132:135], a[148:151], a[56:59], v[132:135]
    ds_read_b64_tr_b16 a[106:107], v15 offset:33792
    v_mfma_f32_16x16x32_bf16 v[164:167], a[148:151], a[60:63], v[164:167]
    ds_read_b64_tr_b16 a[108:109], v15 offset:32776
    v_mfma_f32_16x16x32_bf16 v[72:75], a[152:155], a[48:51], v[72:75]
    ds_read_b64_tr_b16 a[110:111], v15 offset:33800
    s_add_u32 m0, s51, 0
    s_nop 0
    v_mfma_f32_16x16x32_bf16 v[104:107], a[152:155], a[52:55], v[104:107]
    ds_read_b64_tr_b16 a[112:113], v16 offset:32768
    v_mfma_f32_16x16x32_bf16 v[136:139], a[152:155], a[56:59], v[136:139]
    ds_read_b64_tr_b16 a[114:115], v16 offset:33792
    v_mfma_f32_16x16x32_bf16 v[168:171], a[152:155], a[60:63], v[168:171]
    ds_read_b64_tr_b16 a[116:117], v16 offset:32776
    v_mfma_f32_16x16x32_bf16 v[76:79], a[156:159], a[48:51], v[76:79]
    ds_read_b64_tr_b16 a[118:119], v16 offset:33800
    buffer_load_dwordx4 v26, s[12:15], s44 offen offset:0 lds
    v_mfma_f32_16x16x32_bf16 v[108:111], a[156:159], a[52:55], v[108:111]
    ds_read_b64_tr_b16 a[120:121], v17 offset:32768
    v_mfma_f32_16x16x32_bf16 v[140:143], a[156:159], a[56:59], v[140:143]
    ds_read_b64_tr_b16 a[122:123], v17 offset:33792
    v_mfma_f32_16x16x32_bf16 v[172:175], a[156:159], a[60:63], v[172:175]
    ds_read_b64_tr_b16 a[124:125], v17 offset:32776
    v_mfma_f32_16x16x32_bf16 v[80:83], a[160:163], a[48:51], v[80:83]
    ds_read_b64_tr_b16 a[126:127], v17 offset:33800
    buffer_load_dwordx4 v27, s[12:15], s44 offen offset:1024 lds
    v_mfma_f32_16x16x32_bf16 v[112:115], a[160:163], a[52:55], v[112:115]
    ds_read_b64_tr_b16 a[128:129], v18 offset:16384
    v_mfma_f32_16x16x32_bf16 v[144:147], a[160:163], a[56:59], v[144:147]
    ds_read_b64_tr_b16 a[130:131], v18 offset:16896
    v_mfma_f32_16x16x32_bf16 v[176:179], a[160:163], a[60:63], v[176:179]
    ds_read_b64_tr_b16 a[132:133], v19 offset:16384
    v_mfma_f32_16x16x32_bf16 v[84:87], a[164:167], a[48:51], v[84:87]
    ds_read_b64_tr_b16 a[134:135], v19 offset:16896
    buffer_load_dwordx4 v28, s[12:15], s44 offen offset:2048 lds
    v_mfma_f32_16x16x32_bf16 v[116:119], a[164:167], a[52:55], v[116:119]
    ds_read_b64_tr_b16 a[136:137], v20 offset:16384
    v_mfma_f32_16x16x32_bf16 v[148:151], a[164:167], a[56:59], v[148:151]
    ds_read_b64_tr_b16 a[138:139], v20 offset:16896
    v_mfma_f32_16x16x32_bf16 v[180:183], a[164:167], a[60:63], v[180:183]
    ds_read_b64_tr_b16 a[140:141], v21 offset:16384
    v_mfma_f32_16x16x32_bf16 v[88:91], a[168:171], a[48:51], v[88:91]
    ds_read_b64_tr_b16 a[142:143], v21 offset:16896
    buffer_load_dwordx4 v29, s[12:15], s44 offen offset:3072 lds
    v_mfma_f32_16x16x32_bf16 v[120:123], a[168:171], a[52:55], v[120:123]
    v_mfma_f32_16x16x32_bf16 v[152:155], a[168:171], a[56:59], v[152:155]
    v_mfma_f32_16x16x32_bf16 v[184:187], a[168:171], a[60:63], v[184:187]
    v_mfma_f32_16x16x32_bf16 v[92:95], a[172:175], a[48:51], v[92:95]
    s_add_u32 s44, s44, 524288
    v_mfma_f32_16x16x32_bf16 v[124:127], a[172:175], a[52:55], v[124:127]
    v_mfma_f32_16x16x32_bf16 v[156:159], a[172:175], a[56:59], v[156:159]
    v_mfma_f32_16x16x32_bf16 v[188:191], a[172:175], a[60:63], v[188:191]
    v_mfma_f32_16x16x32_bf16 v[192:195], a[176:179], a[48:51], v[192:195]
    s_add_u32 m0, s50, 0
    s_nop 0
    v_mfma_f32_16x16x32_bf16 v[208:211], a[176:179], a[52:55], v[208:211]
    v_mfma_f32_16x16x32_bf16 v[224:227], a[176:179], a[56:59], v[224:227]
    v_mfma_f32_16x16x32_bf16 v[240:243], a[176:179], a[60:63], v[240:243]
    v_mfma_f32_16x16x32_bf16 v[196:199], a[180:183], a[48:51], v[196:199]
    buffer_load_dwordx4 v30, s[16:19], s45 offen offset:0 lds
    v_mfma_f32_16x16x32_bf16 v[212:215], a[180:183], a[52:55], v[212:215]
    v_mfma_f32_16x16x32_bf16 v[228:231], a[180:183], a[56:59], v[228:231]
    v_mfma_f32_16x16x32_bf16 v[244:247], a[180:183], a[60:63], v[244:247]
    v_mfma_f32_16x16x32_bf16 v[200:203], a[184:187], a[48:51], v[200:203]
    buffer_load_dwordx4 v31, s[16:19], s45 offen offset:1024 lds
    v_mfma_f32_16x16x32_bf16 v[216:219], a[184:187], a[52:55], v[216:219]
    v_mfma_f32_16x16x32_bf16 v[232:235], a[184:187], a[56:59], v[232:235]
    v_mfma_f32_16x16x32_bf16 v[248:251], a[184:187], a[60:63], v[248:251]
    v_mfma_f32_16x16x32_bf16 v[204:207], a[188:191], a[48:51], v[204:207]
    s_add_u32 s45, s45, 221184
    v_mfma_f32_16x16x32_bf16 v[220:223], a[188:191], a[52:55], v[220:223]
    v_mfma_f32_16x16x32_bf16 v[236:239], a[188:191], a[56:59], v[236:239]
    v_mfma_f32_16x16x32_bf16 v[252:255], a[188:191], a[60:63], v[252:255]
    s_waitcnt vmcnt(20)
    s_waitcnt lgkmcnt(0)
    v_mfma_f32_16x16x32_bf16 v[64:67], a[96:99], a[64:67], v[64:67]
    v_mfma_f32_16x16x32_bf16 v[96:99], a[96:99], a[68:71], v[96:99]
    ds_read_b64_tr_b16 a[144:145], v14 offset:40960
    v_mfma_f32_16x16x32_bf16 v[128:131], a[96:99], a[72:75], v[128:131]
    ds_read_b64_tr_b16 a[146:147], v14 offset:41984
    v_mfma_f32_16x16x32_bf16 v[160:163], a[96:99], a[76:79], v[160:163]
    ds_read_b64_tr_b16 a[148:149], v14 offset:40968
    v_mfma_f32_16x16x32_bf16 v[68:71], a[100:103], a[64:67], v[68:71]
    ds_read_b64_tr_b16 a[150:151], v14 offset:41992
    v_mfma_f32_16x16x32_bf16 v[100:103], a[100:103], a[68:71], v[100:103]
    ds_read_b64_tr_b16 a[152:153], v15 offset:40960
    v_mfma_f32_16x16x32_bf16 v[132:135], a[100:103], a[72:75], v[132:135]
    ds_read_b64_tr_b16 a[154:155], v15 offset:41984
    v_mfma_f32_16x16x32_bf16 v[164:167], a[100:103], a[76:79], v[164:167]
    ds_read_b64_tr_b16 a[156:157], v15 offset:40968
    v_mfma_f32_16x16x32_bf16 v[72:75], a[104:107], a[64:67], v[72:75]
    ds_read_b64_tr_b16 a[158:159], v15 offset:41992
    buffer_load_dwordx2 v[38:39], v62, s[32:35], 0 offen offset:0
    buffer_load_dwordx2 v[40:41], v62, s[32:35], 0 offen offset:32
    buffer_load_dwordx2 v[42:43], v62, s[32:35], 0 offen offset:64
    buffer_load_dwordx2 v[44:45], v62, s[32:35], 0 offen offset:96
    buffer_load_dword v33, v63, s[36:39], 0 offen offset:0 sc1
    buffer_load_dword v34, v63, s[36:39], 0 offen offset:64 sc1
    buffer_load_dword v35, v63, s[36:39], 0 offen offset:128 sc1
    buffer_load_dword v36, v63, s[36:39], 0 offen offset:192 sc1
    v_mfma_f32_16x16x32_bf16 v[104:107], a[104:107], a[68:71], v[104:107]
    ds_read_b64_tr_b16 a[160:161], v16 offset:40960
    v_mfma_f32_16x16x32_bf16 v[136:139], a[104:107], a[72:75], v[136:139]
    ds_read_b64_tr_b16 a[162:163], v16 offset:41984
    v_mfma_f32_16x16x32_bf16 v[168:171], a[104:107], a[76:79], v[168:171]
    ds_read_b64_tr_b16 a[164:165], v16 offset:40968
    v_mfma_f32_16x16x32_bf16 v[76:79], a[108:111], a[64:67], v[76:79]
    ds_read_b64_tr_b16 a[166:167], v16 offset:41992
    buffer_load_dwordx4 a[32:35], v32, s[20:23], s56 offen offset:0 sc1
    v_mfma_f32_16x16x32_bf16 v[108:111], a[108:111], a[68:71], v[108:111]
    ds_read_b64_tr_b16 a[168:169], v17 offset:40960
    v_mfma_f32_16x16x32_bf16 v[140:143], a[108:111], a[72:75], v[140:143]
    ds_read_b64_tr_b16 a[170:171], v17 offset:41984
    v_mfma_f32_16x16x32_bf16 v[172:175], a[108:111], a[76:79], v[172:175]
    ds_read_b64_tr_b16 a[172:173], v17 offset:40968
    v_mfma_f32_16x16x32_bf16 v[80:83], a[112:115], a[64:67], v[80:83]
    ds_read_b64_tr_b16 a[174:175], v17 offset:41992
    buffer_load_dwordx4 a[36:39], v32, s[20:23], s57 offen offset:0 sc1
    v_mfma_f32_16x16x32_bf16 v[112:115], a[112:115], a[68:71], v[112:115]
    ds_read_b64_tr_b16 a[176:177], v18 offset:20480
    v_mfma_f32_16x16x32_bf16 v[144:147], a[112:115], a[72:75], v[144:147]
    ds_read_b64_tr_b16 a[178:179], v18 offset:20992
    v_mfma_f32_16x16x32_bf16 v[176:179], a[112:115], a[76:79], v[176:179]
    ds_read_b64_tr_b16 a[180:181], v19 offset:20480
    v_mfma_f32_16x16x32_bf16 v[84:87], a[116:119], a[64:67], v[84:87]
    ds_read_b64_tr_b16 a[182:183], v19 offset:20992
    v_mfma_f32_16x16x32_bf16 v[116:119], a[116:119], a[68:71], v[116:119]
    ds_read_b64_tr_b16 a[184:185], v20 offset:20480
    buffer_load_dwordx4 a[40:43], v32, s[20:23], s58 offen offset:0 sc1
    v_mfma_f32_16x16x32_bf16 v[148:151], a[116:119], a[72:75], v[148:151]
    ds_read_b64_tr_b16 a[186:187], v20 offset:20992
    v_mfma_f32_16x16x32_bf16 v[180:183], a[116:119], a[76:79], v[180:183]
    ds_read_b64_tr_b16 a[188:189], v21 offset:20480
    v_mfma_f32_16x16x32_bf16 v[88:91], a[120:123], a[64:67], v[88:91]
    ds_read_b64_tr_b16 a[190:191], v21 offset:20992
    v_mfma_f32_16x16x32_bf16 v[120:123], a[120:123], a[68:71], v[120:123]
    buffer_load_dwordx4 a[44:47], v32, s[20:23], s59 offen offset:0 sc1
    v_mfma_f32_16x16x32_bf16 v[152:155], a[120:123], a[72:75], v[152:155]
    v_mfma_f32_16x16x32_bf16 v[184:187], a[120:123], a[76:79], v[184:187]
    v_mfma_f32_16x16x32_bf16 v[92:95], a[124:127], a[64:67], v[92:95]
    v_mfma_f32_16x16x32_bf16 v[124:127], a[124:127], a[68:71], v[124:127]
    v_mfma_f32_16x16x32_bf16 v[156:159], a[124:127], a[72:75], v[156:159]
    buffer_load_dwordx4 a[48:51], v32, s[20:23], s56 offen offset:1024 sc1
    v_mfma_f32_16x16x32_bf16 v[188:191], a[124:127], a[76:79], v[188:191]
    v_mfma_f32_16x16x32_bf16 v[192:195], a[128:131], a[64:67], v[192:195]
    v_mfma_f32_16x16x32_bf16 v[208:211], a[128:131], a[68:71], v[208:211]
    v_mfma_f32_16x16x32_bf16 v[224:227], a[128:131], a[72:75], v[224:227]
    buffer_load_dwordx4 a[52:55], v32, s[20:23], s57 offen offset:1024 sc1
    v_mfma_f32_16x16x32_bf16 v[240:243], a[128:131], a[76:79], v[240:243]
    v_mfma_f32_16x16x32_bf16 v[196:199], a[132:135], a[64:67], v[196:199]
    v_mfma_f32_16x16x32_bf16 v[212:215], a[132:135], a[68:71], v[212:215]
    v_mfma_f32_16x16x32_bf16 v[228:231], a[132:135], a[72:75], v[228:231]
    v_mfma_f32_16x16x32_bf16 v[244:247], a[132:135], a[76:79], v[244:247]
    buffer_load_dwordx4 a[56:59], v32, s[20:23], s58 offen offset:1024 sc1
    v_mfma_f32_16x16x32_bf16 v[200:203], a[136:139], a[64:67], v[200:203]
    v_mfma_f32_16x16x32_bf16 v[216:219], a[136:139], a[68:71], v[216:219]
    v_mfma_f32_16x16x32_bf16 v[232:235], a[136:139], a[72:75], v[232:235]
    v_mfma_f32_16x16x32_bf16 v[248:251], a[136:139], a[76:79], v[248:251]
    buffer_load_dwordx4 a[60:63], v32, s[20:23], s59 offen offset:1024 sc1
    v_mfma_f32_16x16x32_bf16 v[204:207], a[140:143], a[64:67], v[204:207]
    v_mfma_f32_16x16x32_bf16 v[220:223], a[140:143], a[68:71], v[220:223]
    v_mfma_f32_16x16x32_bf16 v[236:239], a[140:143], a[72:75], v[236:239]
    v_mfma_f32_16x16x32_bf16 v[252:255], a[140:143], a[76:79], v[252:255]
    s_waitcnt lgkmcnt(0)
    v_mfma_f32_16x16x32_bf16 v[64:67], a[144:147], a[80:83], v[64:67]
    s_waitcnt vmcnt(30)
    s_barrier
    v_mfma_f32_16x16x32_bf16 v[96:99], a[144:147], a[84:87], v[96:99]
    ds_read_b64_tr_b16 a[96:97], v14 offset:49152
    v_mfma_f32_16x16x32_bf16 v[128:131], a[144:147], a[88:91], v[128:131]
    ds_read_b64_tr_b16 a[98:99], v14 offset:50176
    v_mfma_f32_16x16x32_bf16 v[160:163], a[144:147], a[92:95], v[160:163]
    ds_read_b64_tr_b16 a[100:101], v14 offset:49160
    v_mfma_f32_16x16x32_bf16 v[68:71], a[148:151], a[80:83], v[68:71]
    ds_read_b64_tr_b16 a[102:103], v14 offset:50184
    v_mfma_f32_16x16x32_bf16 v[100:103], a[148:151], a[84:87], v[100:103]
    ds_read_b64_tr_b16 a[104:105], v15 offset:49152
    v_mfma_f32_16x16x32_bf16 v[132:135], a[148:151], a[88:91], v[132:135]
    ds_read_b64_tr_b16 a[106:107], v15 offset:50176
    v_mfma_f32_16x16x32_bf16 v[164:167], a[148:151], a[92:95], v[164:167]
    ds_read_b64_tr_b16 a[108:109], v15 offset:49160
    v_mfma_f32_16x16x32_bf16 v[72:75], a[152:155], a[80:83], v[72:75]
    ds_read_b64_tr_b16 a[110:111], v15 offset:50184
    s_add_u32 m0, s51, 16384
    s_nop 0
    v_mfma_f32_16x16x32_bf16 v[104:107], a[152:155], a[84:87], v[104:107]
    ds_read_b64_tr_b16 a[112:113], v16 offset:49152
    v_mfma_f32_16x16x32_bf16 v[136:139], a[152:155], a[88:91], v[136:139]
    ds_read_b64_tr_b16 a[114:115], v16 offset:50176
    v_mfma_f32_16x16x32_bf16 v[168:171], a[152:155], a[92:95], v[168:171]
    ds_read_b64_tr_b16 a[116:117], v16 offset:49160
    v_mfma_f32_16x16x32_bf16 v[76:79], a[156:159], a[80:83], v[76:79]
    ds_read_b64_tr_b16 a[118:119], v16 offset:50184
    buffer_load_dwordx4 v26, s[12:15], s44 offen offset:0 lds
    v_mfma_f32_16x16x32_bf16 v[108:111], a[156:159], a[84:87], v[108:111]
    ds_read_b64_tr_b16 a[120:121], v17 offset:49152
    v_mfma_f32_16x16x32_bf16 v[140:143], a[156:159], a[88:91], v[140:143]
    ds_read_b64_tr_b16 a[122:123], v17 offset:50176
    v_mfma_f32_16x16x32_bf16 v[172:175], a[156:159], a[92:95], v[172:175]
    ds_read_b64_tr_b16 a[124:125], v17 offset:49160
    v_mfma_f32_16x16x32_bf16 v[80:83], a[160:163], a[80:83], v[80:83]
    ds_read_b64_tr_b16 a[126:127], v17 offset:50184
    buffer_load_dwordx4 v27, s[12:15], s44 offen offset:1024 lds
    v_mfma_f32_16x16x32_bf16 v[112:115], a[160:163], a[84:87], v[112:115]
    ds_read_b64_tr_b16 a[128:129], v18 offset:24576
    v_mfma_f32_16x16x32_bf16 v[144:147], a[160:163], a[88:91], v[144:147]
    ds_read_b64_tr_b16 a[130:131], v18 offset:25088
    v_mfma_f32_16x16x32_bf16 v[176:179], a[160:163], a[92:95], v[176:179]
    ds_read_b64_tr_b16 a[132:133], v19 offset:24576
    v_mfma_f32_16x16x32_bf16 v[84:87], a[164:167], a[80:83], v[84:87]
    ds_read_b64_tr_b16 a[134:135], v19 offset:25088
    buffer_load_dwordx4 v28, s[12:15], s44 offen offset:2048 lds
    v_mfma_f32_16x16x32_bf16 v[116:119], a[164:167], a[84:87], v[116:119]
    ds_read_b64_tr_b16 a[136:137], v20 offset:24576
    v_mfma_f32_16x16x32_bf16 v[148:151], a[164:167], a[88:91], v[148:151]
    ds_read_b64_tr_b16 a[138:139], v20 offset:25088
    v_mfma_f32_16x16x32_bf16 v[180:183], a[164:167], a[92:95], v[180:183]
    ds_read_b64_tr_b16 a[140:141], v21 offset:24576
    v_mfma_f32_16x16x32_bf16 v[88:91], a[168:171], a[80:83], v[88:91]
    ds_read_b64_tr_b16 a[142:143], v21 offset:25088
    buffer_load_dwordx4 v29, s[12:15], s44 offen offset:3072 lds
    v_mfma_f32_16x16x32_bf16 v[120:123], a[168:171], a[84:87], v[120:123]
    v_mfma_f32_16x16x32_bf16 v[152:155], a[168:171], a[88:91], v[152:155]
    v_mfma_f32_16x16x32_bf16 v[184:187], a[168:171], a[92:95], v[184:187]
    v_mfma_f32_16x16x32_bf16 v[92:95], a[172:175], a[80:83], v[92:95]
    s_add_u32 s44, s44, 524288
    v_mfma_f32_16x16x32_bf16 v[124:127], a[172:175], a[84:87], v[124:127]
    v_mfma_f32_16x16x32_bf16 v[156:159], a[172:175], a[88:91], v[156:159]
    v_mfma_f32_16x16x32_bf16 v[188:191], a[172:175], a[92:95], v[188:191]
    v_mfma_f32_16x16x32_bf16 v[192:195], a[176:179], a[80:83], v[192:195]
    s_add_u32 m0, s50, 8192
    s_nop 0
    v_mfma_f32_16x16x32_bf16 v[208:211], a[176:179], a[84:87], v[208:211]
    v_mfma_f32_16x16x32_bf16 v[224:227], a[176:179], a[88:91], v[224:227]
    v_mfma_f32_16x16x32_bf16 v[240:243], a[176:179], a[92:95], v[240:243]
    v_mfma_f32_16x16x32_bf16 v[196:199], a[180:183], a[80:83], v[196:199]
    buffer_load_dwordx4 v30, s[16:19], s45 offen offset:0 lds
    v_mfma_f32_16x16x32_bf16 v[212:215], a[180:183], a[84:87], v[212:215]
    v_mfma_f32_16x16x32_bf16 v[228:231], a[180:183], a[88:91], v[228:231]
    v_mfma_f32_16x16x32_bf16 v[244:247], a[180:183], a[92:95], v[244:247]
    v_mfma_f32_16x16x32_bf16 v[200:203], a[184:187], a[80:83], v[200:203]
    buffer_load_dwordx4 v31, s[16:19], s45 offen offset:1024 lds
    v_mfma_f32_16x16x32_bf16 v[216:219], a[184:187], a[84:87], v[216:219]
    v_mfma_f32_16x16x32_bf16 v[232:235], a[184:187], a[88:91], v[232:235]
    v_mfma_f32_16x16x32_bf16 v[248:251], a[184:187], a[92:95], v[248:251]
    v_mfma_f32_16x16x32_bf16 v[204:207], a[188:191], a[80:83], v[204:207]
    s_add_u32 s45, s45, 221184
    v_mfma_f32_16x16x32_bf16 v[220:223], a[188:191], a[84:87], v[220:223]
    v_mfma_f32_16x16x32_bf16 v[236:239], a[188:191], a[88:91], v[236:239]
    v_mfma_f32_16x16x32_bf16 v[252:255], a[188:191], a[92:95], v[252:255]
    s_waitcnt vmcnt(28)
    s_waitcnt lgkmcnt(0)
    v_mfma_f32_16x16x32_bf16 v[64:67], a[96:99], a[0:3], v[64:67]
    v_mfma_f32_16x16x32_bf16 v[96:99], a[96:99], a[4:7], v[96:99]
    ds_read_b64_tr_b16 a[144:145], v14 offset:57344
    v_mfma_f32_16x16x32_bf16 v[128:131], a[96:99], a[8:11], v[128:131]
    ds_read_b64_tr_b16 a[146:147], v14 offset:58368
    v_mfma_f32_16x16x32_bf16 v[160:163], a[96:99], a[12:15], v[160:163]
    ds_read_b64_tr_b16 a[148:149], v14 offset:57352
    v_mfma_f32_16x16x32_bf16 v[68:71], a[100:103], a[0:3], v[68:71]
    ds_read_b64_tr_b16 a[150:151], v14 offset:58376
    v_mfma_f32_16x16x32_bf16 v[100:103], a[100:103], a[4:7], v[100:103]
    ds_read_b64_tr_b16 a[152:153], v15 offset:57344
    v_mfma_f32_16x16x32_bf16 v[132:135], a[100:103], a[8:11], v[132:135]
    ds_read_b64_tr_b16 a[154:155], v15 offset:58368
    v_mfma_f32_16x16x32_bf16 v[164:167], a[100:103], a[12:15], v[164:167]
    ds_read_b64_tr_b16 a[156:157], v15 offset:57352
    v_mfma_f32_16x16x32_bf16 v[72:75], a[104:107], a[0:3], v[72:75]
    ds_read_b64_tr_b16 a[158:159], v15 offset:58376
    buffer_load_dwordx4 a[64:67], v32, s[20:23], s56 offen offset:2048 sc1
    v_mfma_f32_16x16x32_bf16 v[104:107], a[104:107], a[4:7], v[104:107]
    ds_read_b64_tr_b16 a[160:161], v16 offset:57344
    v_mfma_f32_16x16x32_bf16 v[136:139], a[104:107], a[8:11], v[136:139]
    ds_read_b64_tr_b16 a[162:163], v16 offset:58368
    v_mfma_f32_16x16x32_bf16 v[168:171], a[104:107], a[12:15], v[168:171]
    ds_read_b64_tr_b16 a[164:165], v16 offset:57352
    v_mfma_f32_16x16x32_bf16 v[76:79], a[108:111], a[0:3], v[76:79]
    ds_read_b64_tr_b16 a[166:167], v16 offset:58376
    buffer_load_dwordx4 a[68:71], v32, s[20:23], s57 offen offset:2048 sc1
    v_mfma_f32_16x16x32_bf16 v[108:111], a[108:111], a[4:7], v[108:111]
    ds_read_b64_tr_b16 a[168:169], v17 offset:57344
    v_mfma_f32_16x16x32_bf16 v[140:143], a[108:111], a[8:11], v[140:143]
    ds_read_b64_tr_b16 a[170:171], v17 offset:58368
    v_mfma_f32_16x16x32_bf16 v[172:175], a[108:111], a[12:15], v[172:175]
    ds_read_b64_tr_b16 a[172:173], v17 offset:57352
    v_mfma_f32_16x16x32_bf16 v[80:83], a[112:115], a[0:3], v[80:83]
    ds_read_b64_tr_b16 a[174:175], v17 offset:58376
    buffer_load_dwordx4 a[72:75], v32, s[20:23], s58 offen offset:2048 sc1
    v_mfma_f32_16x16x32_bf16 v[112:115], a[112:115], a[4:7], v[112:115]
    ds_read_b64_tr_b16 a[176:177], v18 offset:28672
    v_mfma_f32_16x16x32_bf16 v[144:147], a[112:115], a[8:11], v[144:147]
    ds_read_b64_tr_b16 a[178:179], v18 offset:29184
    v_mfma_f32_16x16x32_bf16 v[176:179], a[112:115], a[12:15], v[176:179]
    ds_read_b64_tr_b16 a[180:181], v19 offset:28672
    v_mfma_f32_16x16x32_bf16 v[84:87], a[116:119], a[0:3], v[84:87]
    ds_read_b64_tr_b16 a[182:183], v19 offset:29184
    v_mfma_f32_16x16x32_bf16 v[116:119], a[116:119], a[4:7], v[116:119]
    ds_read_b64_tr_b16 a[184:185], v20 offset:28672
    buffer_load_dwordx4 a[76:79], v32, s[20:23], s59 offen offset:2048 sc1
    v_mfma_f32_16x16x32_bf16 v[148:151], a[116:119], a[8:11], v[148:151]
    ds_read_b64_tr_b16 a[186:187], v20 offset:29184
    v_mfma_f32_16x16x32_bf16 v[180:183], a[116:119], a[12:15], v[180:183]
    ds_read_b64_tr_b16 a[188:189], v21 offset:28672
    v_mfma_f32_16x16x32_bf16 v[88:91], a[120:123], a[0:3], v[88:91]
    ds_read_b64_tr_b16 a[190:191], v21 offset:29184
    v_mfma_f32_16x16x32_bf16 v[120:123], a[120:123], a[4:7], v[120:123]
    buffer_load_dwordx4 a[80:83], v32, s[20:23], s56 offen offset:3072 sc1
    v_mfma_f32_16x16x32_bf16 v[152:155], a[120:123], a[8:11], v[152:155]
    v_mfma_f32_16x16x32_bf16 v[184:187], a[120:123], a[12:15], v[184:187]
    v_mfma_f32_16x16x32_bf16 v[92:95], a[124:127], a[0:3], v[92:95]
    v_mfma_f32_16x16x32_bf16 v[124:127], a[124:127], a[4:7], v[124:127]
    v_mfma_f32_16x16x32_bf16 v[156:159], a[124:127], a[8:11], v[156:159]
    buffer_load_dwordx4 a[84:87], v32, s[20:23], s57 offen offset:3072 sc1
    v_mfma_f32_16x16x32_bf16 v[188:191], a[124:127], a[12:15], v[188:191]
    v_mfma_f32_16x16x32_bf16 v[192:195], a[128:131], a[0:3], v[192:195]
    v_mfma_f32_16x16x32_bf16 v[208:211], a[128:131], a[4:7], v[208:211]
    v_mfma_f32_16x16x32_bf16 v[224:227], a[128:131], a[8:11], v[224:227]
    buffer_load_dwordx4 a[88:91], v32, s[20:23], s58 offen offset:3072 sc1
    v_mfma_f32_16x16x32_bf16 v[240:243], a[128:131], a[12:15], v[240:243]
    v_mfma_f32_16x16x32_bf16 v[196:199], a[132:135], a[0:3], v[196:199]
    v_mfma_f32_16x16x32_bf16 v[212:215], a[132:135], a[4:7], v[212:215]
    v_mfma_f32_16x16x32_bf16 v[228:231], a[132:135], a[8:11], v[228:231]
    v_mfma_f32_16x16x32_bf16 v[244:247], a[132:135], a[12:15], v[244:247]
    buffer_load_dwordx4 a[92:95], v32, s[20:23], s59 offen offset:3072 sc1
    v_mfma_f32_16x16x32_bf16 v[200:203], a[136:139], a[0:3], v[200:203]
    v_mfma_f32_16x16x32_bf16 v[216:219], a[136:139], a[4:7], v[216:219]
    v_mfma_f32_16x16x32_bf16 v[232:235], a[136:139], a[8:11], v[232:235]
    v_mfma_f32_16x16x32_bf16 v[248:251], a[136:139], a[12:15], v[248:251]
    s_add_u32 s56, s56, 4096
    s_add_u32 s57, s57, 4096
    s_add_u32 s58, s58, 4096
    s_add_u32 s59, s59, 4096
    v_mfma_f32_16x16x32_bf16 v[204:207], a[140:143], a[0:3], v[204:207]
    v_mfma_f32_16x16x32_bf16 v[220:223], a[140:143], a[4:7], v[220:223]
    v_mfma_f32_16x16x32_bf16 v[236:239], a[140:143], a[8:11], v[236:239]
    v_mfma_f32_16x16x32_bf16 v[252:255], a[140:143], a[12:15], v[252:255]
    s_waitcnt lgkmcnt(0)
    v_mfma_f32_16x16x32_bf16 v[64:67], a[144:147], a[16:19], v[64:67]
    s_waitcnt vmcnt(30)
    s_barrier
    v_mfma_f32_16x16x32_bf16 v[96:99], a[144:147], a[20:23], v[96:99]
    ds_read_b64_tr_b16 a[96:97], v14 offset:0
    v_mfma_f32_16x16x32_bf16 v[128:131], a[144:147], a[24:27], v[128:131]
    ds_read_b64_tr_b16 a[98:99], v14 offset:1024
    v_mfma_f32_16x16x32_bf16 v[160:163], a[144:147], a[28:31], v[160:163]
    ds_read_b64_tr_b16 a[100:101], v14 offset:8
    v_mfma_f32_16x16x32_bf16 v[68:71], a[148:151], a[16:19], v[68:71]
    ds_read_b64_tr_b16 a[102:103], v14 offset:1032
    v_mfma_f32_16x16x32_bf16 v[100:103], a[148:151], a[20:23], v[100:103]
    ds_read_b64_tr_b16 a[104:105], v15 offset:0
    v_mfma_f32_16x16x32_bf16 v[132:135], a[148:151], a[24:27], v[132:135]
    ds_read_b64_tr_b16 a[106:107], v15 offset:1024
    v_mfma_f32_16x16x32_bf16 v[164:167], a[148:151], a[28:31], v[164:167]
    ds_read_b64_tr_b16 a[108:109], v15 offset:8
    v_mfma_f32_16x16x32_bf16 v[72:75], a[152:155], a[16:19], v[72:75]
    ds_read_b64_tr_b16 a[110:111], v15 offset:1032
    s_add_u32 m0, s51, 32768
    s_nop 0
    v_mfma_f32_16x16x32_bf16 v[104:107], a[152:155], a[20:23], v[104:107]
    ds_read_b64_tr_b16 a[112:113], v16 offset:0
    v_mfma_f32_16x16x32_bf16 v[136:139], a[152:155], a[24:27], v[136:139]
    ds_read_b64_tr_b16 a[114:115], v16 offset:1024
    v_mfma_f32_16x16x32_bf16 v[168:171], a[152:155], a[28:31], v[168:171]
    ds_read_b64_tr_b16 a[116:117], v16 offset:8
    v_mfma_f32_16x16x32_bf16 v[76:79], a[156:159], a[16:19], v[76:79]
    ds_read_b64_tr_b16 a[118:119], v16 offset:1032
    buffer_load_dwordx4 v26, s[12:15], s44 offen offset:0 lds
    v_mfma_f32_16x16x32_bf16 v[108:111], a[156:159], a[20:23], v[108:111]
    ds_read_b64_tr_b16 a[120:121], v17 offset:0
    v_mfma_f32_16x16x32_bf16 v[140:143], a[156:159], a[24:27], v[140:143]
    ds_read_b64_tr_b16 a[122:123], v17 offset:1024
    v_mfma_f32_16x16x32_bf16 v[172:175], a[156:159], a[28:31], v[172:175]
    ds_read_b64_tr_b16 a[124:125], v17 offset:8
    v_mfma_f32_16x16x32_bf16 v[80:83], a[160:163], a[16:19], v[80:83]
    ds_read_b64_tr_b16 a[126:127], v17 offset:1032
    buffer_load_dwordx4 v27, s[12:15], s44 offen offset:1024 lds
    v_mfma_f32_16x16x32_bf16 v[112:115], a[160:163], a[20:23], v[112:115]
    ds_read_b64_tr_b16 a[128:129], v18 offset:0
    v_mfma_f32_16x16x32_bf16 v[144:147], a[160:163], a[24:27], v[144:147]
    ds_read_b64_tr_b16 a[130:131], v18 offset:512
    v_mfma_f32_16x16x32_bf16 v[176:179], a[160:163], a[28:31], v[176:179]
    ds_read_b64_tr_b16 a[132:133], v19 offset:0
    v_mfma_f32_16x16x32_bf16 v[84:87], a[164:167], a[16:19], v[84:87]
    ds_read_b64_tr_b16 a[134:135], v19 offset:512
    buffer_load_dwordx4 v28, s[12:15], s44 offen offset:2048 lds
    v_mfma_f32_16x16x32_bf16 v[116:119], a[164:167], a[20:23], v[116:119]
    ds_read_b64_tr_b16 a[136:137], v20 offset:0
    v_mfma_f32_16x16x32_bf16 v[148:151], a[164:167], a[24:27], v[148:151]
    ds_read_b64_tr_b16 a[138:139], v20 offset:512
    v_mfma_f32_16x16x32_bf16 v[180:183], a[164:167], a[28:31], v[180:183]
    ds_read_b64_tr_b16 a[140:141], v21 offset:0
    v_mfma_f32_16x16x32_bf16 v[88:91], a[168:171], a[16:19], v[88:91]
    ds_read_b64_tr_b16 a[142:143], v21 offset:512
    buffer_load_dwordx4 v29, s[12:15], s44 offen offset:3072 lds
    v_mfma_f32_16x16x32_bf16 v[120:123], a[168:171], a[20:23], v[120:123]
    v_mfma_f32_16x16x32_bf16 v[152:155], a[168:171], a[24:27], v[152:155]
    v_mfma_f32_16x16x32_bf16 v[184:187], a[168:171], a[28:31], v[184:187]
    v_mfma_f32_16x16x32_bf16 v[92:95], a[172:175], a[16:19], v[92:95]
    s_add_u32 s44, s44, 524288
    v_mfma_f32_16x16x32_bf16 v[124:127], a[172:175], a[20:23], v[124:127]
    v_mfma_f32_16x16x32_bf16 v[156:159], a[172:175], a[24:27], v[156:159]
    v_mfma_f32_16x16x32_bf16 v[188:191], a[172:175], a[28:31], v[188:191]
    v_mfma_f32_16x16x32_bf16 v[192:195], a[176:179], a[16:19], v[192:195]
    s_add_u32 m0, s50, 16384
    s_nop 0
    v_mfma_f32_16x16x32_bf16 v[208:211], a[176:179], a[20:23], v[208:211]
    v_mfma_f32_16x16x32_bf16 v[224:227], a[176:179], a[24:27], v[224:227]
    v_mfma_f32_16x16x32_bf16 v[240:243], a[176:179], a[28:31], v[240:243]
    v_mfma_f32_16x16x32_bf16 v[196:199], a[180:183], a[16:19], v[196:199]
    buffer_load_dwordx4 v30, s[16:19], s45 offen offset:0 lds
    v_mfma_f32_16x16x32_bf16 v[212:215], a[180:183], a[20:23], v[212:215]
    v_mfma_f32_16x16x32_bf16 v[228:231], a[180:183], a[24:27], v[228:231]
    v_mfma_f32_16x16x32_bf16 v[244:247], a[180:183], a[28:31], v[244:247]
    v_mfma_f32_16x16x32_bf16 v[200:203], a[184:187], a[16:19], v[200:203]
    buffer_load_dwordx4 v31, s[16:19], s45 offen offset:1024 lds
    v_mfma_f32_16x16x32_bf16 v[216:219], a[184:187], a[20:23], v[216:219]
    v_mfma_f32_16x16x32_bf16 v[232:235], a[184:187], a[24:27], v[232:235]
    v_mfma_f32_16x16x32_bf16 v[248:251], a[184:187], a[28:31], v[248:251]
    v_mfma_f32_16x16x32_bf16 v[204:207], a[188:191], a[16:19], v[204:207]
    s_add_u32 s45, s45, 221184
    v_mfma_f32_16x16x32_bf16 v[220:223], a[188:191], a[20:23], v[220:223]
    v_mfma_f32_16x16x32_bf16 v[236:239], a[188:191], a[24:27], v[236:239]
    v_mfma_f32_16x16x32_bf16 v[252:255], a[188:191], a[28:31], v[252:255]
    s_waitcnt vmcnt(20)
    s_waitcnt lgkmcnt(0)
    v_mfma_f32_16x16x32_bf16 v[64:67], a[96:99], a[32:35], v[64:67]
    v_mfma_f32_16x16x32_bf16 v[96:99], a[96:99], a[36:39], v[96:99]
    ds_read_b64_tr_b16 a[144:145], v14 offset:8192
    v_mfma_f32_16x16x32_bf16 v[128:131], a[96:99], a[40:43], v[128:131]
    ds_read_b64_tr_b16 a[146:147], v14 offset:9216
    v_mfma_f32_16x16x32_bf16 v[160:163], a[96:99], a[44:47], v[160:163]
    ds_read_b64_tr_b16 a[148:149], v14 offset:8200
    v_mfma_f32_16x16x32_bf16 v[68:71], a[100:103], a[32:35], v[68:71]
    ds_read_b64_tr_b16 a[150:151], v14 offset:9224
    v_mfma_f32_16x16x32_bf16 v[100:103], a[100:103], a[36:39], v[100:103]
    ds_read_b64_tr_b16 a[152:153], v15 offset:8192
    v_mfma_f32_16x16x32_bf16 v[132:135], a[100:103], a[40:43], v[132:135]
    ds_read_b64_tr_b16 a[154:155], v15 offset:9216
    v_mfma_f32_16x16x32_bf16 v[164:167], a[100:103], a[44:47], v[164:167]
    ds_read_b64_tr_b16 a[156:157], v15 offset:8200
    v_mfma_f32_16x16x32_bf16 v[72:75], a[104:107], a[32:35], v[72:75]
    ds_read_b64_tr_b16 a[158:159], v15 offset:9224
    buffer_load_dwordx4 a[0:3], v32, s[20:23], s56 offen offset:0 sc1
    v_mfma_f32_16x16x32_bf16 v[104:107], a[104:107], a[36:39], v[104:107]
    ds_read_b64_tr_b16 a[160:161], v16 offset:8192
    v_mfma_f32_16x16x32_bf16 v[136:139], a[104:107], a[40:43], v[136:139]
    ds_read_b64_tr_b16 a[162:163], v16 offset:9216
    v_mfma_f32_16x16x32_bf16 v[168:171], a[104:107], a[44:47], v[168:171]
    ds_read_b64_tr_b16 a[164:165], v16 offset:8200
    v_mfma_f32_16x16x32_bf16 v[76:79], a[108:111], a[32:35], v[76:79]
    ds_read_b64_tr_b16 a[166:167], v16 offset:9224
    v_mfma_f32_16x16x32_bf16 v[108:111], a[108:111], a[36:39], v[108:111]
    ds_read_b64_tr_b16 a[168:169], v17 offset:8192
    buffer_load_dwordx4 a[4:7], v32, s[20:23], s57 offen offset:0 sc1
    v_mfma_f32_16x16x32_bf16 v[140:143], a[108:111], a[40:43], v[140:143]
    ds_read_b64_tr_b16 a[170:171], v17 offset:9216
    v_mfma_f32_16x16x32_bf16 v[172:175], a[108:111], a[44:47], v[172:175]
    ds_read_b64_tr_b16 a[172:173], v17 offset:8200
    v_mfma_f32_16x16x32_bf16 v[80:83], a[112:115], a[32:35], v[80:83]
    ds_read_b64_tr_b16 a[174:175], v17 offset:9224
    v_mfma_f32_16x16x32_bf16 v[112:115], a[112:115], a[36:39], v[112:115]
    ds_read_b64_tr_b16 a[176:177], v18 offset:4096
    v_mfma_f32_16x16x32_bf16 v[144:147], a[112:115], a[40:43], v[144:147]
    ds_read_b64_tr_b16 a[178:179], v18 offset:4608
    buffer_load_dwordx4 a[8:11], v32, s[20:23], s58 offen offset:0 sc1
    v_mfma_f32_16x16x32_bf16 v[176:179], a[112:115], a[44:47], v[176:179]
    ds_read_b64_tr_b16 a[180:181], v19 offset:4096
    v_mfma_f32_16x16x32_bf16 v[84:87], a[116:119], a[32:35], v[84:87]
    ds_read_b64_tr_b16 a[182:183], v19 offset:4608
    v_mfma_f32_16x16x32_bf16 v[116:119], a[116:119], a[36:39], v[116:119]
    ds_read_b64_tr_b16 a[184:185], v20 offset:4096
    v_mfma_f32_16x16x32_bf16 v[148:151], a[116:119], a[40:43], v[148:151]
    ds_read_b64_tr_b16 a[186:187], v20 offset:4608
    v_mfma_f32_16x16x32_bf16 v[180:183], a[116:119], a[44:47], v[180:183]
    ds_read_b64_tr_b16 a[188:189], v21 offset:4096
    buffer_load_dwordx4 a[12:15], v32, s[20:23], s59 offen offset:0 sc1
    v_mfma_f32_16x16x32_bf16 v[88:91], a[120:123], a[32:35], v[88:91]
    ds_read_b64_tr_b16 a[190:191], v21 offset:4608
    v_mfma_f32_16x16x32_bf16 v[120:123], a[120:123], a[36:39], v[120:123]
    v_mfma_f32_16x16x32_bf16 v[152:155], a[120:123], a[40:43], v[152:155]
    v_mfma_f32_16x16x32_bf16 v[184:187], a[120:123], a[44:47], v[184:187]
    v_mfma_f32_16x16x32_bf16 v[92:95], a[124:127], a[32:35], v[92:95]
    buffer_load_dwordx4 a[16:19], v32, s[20:23], s56 offen offset:1024 sc1
    v_mfma_f32_16x16x32_bf16 v[124:127], a[124:127], a[36:39], v[124:127]
    v_mfma_f32_16x16x32_bf16 v[156:159], a[124:127], a[40:43], v[156:159]
    v_mfma_f32_16x16x32_bf16 v[188:191], a[124:127], a[44:47], v[188:191]
    v_mfma_f32_16x16x32_bf16 v[192:195], a[128:131], a[32:35], v[192:195]
    v_mfma_f32_16x16x32_bf16 v[208:211], a[128:131], a[36:39], v[208:211]
    buffer_load_dwordx4 a[20:23], v32, s[20:23], s57 offen offset:1024 sc1
    v_mfma_f32_16x16x32_bf16 v[224:227], a[128:131], a[40:43], v[224:227]
    v_mfma_f32_16x16x32_bf16 v[240:243], a[128:131], a[44:47], v[240:243]
    v_mfma_f32_16x16x32_bf16 v[196:199], a[132:135], a[32:35], v[196:199]
    v_mfma_f32_16x16x32_bf16 v[212:215], a[132:135], a[36:39], v[212:215]
    v_mfma_f32_16x16x32_bf16 v[228:231], a[132:135], a[40:43], v[228:231]
    buffer_load_dwordx4 a[24:27], v32, s[20:23], s58 offen offset:1024 sc1
    v_mfma_f32_16x16x32_bf16 v[244:247], a[132:135], a[44:47], v[244:247]
    v_mfma_f32_16x16x32_bf16 v[200:203], a[136:139], a[32:35], v[200:203]
    v_mfma_f32_16x16x32_bf16 v[216:219], a[136:139], a[36:39], v[216:219]
    v_mfma_f32_16x16x32_bf16 v[232:235], a[136:139], a[40:43], v[232:235]
    v_mfma_f32_16x16x32_bf16 v[248:251], a[136:139], a[44:47], v[248:251]
    buffer_load_dwordx4 a[28:31], v32, s[20:23], s59 offen offset:1024 sc1
    v_mfma_f32_16x16x32_bf16 v[204:207], a[140:143], a[32:35], v[204:207]
    v_mfma_f32_16x16x32_bf16 v[220:223], a[140:143], a[36:39], v[220:223]
    v_mfma_f32_16x16x32_bf16 v[236:239], a[140:143], a[40:43], v[236:239]
    v_mfma_f32_16x16x32_bf16 v[252:255], a[140:143], a[44:47], v[252:255]
    s_waitcnt lgkmcnt(0)
    v_mfma_f32_16x16x32_bf16 v[64:67], a[144:147], a[48:51], v[64:67]
    s_waitcnt vmcnt(22)
    s_barrier
    v_mfma_f32_16x16x32_bf16 v[96:99], a[144:147], a[52:55], v[96:99]
    ds_read_b64_tr_b16 a[96:97], v14 offset:16384
    v_mfma_f32_16x16x32_bf16 v[128:131], a[144:147], a[56:59], v[128:131]
    ds_read_b64_tr_b16 a[98:99], v14 offset:17408
    v_mfma_f32_16x16x32_bf16 v[160:163], a[144:147], a[60:63], v[160:163]
    ds_read_b64_tr_b16 a[100:101], v14 offset:16392
    v_mfma_f32_16x16x32_bf16 v[68:71], a[148:151], a[48:51], v[68:71]
    ds_read_b64_tr_b16 a[102:103], v14 offset:17416
    v_mfma_f32_16x16x32_bf16 v[100:103], a[148:151], a[52:55], v[100:103]
    ds_read_b64_tr_b16 a[104:105], v15 offset:16384
    v_mfma_f32_16x16x32_bf16 v[132:135], a[148:151], a[56:59], v[132:135]
    ds_read_b64_tr_b16 a[106:107], v15 offset:17408
    v_mfma_f32_16x16x32_bf16 v[164:167], a[148:151], a[60:63], v[164:167]
    ds_read_b64_tr_b16 a[108:109], v15 offset:16392
    v_mfma_f32_16x16x32_bf16 v[72:75], a[152:155], a[48:51], v[72:75]
    ds_read_b64_tr_b16 a[110:111], v15 offset:17416
    s_add_u32 m0, s51, 49152
    s_nop 0
    v_mfma_f32_16x16x32_bf16 v[104:107], a[152:155], a[52:55], v[104:107]
    ds_read_b64_tr_b16 a[112:113], v16 offset:16384
    v_mfma_f32_16x16x32_bf16 v[136:139], a[152:155], a[56:59], v[136:139]
    ds_read_b64_tr_b16 a[114:115], v16 offset:17408
    v_mfma_f32_16x16x32_bf16 v[168:171], a[152:155], a[60:63], v[168:171]
    ds_read_b64_tr_b16 a[116:117], v16 offset:16392
    v_mfma_f32_16x16x32_bf16 v[76:79], a[156:159], a[48:51], v[76:79]
    ds_read_b64_tr_b16 a[118:119], v16 offset:17416
    buffer_load_dwordx4 v26, s[12:15], s44 offen offset:0 lds
    v_mfma_f32_16x16x32_bf16 v[108:111], a[156:159], a[52:55], v[108:111]
    ds_read_b64_tr_b16 a[120:121], v17 offset:16384
    v_mfma_f32_16x16x32_bf16 v[140:143], a[156:159], a[56:59], v[140:143]
    ds_read_b64_tr_b16 a[122:123], v17 offset:17408
    v_mfma_f32_16x16x32_bf16 v[172:175], a[156:159], a[60:63], v[172:175]
    ds_read_b64_tr_b16 a[124:125], v17 offset:16392
    v_mfma_f32_16x16x32_bf16 v[80:83], a[160:163], a[48:51], v[80:83]
    ds_read_b64_tr_b16 a[126:127], v17 offset:17416
    buffer_load_dwordx4 v27, s[12:15], s44 offen offset:1024 lds
    v_mfma_f32_16x16x32_bf16 v[112:115], a[160:163], a[52:55], v[112:115]
    ds_read_b64_tr_b16 a[128:129], v18 offset:8192
    v_mfma_f32_16x16x32_bf16 v[144:147], a[160:163], a[56:59], v[144:147]
    ds_read_b64_tr_b16 a[130:131], v18 offset:8704
    v_mfma_f32_16x16x32_bf16 v[176:179], a[160:163], a[60:63], v[176:179]
    ds_read_b64_tr_b16 a[132:133], v19 offset:8192
    v_mfma_f32_16x16x32_bf16 v[84:87], a[164:167], a[48:51], v[84:87]
    ds_read_b64_tr_b16 a[134:135], v19 offset:8704
    buffer_load_dwordx4 v28, s[12:15], s44 offen offset:2048 lds
    v_mfma_f32_16x16x32_bf16 v[116:119], a[164:167], a[52:55], v[116:119]
    ds_read_b64_tr_b16 a[136:137], v20 offset:8192
    v_mfma_f32_16x16x32_bf16 v[148:151], a[164:167], a[56:59], v[148:151]
    ds_read_b64_tr_b16 a[138:139], v20 offset:8704
    v_mfma_f32_16x16x32_bf16 v[180:183], a[164:167], a[60:63], v[180:183]
    ds_read_b64_tr_b16 a[140:141], v21 offset:8192
    v_mfma_f32_16x16x32_bf16 v[88:91], a[168:171], a[48:51], v[88:91]
    ds_read_b64_tr_b16 a[142:143], v21 offset:8704
    buffer_load_dwordx4 v29, s[12:15], s44 offen offset:3072 lds
    v_mfma_f32_16x16x32_bf16 v[120:123], a[168:171], a[52:55], v[120:123]
    v_mfma_f32_16x16x32_bf16 v[152:155], a[168:171], a[56:59], v[152:155]
    v_mfma_f32_16x16x32_bf16 v[184:187], a[168:171], a[60:63], v[184:187]
    v_mfma_f32_16x16x32_bf16 v[92:95], a[172:175], a[48:51], v[92:95]
    s_add_u32 s44, s44, 524288
    v_mfma_f32_16x16x32_bf16 v[124:127], a[172:175], a[52:55], v[124:127]
    v_mfma_f32_16x16x32_bf16 v[156:159], a[172:175], a[56:59], v[156:159]
    v_mfma_f32_16x16x32_bf16 v[188:191], a[172:175], a[60:63], v[188:191]
    v_mfma_f32_16x16x32_bf16 v[192:195], a[176:179], a[48:51], v[192:195]
    s_add_u32 m0, s50, 24576
    s_nop 0
    v_mfma_f32_16x16x32_bf16 v[208:211], a[176:179], a[52:55], v[208:211]
    v_mfma_f32_16x16x32_bf16 v[224:227], a[176:179], a[56:59], v[224:227]
    v_mfma_f32_16x16x32_bf16 v[240:243], a[176:179], a[60:63], v[240:243]
    v_mfma_f32_16x16x32_bf16 v[196:199], a[180:183], a[48:51], v[196:199]
    buffer_load_dwordx4 v30, s[16:19], s45 offen offset:0 lds
    v_mfma_f32_16x16x32_bf16 v[212:215], a[180:183], a[52:55], v[212:215]
    v_mfma_f32_16x16x32_bf16 v[228:231], a[180:183], a[56:59], v[228:231]
    v_mfma_f32_16x16x32_bf16 v[244:247], a[180:183], a[60:63], v[244:247]
    v_mfma_f32_16x16x32_bf16 v[200:203], a[184:187], a[48:51], v[200:203]
    buffer_load_dwordx4 v31, s[16:19], s45 offen offset:1024 lds
    v_mfma_f32_16x16x32_bf16 v[216:219], a[184:187], a[52:55], v[216:219]
    v_mfma_f32_16x16x32_bf16 v[232:235], a[184:187], a[56:59], v[232:235]
    v_mfma_f32_16x16x32_bf16 v[248:251], a[184:187], a[60:63], v[248:251]
    v_mfma_f32_16x16x32_bf16 v[204:207], a[188:191], a[48:51], v[204:207]
    s_add_u32 s45, s45, 221184
    v_mfma_f32_16x16x32_bf16 v[220:223], a[188:191], a[52:55], v[220:223]
    v_mfma_f32_16x16x32_bf16 v[236:239], a[188:191], a[56:59], v[236:239]
    v_mfma_f32_16x16x32_bf16 v[252:255], a[188:191], a[60:63], v[252:255]
    s_waitcnt vmcnt(20)
    s_waitcnt lgkmcnt(0)
    v_mfma_f32_16x16x32_bf16 v[64:67], a[96:99], a[64:67], v[64:67]
    v_mfma_f32_16x16x32_bf16 v[96:99], a[96:99], a[68:71], v[96:99]
    ds_read_b64_tr_b16 a[144:145], v14 offset:24576
    v_mfma_f32_16x16x32_bf16 v[128:131], a[96:99], a[72:75], v[128:131]
    ds_read_b64_tr_b16 a[146:147], v14 offset:25600
    v_mfma_f32_16x16x32_bf16 v[160:163], a[96:99], a[76:79], v[160:163]
    ds_read_b64_tr_b16 a[148:149], v14 offset:24584
    v_mfma_f32_16x16x32_bf16 v[68:71], a[100:103], a[64:67], v[68:71]
    ds_read_b64_tr_b16 a[150:151], v14 offset:25608
    v_mfma_f32_16x16x32_bf16 v[100:103], a[100:103], a[68:71], v[100:103]
    ds_read_b64_tr_b16 a[152:153], v15 offset:24576
    v_mfma_f32_16x16x32_bf16 v[132:135], a[100:103], a[72:75], v[132:135]
    ds_read_b64_tr_b16 a[154:155], v15 offset:25600
    v_mfma_f32_16x16x32_bf16 v[164:167], a[100:103], a[76:79], v[164:167]
    ds_read_b64_tr_b16 a[156:157], v15 offset:24584
    v_mfma_f32_16x16x32_bf16 v[72:75], a[104:107], a[64:67], v[72:75]
    ds_read_b64_tr_b16 a[158:159], v15 offset:25608
    buffer_load_dwordx4 a[32:35], v32, s[20:23], s56 offen offset:2048 sc1
    v_mfma_f32_16x16x32_bf16 v[104:107], a[104:107], a[68:71], v[104:107]
    ds_read_b64_tr_b16 a[160:161], v16 offset:24576
    v_mfma_f32_16x16x32_bf16 v[136:139], a[104:107], a[72:75], v[136:139]
    ds_read_b64_tr_b16 a[162:163], v16 offset:25600
    v_mfma_f32_16x16x32_bf16 v[168:171], a[104:107], a[76:79], v[168:171]
    ds_read_b64_tr_b16 a[164:165], v16 offset:24584
    v_mfma_f32_16x16x32_bf16 v[76:79], a[108:111], a[64:67], v[76:79]
    ds_read_b64_tr_b16 a[166:167], v16 offset:25608
    buffer_load_dwordx4 a[36:39], v32, s[20:23], s57 offen offset:2048 sc1
    v_mfma_f32_16x16x32_bf16 v[108:111], a[108:111], a[68:71], v[108:111]
    ds_read_b64_tr_b16 a[168:169], v17 offset:24576
    v_mfma_f32_16x16x32_bf16 v[140:143], a[108:111], a[72:75], v[140:143]
    ds_read_b64_tr_b16 a[170:171], v17 offset:25600
    v_mfma_f32_16x16x32_bf16 v[172:175], a[108:111], a[76:79], v[172:175]
    ds_read_b64_tr_b16 a[172:173], v17 offset:24584
    v_mfma_f32_16x16x32_bf16 v[80:83], a[112:115], a[64:67], v[80:83]
    ds_read_b64_tr_b16 a[174:175], v17 offset:25608
    buffer_load_dwordx4 a[40:43], v32, s[20:23], s58 offen offset:2048 sc1
    v_mfma_f32_16x16x32_bf16 v[112:115], a[112:115], a[68:71], v[112:115]
    ds_read_b64_tr_b16 a[176:177], v18 offset:12288
    v_mfma_f32_16x16x32_bf16 v[144:147], a[112:115], a[72:75], v[144:147]
    ds_read_b64_tr_b16 a[178:179], v18 offset:12800
    v_mfma_f32_16x16x32_bf16 v[176:179], a[112:115], a[76:79], v[176:179]
    ds_read_b64_tr_b16 a[180:181], v19 offset:12288
    v_mfma_f32_16x16x32_bf16 v[84:87], a[116:119], a[64:67], v[84:87]
    ds_read_b64_tr_b16 a[182:183], v19 offset:12800
    v_mfma_f32_16x16x32_bf16 v[116:119], a[116:119], a[68:71], v[116:119]
    ds_read_b64_tr_b16 a[184:185], v20 offset:12288
    buffer_load_dwordx4 a[44:47], v32, s[20:23], s59 offen offset:2048 sc1
    v_mfma_f32_16x16x32_bf16 v[148:151], a[116:119], a[72:75], v[148:151]
    ds_read_b64_tr_b16 a[186:187], v20 offset:12800
    v_mfma_f32_16x16x32_bf16 v[180:183], a[116:119], a[76:79], v[180:183]
    ds_read_b64_tr_b16 a[188:189], v21 offset:12288
    v_mfma_f32_16x16x32_bf16 v[88:91], a[120:123], a[64:67], v[88:91]
    ds_read_b64_tr_b16 a[190:191], v21 offset:12800
    v_mfma_f32_16x16x32_bf16 v[120:123], a[120:123], a[68:71], v[120:123]
    buffer_load_dwordx4 a[48:51], v32, s[20:23], s56 offen offset:3072 sc1
    v_mfma_f32_16x16x32_bf16 v[152:155], a[120:123], a[72:75], v[152:155]
    v_mfma_f32_16x16x32_bf16 v[184:187], a[120:123], a[76:79], v[184:187]
    v_mfma_f32_16x16x32_bf16 v[92:95], a[124:127], a[64:67], v[92:95]
    v_mfma_f32_16x16x32_bf16 v[124:127], a[124:127], a[68:71], v[124:127]
    v_mfma_f32_16x16x32_bf16 v[156:159], a[124:127], a[72:75], v[156:159]
    buffer_load_dwordx4 a[52:55], v32, s[20:23], s57 offen offset:3072 sc1
    v_mfma_f32_16x16x32_bf16 v[188:191], a[124:127], a[76:79], v[188:191]
    v_mfma_f32_16x16x32_bf16 v[192:195], a[128:131], a[64:67], v[192:195]
    v_mfma_f32_16x16x32_bf16 v[208:211], a[128:131], a[68:71], v[208:211]
    v_mfma_f32_16x16x32_bf16 v[224:227], a[128:131], a[72:75], v[224:227]
    buffer_load_dwordx4 a[56:59], v32, s[20:23], s58 offen offset:3072 sc1
    v_mfma_f32_16x16x32_bf16 v[240:243], a[128:131], a[76:79], v[240:243]
    v_mfma_f32_16x16x32_bf16 v[196:199], a[132:135], a[64:67], v[196:199]
    v_mfma_f32_16x16x32_bf16 v[212:215], a[132:135], a[68:71], v[212:215]
    v_mfma_f32_16x16x32_bf16 v[228:231], a[132:135], a[72:75], v[228:231]
    v_mfma_f32_16x16x32_bf16 v[244:247], a[132:135], a[76:79], v[244:247]
    buffer_load_dwordx4 a[60:63], v32, s[20:23], s59 offen offset:3072 sc1
    v_mfma_f32_16x16x32_bf16 v[200:203], a[136:139], a[64:67], v[200:203]
    v_mfma_f32_16x16x32_bf16 v[216:219], a[136:139], a[68:71], v[216:219]
    v_mfma_f32_16x16x32_bf16 v[232:235], a[136:139], a[72:75], v[232:235]
    v_mfma_f32_16x16x32_bf16 v[248:251], a[136:139], a[76:79], v[248:251]
    s_add_u32 s56, s56, 4096
    s_add_u32 s57, s57, 4096
    s_add_u32 s58, s58, 4096
    s_add_u32 s59, s59, 4096
    v_mfma_f32_16x16x32_bf16 v[204:207], a[140:143], a[64:67], v[204:207]
    v_mfma_f32_16x16x32_bf16 v[220:223], a[140:143], a[68:71], v[220:223]
    v_mfma_f32_16x16x32_bf16 v[236:239], a[140:143], a[72:75], v[236:239]
    v_mfma_f32_16x16x32_bf16 v[252:255], a[140:143], a[76:79], v[252:255]
    s_waitcnt lgkmcnt(0)
    v_mfma_f32_16x16x32_bf16 v[64:67], a[144:147], a[80:83], v[64:67]
    s_waitcnt vmcnt(22)
    s_barrier
    v_mfma_f32_16x16x32_bf16 v[96:99], a[144:147], a[84:87], v[96:99]
    ds_read_b64_tr_b16 a[96:97], v14 offset:32768
    v_mfma_f32_16x16x32_bf16 v[128:131], a[144:147], a[88:91], v[128:131]
    ds_read_b64_tr_b16 a[98:99], v14 offset:33792
    v_mfma_f32_16x16x32_bf16 v[160:163], a[144:147], a[92:95], v[160:163]
    ds_read_b64_tr_b16 a[100:101], v14 offset:32776
    v_mfma_f32_16x16x32_bf16 v[68:71], a[148:151], a[80:83], v[68:71]
    ds_read_b64_tr_b16 a[102:103], v14 offset:33800
    v_mfma_f32_16x16x32_bf16 v[100:103], a[148:151], a[84:87], v[100:103]
    ds_read_b64_tr_b16 a[104:105], v15 offset:32768
    v_mfma_f32_16x16x32_bf16 v[132:135], a[148:151], a[88:91], v[132:135]
    ds_read_b64_tr_b16 a[106:107], v15 offset:33792
    v_mfma_f32_16x16x32_bf16 v[164:167], a[148:151], a[92:95], v[164:167]
    ds_read_b64_tr_b16 a[108:109], v15 offset:32776
    v_mfma_f32_16x16x32_bf16 v[72:75], a[152:155], a[80:83], v[72:75]
    ds_read_b64_tr_b16 a[110:111], v15 offset:33800
    s_add_u32 m0, s51, 0
    s_nop 0
    v_mfma_f32_16x16x32_bf16 v[104:107], a[152:155], a[84:87], v[104:107]
    ds_read_b64_tr_b16 a[112:113], v16 offset:32768
    v_mfma_f32_16x16x32_bf16 v[136:139], a[152:155], a[88:91], v[136:139]
    ds_read_b64_tr_b16 a[114:115], v16 offset:33792
    v_mfma_f32_16x16x32_bf16 v[168:171], a[152:155], a[92:95], v[168:171]
    ds_read_b64_tr_b16 a[116:117], v16 offset:32776
    v_mfma_f32_16x16x32_bf16 v[76:79], a[156:159], a[80:83], v[76:79]
    ds_read_b64_tr_b16 a[118:119], v16 offset:33800
    buffer_load_dwordx4 v26, s[12:15], s44 offen offset:0 lds
    v_mfma_f32_16x16x32_bf16 v[108:111], a[156:159], a[84:87], v[108:111]
    ds_read_b64_tr_b16 a[120:121], v17 offset:32768
    v_mfma_f32_16x16x32_bf16 v[140:143], a[156:159], a[88:91], v[140:143]
    ds_read_b64_tr_b16 a[122:123], v17 offset:33792
    v_mfma_f32_16x16x32_bf16 v[172:175], a[156:159], a[92:95], v[172:175]
    ds_read_b64_tr_b16 a[124:125], v17 offset:32776
    v_mfma_f32_16x16x32_bf16 v[80:83], a[160:163], a[80:83], v[80:83]
    ds_read_b64_tr_b16 a[126:127], v17 offset:33800
    buffer_load_dwordx4 v27, s[12:15], s44 offen offset:1024 lds
    v_mfma_f32_16x16x32_bf16 v[112:115], a[160:163], a[84:87], v[112:115]
    ds_read_b64_tr_b16 a[128:129], v18 offset:16384
    v_mfma_f32_16x16x32_bf16 v[144:147], a[160:163], a[88:91], v[144:147]
    ds_read_b64_tr_b16 a[130:131], v18 offset:16896
    v_mfma_f32_16x16x32_bf16 v[176:179], a[160:163], a[92:95], v[176:179]
    ds_read_b64_tr_b16 a[132:133], v19 offset:16384
    v_mfma_f32_16x16x32_bf16 v[84:87], a[164:167], a[80:83], v[84:87]
    ds_read_b64_tr_b16 a[134:135], v19 offset:16896
    buffer_load_dwordx4 v28, s[12:15], s44 offen offset:2048 lds
    v_mfma_f32_16x16x32_bf16 v[116:119], a[164:167], a[84:87], v[116:119]
    ds_read_b64_tr_b16 a[136:137], v20 offset:16384
    v_mfma_f32_16x16x32_bf16 v[148:151], a[164:167], a[88:91], v[148:151]
    ds_read_b64_tr_b16 a[138:139], v20 offset:16896
    v_mfma_f32_16x16x32_bf16 v[180:183], a[164:167], a[92:95], v[180:183]
    ds_read_b64_tr_b16 a[140:141], v21 offset:16384
    v_mfma_f32_16x16x32_bf16 v[88:91], a[168:171], a[80:83], v[88:91]
    ds_read_b64_tr_b16 a[142:143], v21 offset:16896
    buffer_load_dwordx4 v29, s[12:15], s44 offen offset:3072 lds
    v_mfma_f32_16x16x32_bf16 v[120:123], a[168:171], a[84:87], v[120:123]
    v_mfma_f32_16x16x32_bf16 v[152:155], a[168:171], a[88:91], v[152:155]
    v_mfma_f32_16x16x32_bf16 v[184:187], a[168:171], a[92:95], v[184:187]
    v_mfma_f32_16x16x32_bf16 v[92:95], a[172:175], a[80:83], v[92:95]
    s_add_u32 s44, s44, 524288
    v_mfma_f32_16x16x32_bf16 v[124:127], a[172:175], a[84:87], v[124:127]
    v_mfma_f32_16x16x32_bf16 v[156:159], a[172:175], a[88:91], v[156:159]
    v_mfma_f32_16x16x32_bf16 v[188:191], a[172:175], a[92:95], v[188:191]
    v_mfma_f32_16x16x32_bf16 v[192:195], a[176:179], a[80:83], v[192:195]
    s_add_u32 m0, s50, 0
    s_nop 0
    v_mfma_f32_16x16x32_bf16 v[208:211], a[176:179], a[84:87], v[208:211]
    v_mfma_f32_16x16x32_bf16 v[224:227], a[176:179], a[88:91], v[224:227]
    v_mfma_f32_16x16x32_bf16 v[240:243], a[176:179], a[92:95], v[240:243]
    v_mfma_f32_16x16x32_bf16 v[196:199], a[180:183], a[80:83], v[196:199]
    buffer_load_dwordx4 v30, s[16:19], s45 offen offset:0 lds
    v_mfma_f32_16x16x32_bf16 v[212:215], a[180:183], a[84:87], v[212:215]
    v_mfma_f32_16x16x32_bf16 v[228:231], a[180:183], a[88:91], v[228:231]
    v_mfma_f32_16x16x32_bf16 v[244:247], a[180:183], a[92:95], v[244:247]
    v_mfma_f32_16x16x32_bf16 v[200:203], a[184:187], a[80:83], v[200:203]
    buffer_load_dwordx4 v31, s[16:19], s45 offen offset:1024 lds
    v_mfma_f32_16x16x32_bf16 v[216:219], a[184:187], a[84:87], v[216:219]
    v_mfma_f32_16x16x32_bf16 v[232:235], a[184:187], a[88:91], v[232:235]
    v_mfma_f32_16x16x32_bf16 v[248:251], a[184:187], a[92:95], v[248:251]
    v_mfma_f32_16x16x32_bf16 v[204:207], a[188:191], a[80:83], v[204:207]
    s_add_u32 s45, s45, 221184
    v_mfma_f32_16x16x32_bf16 v[220:223], a[188:191], a[84:87], v[220:223]
    v_mfma_f32_16x16x32_bf16 v[236:239], a[188:191], a[88:91], v[236:239]
    v_mfma_f32_16x16x32_bf16 v[252:255], a[188:191], a[92:95], v[252:255]
    s_waitcnt vmcnt(20)
    s_waitcnt lgkmcnt(0)
    v_mfma_f32_16x16x32_bf16 v[64:67], a[96:99], a[0:3], v[64:67]
    v_mfma_f32_16x16x32_bf16 v[96:99], a[96:99], a[4:7], v[96:99]
    ds_read_b64_tr_b16 a[144:145], v14 offset:40960
    v_mfma_f32_16x16x32_bf16 v[128:131], a[96:99], a[8:11], v[128:131]
    ds_read_b64_tr_b16 a[146:147], v14 offset:41984
    v_mfma_f32_16x16x32_bf16 v[160:163], a[96:99], a[12:15], v[160:163]
    ds_read_b64_tr_b16 a[148:149], v14 offset:40968
    v_mfma_f32_16x16x32_bf16 v[68:71], a[100:103], a[0:3], v[68:71]
    ds_read_b64_tr_b16 a[150:151], v14 offset:41992
    v_mfma_f32_16x16x32_bf16 v[100:103], a[100:103], a[4:7], v[100:103]
    ds_read_b64_tr_b16 a[152:153], v15 offset:40960
    v_mfma_f32_16x16x32_bf16 v[132:135], a[100:103], a[8:11], v[132:135]
    ds_read_b64_tr_b16 a[154:155], v15 offset:41984
    v_mfma_f32_16x16x32_bf16 v[164:167], a[100:103], a[12:15], v[164:167]
    ds_read_b64_tr_b16 a[156:157], v15 offset:40968
    v_mfma_f32_16x16x32_bf16 v[72:75], a[104:107], a[0:3], v[72:75]
    ds_read_b64_tr_b16 a[158:159], v15 offset:41992
    buffer_load_dwordx4 a[64:67], v32, s[20:23], s56 offen offset:0 sc1
    v_mfma_f32_16x16x32_bf16 v[104:107], a[104:107], a[4:7], v[104:107]
    ds_read_b64_tr_b16 a[160:161], v16 offset:40960
    v_mfma_f32_16x16x32_bf16 v[136:139], a[104:107], a[8:11], v[136:139]
    ds_read_b64_tr_b16 a[162:163], v16 offset:41984
    v_mfma_f32_16x16x32_bf16 v[168:171], a[104:107], a[12:15], v[168:171]
    ds_read_b64_tr_b16 a[164:165], v16 offset:40968
    v_mfma_f32_16x16x32_bf16 v[76:79], a[108:111], a[0:3], v[76:79]
    ds_read_b64_tr_b16 a[166:167], v16 offset:41992
    v_mfma_f32_16x16x32_bf16 v[108:111], a[108:111], a[4:7], v[108:111]
    ds_read_b64_tr_b16 a[168:169], v17 offset:40960
    buffer_load_dwordx4 a[68:71], v32, s[20:23], s57 offen offset:0 sc1
    v_mfma_f32_16x16x32_bf16 v[140:143], a[108:111], a[8:11], v[140:143]
    ds_read_b64_tr_b16 a[170:171], v17 offset:41984
    v_mfma_f32_16x16x32_bf16 v[172:175], a[108:111], a[12:15], v[172:175]
    ds_read_b64_tr_b16 a[172:173], v17 offset:40968
    v_mfma_f32_16x16x32_bf16 v[80:83], a[112:115], a[0:3], v[80:83]
    ds_read_b64_tr_b16 a[174:175], v17 offset:41992
    v_mfma_f32_16x16x32_bf16 v[112:115], a[112:115], a[4:7], v[112:115]
    ds_read_b64_tr_b16 a[176:177], v18 offset:20480
    v_mfma_f32_16x16x32_bf16 v[144:147], a[112:115], a[8:11], v[144:147]
    ds_read_b64_tr_b16 a[178:179], v18 offset:20992
    buffer_load_dwordx4 a[72:75], v32, s[20:23], s58 offen offset:0 sc1
    v_mfma_f32_16x16x32_bf16 v[176:179], a[112:115], a[12:15], v[176:179]
    ds_read_b64_tr_b16 a[180:181], v19 offset:20480
    v_mfma_f32_16x16x32_bf16 v[84:87], a[116:119], a[0:3], v[84:87]
    ds_read_b64_tr_b16 a[182:183], v19 offset:20992
    v_mfma_f32_16x16x32_bf16 v[116:119], a[116:119], a[4:7], v[116:119]
    ds_read_b64_tr_b16 a[184:185], v20 offset:20480
    v_mfma_f32_16x16x32_bf16 v[148:151], a[116:119], a[8:11], v[148:151]
    ds_read_b64_tr_b16 a[186:187], v20 offset:20992
    v_mfma_f32_16x16x32_bf16 v[180:183], a[116:119], a[12:15], v[180:183]
    ds_read_b64_tr_b16 a[188:189], v21 offset:20480
    buffer_load_dwordx4 a[76:79], v32, s[20:23], s59 offen offset:0 sc1
    v_mfma_f32_16x16x32_bf16 v[88:91], a[120:123], a[0:3], v[88:91]
    ds_read_b64_tr_b16 a[190:191], v21 offset:20992
    v_mfma_f32_16x16x32_bf16 v[120:123], a[120:123], a[4:7], v[120:123]
    v_mfma_f32_16x16x32_bf16 v[152:155], a[120:123], a[8:11], v[152:155]
    v_mfma_f32_16x16x32_bf16 v[184:187], a[120:123], a[12:15], v[184:187]
    v_mfma_f32_16x16x32_bf16 v[92:95], a[124:127], a[0:3], v[92:95]
    buffer_load_dwordx4 a[80:83], v32, s[20:23], s56 offen offset:1024 sc1
    v_mfma_f32_16x16x32_bf16 v[124:127], a[124:127], a[4:7], v[124:127]
    v_mfma_f32_16x16x32_bf16 v[156:159], a[124:127], a[8:11], v[156:159]
    v_mfma_f32_16x16x32_bf16 v[188:191], a[124:127], a[12:15], v[188:191]
    v_mfma_f32_16x16x32_bf16 v[192:195], a[128:131], a[0:3], v[192:195]
    v_mfma_f32_16x16x32_bf16 v[208:211], a[128:131], a[4:7], v[208:211]
    buffer_load_dwordx4 a[84:87], v32, s[20:23], s57 offen offset:1024 sc1
    v_mfma_f32_16x16x32_bf16 v[224:227], a[128:131], a[8:11], v[224:227]
    v_mfma_f32_16x16x32_bf16 v[240:243], a[128:131], a[12:15], v[240:243]
    v_mfma_f32_16x16x32_bf16 v[196:199], a[132:135], a[0:3], v[196:199]
    v_mfma_f32_16x16x32_bf16 v[212:215], a[132:135], a[4:7], v[212:215]
    v_mfma_f32_16x16x32_bf16 v[228:231], a[132:135], a[8:11], v[228:231]
    buffer_load_dwordx4 a[88:91], v32, s[20:23], s58 offen offset:1024 sc1
    v_mfma_f32_16x16x32_bf16 v[244:247], a[132:135], a[12:15], v[244:247]
    v_mfma_f32_16x16x32_bf16 v[200:203], a[136:139], a[0:3], v[200:203]
    v_mfma_f32_16x16x32_bf16 v[216:219], a[136:139], a[4:7], v[216:219]
    v_mfma_f32_16x16x32_bf16 v[232:235], a[136:139], a[8:11], v[232:235]
    v_mfma_f32_16x16x32_bf16 v[248:251], a[136:139], a[12:15], v[248:251]
    buffer_load_dwordx4 a[92:95], v32, s[20:23], s59 offen offset:1024 sc1
    v_mfma_f32_16x16x32_bf16 v[204:207], a[140:143], a[0:3], v[204:207]
    v_mfma_f32_16x16x32_bf16 v[220:223], a[140:143], a[4:7], v[220:223]
    v_mfma_f32_16x16x32_bf16 v[236:239], a[140:143], a[8:11], v[236:239]
    v_mfma_f32_16x16x32_bf16 v[252:255], a[140:143], a[12:15], v[252:255]
    s_waitcnt lgkmcnt(0)
    v_mfma_f32_16x16x32_bf16 v[64:67], a[144:147], a[16:19], v[64:67]
    s_waitcnt vmcnt(22)
    s_barrier
    v_mfma_f32_16x16x32_bf16 v[96:99], a[144:147], a[20:23], v[96:99]
    ds_read_b64_tr_b16 a[96:97], v14 offset:49152
    v_mfma_f32_16x16x32_bf16 v[128:131], a[144:147], a[24:27], v[128:131]
    ds_read_b64_tr_b16 a[98:99], v14 offset:50176
    v_mfma_f32_16x16x32_bf16 v[160:163], a[144:147], a[28:31], v[160:163]
    ds_read_b64_tr_b16 a[100:101], v14 offset:49160
    v_mfma_f32_16x16x32_bf16 v[68:71], a[148:151], a[16:19], v[68:71]
    ds_read_b64_tr_b16 a[102:103], v14 offset:50184
    v_mfma_f32_16x16x32_bf16 v[100:103], a[148:151], a[20:23], v[100:103]
    ds_read_b64_tr_b16 a[104:105], v15 offset:49152
    v_mfma_f32_16x16x32_bf16 v[132:135], a[148:151], a[24:27], v[132:135]
    ds_read_b64_tr_b16 a[106:107], v15 offset:50176
    v_mfma_f32_16x16x32_bf16 v[164:167], a[148:151], a[28:31], v[164:167]
    ds_read_b64_tr_b16 a[108:109], v15 offset:49160
    v_mfma_f32_16x16x32_bf16 v[72:75], a[152:155], a[16:19], v[72:75]
    ds_read_b64_tr_b16 a[110:111], v15 offset:50184
    s_add_u32 m0, s51, 16384
    s_nop 0
    v_mfma_f32_16x16x32_bf16 v[104:107], a[152:155], a[20:23], v[104:107]
    ds_read_b64_tr_b16 a[112:113], v16 offset:49152
    v_mfma_f32_16x16x32_bf16 v[136:139], a[152:155], a[24:27], v[136:139]
    ds_read_b64_tr_b16 a[114:115], v16 offset:50176
    v_mfma_f32_16x16x32_bf16 v[168:171], a[152:155], a[28:31], v[168:171]
    ds_read_b64_tr_b16 a[116:117], v16 offset:49160
    v_mfma_f32_16x16x32_bf16 v[76:79], a[156:159], a[16:19], v[76:79]
    ds_read_b64_tr_b16 a[118:119], v16 offset:50184
    buffer_load_dwordx4 v26, s[12:15], s44 offen offset:0 lds
    v_mfma_f32_16x16x32_bf16 v[108:111], a[156:159], a[20:23], v[108:111]
    ds_read_b64_tr_b16 a[120:121], v17 offset:49152
    v_mfma_f32_16x16x32_bf16 v[140:143], a[156:159], a[24:27], v[140:143]
    ds_read_b64_tr_b16 a[122:123], v17 offset:50176
    v_mfma_f32_16x16x32_bf16 v[172:175], a[156:159], a[28:31], v[172:175]
    ds_read_b64_tr_b16 a[124:125], v17 offset:49160
    v_mfma_f32_16x16x32_bf16 v[80:83], a[160:163], a[16:19], v[80:83]
    ds_read_b64_tr_b16 a[126:127], v17 offset:50184
    buffer_load_dwordx4 v27, s[12:15], s44 offen offset:1024 lds
    v_mfma_f32_16x16x32_bf16 v[112:115], a[160:163], a[20:23], v[112:115]
    ds_read_b64_tr_b16 a[128:129], v18 offset:24576
    v_mfma_f32_16x16x32_bf16 v[144:147], a[160:163], a[24:27], v[144:147]
    ds_read_b64_tr_b16 a[130:131], v18 offset:25088
    v_mfma_f32_16x16x32_bf16 v[176:179], a[160:163], a[28:31], v[176:179]
    ds_read_b64_tr_b16 a[132:133], v19 offset:24576
    v_mfma_f32_16x16x32_bf16 v[84:87], a[164:167], a[16:19], v[84:87]
    ds_read_b64_tr_b16 a[134:135], v19 offset:25088
    buffer_load_dwordx4 v28, s[12:15], s44 offen offset:2048 lds
    v_mfma_f32_16x16x32_bf16 v[116:119], a[164:167], a[20:23], v[116:119]
    ds_read_b64_tr_b16 a[136:137], v20 offset:24576
    v_mfma_f32_16x16x32_bf16 v[148:151], a[164:167], a[24:27], v[148:151]
    ds_read_b64_tr_b16 a[138:139], v20 offset:25088
    v_mfma_f32_16x16x32_bf16 v[180:183], a[164:167], a[28:31], v[180:183]
    ds_read_b64_tr_b16 a[140:141], v21 offset:24576
    v_mfma_f32_16x16x32_bf16 v[88:91], a[168:171], a[16:19], v[88:91]
    ds_read_b64_tr_b16 a[142:143], v21 offset:25088
    buffer_load_dwordx4 v29, s[12:15], s44 offen offset:3072 lds
    v_mfma_f32_16x16x32_bf16 v[120:123], a[168:171], a[20:23], v[120:123]
    v_mfma_f32_16x16x32_bf16 v[152:155], a[168:171], a[24:27], v[152:155]
    v_mfma_f32_16x16x32_bf16 v[184:187], a[168:171], a[28:31], v[184:187]
    v_mfma_f32_16x16x32_bf16 v[92:95], a[172:175], a[16:19], v[92:95]
    s_add_u32 s44, s44, 524288
    v_mfma_f32_16x16x32_bf16 v[124:127], a[172:175], a[20:23], v[124:127]
    v_mfma_f32_16x16x32_bf16 v[156:159], a[172:175], a[24:27], v[156:159]
    v_mfma_f32_16x16x32_bf16 v[188:191], a[172:175], a[28:31], v[188:191]
    v_mfma_f32_16x16x32_bf16 v[192:195], a[176:179], a[16:19], v[192:195]
    s_add_u32 m0, s50, 8192
    s_nop 0
    v_mfma_f32_16x16x32_bf16 v[208:211], a[176:179], a[20:23], v[208:211]
    v_mfma_f32_16x16x32_bf16 v[224:227], a[176:179], a[24:27], v[224:227]
    v_mfma_f32_16x16x32_bf16 v[240:243], a[176:179], a[28:31], v[240:243]
    v_mfma_f32_16x16x32_bf16 v[196:199], a[180:183], a[16:19], v[196:199]
    buffer_load_dwordx4 v30, s[16:19], s45 offen offset:0 lds
    v_mfma_f32_16x16x32_bf16 v[212:215], a[180:183], a[20:23], v[212:215]
    v_mfma_f32_16x16x32_bf16 v[228:231], a[180:183], a[24:27], v[228:231]
    v_mfma_f32_16x16x32_bf16 v[244:247], a[180:183], a[28:31], v[244:247]
    v_mfma_f32_16x16x32_bf16 v[200:203], a[184:187], a[16:19], v[200:203]
    buffer_load_dwordx4 v31, s[16:19], s45 offen offset:1024 lds
    v_mfma_f32_16x16x32_bf16 v[216:219], a[184:187], a[20:23], v[216:219]
    v_mfma_f32_16x16x32_bf16 v[232:235], a[184:187], a[24:27], v[232:235]
    v_mfma_f32_16x16x32_bf16 v[248:251], a[184:187], a[28:31], v[248:251]
    v_mfma_f32_16x16x32_bf16 v[204:207], a[188:191], a[16:19], v[204:207]
    s_add_u32 s45, s45, 221184
    v_mfma_f32_16x16x32_bf16 v[220:223], a[188:191], a[20:23], v[220:223]
    v_mfma_f32_16x16x32_bf16 v[236:239], a[188:191], a[24:27], v[236:239]
    v_mfma_f32_16x16x32_bf16 v[252:255], a[188:191], a[28:31], v[252:255]
    s_waitcnt vmcnt(20)
    s_waitcnt lgkmcnt(0)
    v_mfma_f32_16x16x32_bf16 v[64:67], a[96:99], a[32:35], v[64:67]
    v_mfma_f32_16x16x32_bf16 v[96:99], a[96:99], a[36:39], v[96:99]
    ds_read_b64_tr_b16 a[144:145], v14 offset:57344
    v_mfma_f32_16x16x32_bf16 v[128:131], a[96:99], a[40:43], v[128:131]
    ds_read_b64_tr_b16 a[146:147], v14 offset:58368
    v_mfma_f32_16x16x32_bf16 v[160:163], a[96:99], a[44:47], v[160:163]
    ds_read_b64_tr_b16 a[148:149], v14 offset:57352
    v_mfma_f32_16x16x32_bf16 v[68:71], a[100:103], a[32:35], v[68:71]
    ds_read_b64_tr_b16 a[150:151], v14 offset:58376
    v_mfma_f32_16x16x32_bf16 v[100:103], a[100:103], a[36:39], v[100:103]
    ds_read_b64_tr_b16 a[152:153], v15 offset:57344
    v_mfma_f32_16x16x32_bf16 v[132:135], a[100:103], a[40:43], v[132:135]
    ds_read_b64_tr_b16 a[154:155], v15 offset:58368
    v_mfma_f32_16x16x32_bf16 v[164:167], a[100:103], a[44:47], v[164:167]
    ds_read_b64_tr_b16 a[156:157], v15 offset:57352
    v_mfma_f32_16x16x32_bf16 v[72:75], a[104:107], a[32:35], v[72:75]
    ds_read_b64_tr_b16 a[158:159], v15 offset:58376
    buffer_load_dwordx4 a[0:3], v32, s[20:23], s56 offen offset:2048 sc1
    v_mfma_f32_16x16x32_bf16 v[104:107], a[104:107], a[36:39], v[104:107]
    ds_read_b64_tr_b16 a[160:161], v16 offset:57344
    v_mfma_f32_16x16x32_bf16 v[136:139], a[104:107], a[40:43], v[136:139]
    ds_read_b64_tr_b16 a[162:163], v16 offset:58368
    v_mfma_f32_16x16x32_bf16 v[168:171], a[104:107], a[44:47], v[168:171]
    ds_read_b64_tr_b16 a[164:165], v16 offset:57352
    v_mfma_f32_16x16x32_bf16 v[76:79], a[108:111], a[32:35], v[76:79]
    ds_read_b64_tr_b16 a[166:167], v16 offset:58376
    buffer_load_dwordx4 a[4:7], v32, s[20:23], s57 offen offset:2048 sc1
    v_mfma_f32_16x16x32_bf16 v[108:111], a[108:111], a[36:39], v[108:111]
    ds_read_b64_tr_b16 a[168:169], v17 offset:57344
    v_mfma_f32_16x16x32_bf16 v[140:143], a[108:111], a[40:43], v[140:143]
    ds_read_b64_tr_b16 a[170:171], v17 offset:58368
    v_mfma_f32_16x16x32_bf16 v[172:175], a[108:111], a[44:47], v[172:175]
    ds_read_b64_tr_b16 a[172:173], v17 offset:57352
    v_mfma_f32_16x16x32_bf16 v[80:83], a[112:115], a[32:35], v[80:83]
    ds_read_b64_tr_b16 a[174:175], v17 offset:58376
    buffer_load_dwordx4 a[8:11], v32, s[20:23], s58 offen offset:2048 sc1
    v_mfma_f32_16x16x32_bf16 v[112:115], a[112:115], a[36:39], v[112:115]
    ds_read_b64_tr_b16 a[176:177], v18 offset:28672
    v_mfma_f32_16x16x32_bf16 v[144:147], a[112:115], a[40:43], v[144:147]
    ds_read_b64_tr_b16 a[178:179], v18 offset:29184
    v_mfma_f32_16x16x32_bf16 v[176:179], a[112:115], a[44:47], v[176:179]
    ds_read_b64_tr_b16 a[180:181], v19 offset:28672
    v_mfma_f32_16x16x32_bf16 v[84:87], a[116:119], a[32:35], v[84:87]
    ds_read_b64_tr_b16 a[182:183], v19 offset:29184
    v_mfma_f32_16x16x32_bf16 v[116:119], a[116:119], a[36:39], v[116:119]
    ds_read_b64_tr_b16 a[184:185], v20 offset:28672
    buffer_load_dwordx4 a[12:15], v32, s[20:23], s59 offen offset:2048 sc1
    v_mfma_f32_16x16x32_bf16 v[148:151], a[116:119], a[40:43], v[148:151]
    ds_read_b64_tr_b16 a[186:187], v20 offset:29184
    v_mfma_f32_16x16x32_bf16 v[180:183], a[116:119], a[44:47], v[180:183]
    ds_read_b64_tr_b16 a[188:189], v21 offset:28672
    v_mfma_f32_16x16x32_bf16 v[88:91], a[120:123], a[32:35], v[88:91]
    ds_read_b64_tr_b16 a[190:191], v21 offset:29184
    v_mfma_f32_16x16x32_bf16 v[120:123], a[120:123], a[36:39], v[120:123]
    buffer_load_dwordx4 a[16:19], v32, s[20:23], s56 offen offset:3072 sc1
    v_mfma_f32_16x16x32_bf16 v[152:155], a[120:123], a[40:43], v[152:155]
    v_mfma_f32_16x16x32_bf16 v[184:187], a[120:123], a[44:47], v[184:187]
    v_mfma_f32_16x16x32_bf16 v[92:95], a[124:127], a[32:35], v[92:95]
    v_mfma_f32_16x16x32_bf16 v[124:127], a[124:127], a[36:39], v[124:127]
    v_mfma_f32_16x16x32_bf16 v[156:159], a[124:127], a[40:43], v[156:159]
    buffer_load_dwordx4 a[20:23], v32, s[20:23], s57 offen offset:3072 sc1
    v_mfma_f32_16x16x32_bf16 v[188:191], a[124:127], a[44:47], v[188:191]
    v_mfma_f32_16x16x32_bf16 v[192:195], a[128:131], a[32:35], v[192:195]
    v_mfma_f32_16x16x32_bf16 v[208:211], a[128:131], a[36:39], v[208:211]
    v_mfma_f32_16x16x32_bf16 v[224:227], a[128:131], a[40:43], v[224:227]
    buffer_load_dwordx4 a[24:27], v32, s[20:23], s58 offen offset:3072 sc1
    v_mfma_f32_16x16x32_bf16 v[240:243], a[128:131], a[44:47], v[240:243]
    v_mfma_f32_16x16x32_bf16 v[196:199], a[132:135], a[32:35], v[196:199]
    v_mfma_f32_16x16x32_bf16 v[212:215], a[132:135], a[36:39], v[212:215]
    v_mfma_f32_16x16x32_bf16 v[228:231], a[132:135], a[40:43], v[228:231]
    v_mfma_f32_16x16x32_bf16 v[244:247], a[132:135], a[44:47], v[244:247]
    buffer_load_dwordx4 a[28:31], v32, s[20:23], s59 offen offset:3072 sc1
    v_mfma_f32_16x16x32_bf16 v[200:203], a[136:139], a[32:35], v[200:203]
    v_mfma_f32_16x16x32_bf16 v[216:219], a[136:139], a[36:39], v[216:219]
    v_mfma_f32_16x16x32_bf16 v[232:235], a[136:139], a[40:43], v[232:235]
    v_mfma_f32_16x16x32_bf16 v[248:251], a[136:139], a[44:47], v[248:251]
    s_add_u32 s56, s56, 4096
    s_add_u32 s57, s57, 4096
    s_add_u32 s58, s58, 4096
    s_add_u32 s59, s59, 4096
    v_mfma_f32_16x16x32_bf16 v[204:207], a[140:143], a[32:35], v[204:207]
    v_mfma_f32_16x16x32_bf16 v[220:223], a[140:143], a[36:39], v[220:223]
    v_mfma_f32_16x16x32_bf16 v[236:239], a[140:143], a[40:43], v[236:239]
    v_mfma_f32_16x16x32_bf16 v[252:255], a[140:143], a[44:47], v[252:255]
    s_waitcnt lgkmcnt(0)
    v_mfma_f32_16x16x32_bf16 v[64:67], a[144:147], a[48:51], v[64:67]
    s_waitcnt vmcnt(22)
    s_barrier
    v_mfma_f32_16x16x32_bf16 v[96:99], a[144:147], a[52:55], v[96:99]
    ds_read_b64_tr_b16 a[96:97], v14 offset:0
    v_mfma_f32_16x16x32_bf16 v[128:131], a[144:147], a[56:59], v[128:131]
    ds_read_b64_tr_b16 a[98:99], v14 offset:1024
    v_mfma_f32_16x16x32_bf16 v[160:163], a[144:147], a[60:63], v[160:163]
    ds_read_b64_tr_b16 a[100:101], v14 offset:8
    v_mfma_f32_16x16x32_bf16 v[68:71], a[148:151], a[48:51], v[68:71]
    ds_read_b64_tr_b16 a[102:103], v14 offset:1032
    v_mfma_f32_16x16x32_bf16 v[100:103], a[148:151], a[52:55], v[100:103]
    ds_read_b64_tr_b16 a[104:105], v15 offset:0
    v_mfma_f32_16x16x32_bf16 v[132:135], a[148:151], a[56:59], v[132:135]
    ds_read_b64_tr_b16 a[106:107], v15 offset:1024
    v_mfma_f32_16x16x32_bf16 v[164:167], a[148:151], a[60:63], v[164:167]
    ds_read_b64_tr_b16 a[108:109], v15 offset:8
    v_mfma_f32_16x16x32_bf16 v[72:75], a[152:155], a[48:51], v[72:75]
    ds_read_b64_tr_b16 a[110:111], v15 offset:1032
    s_add_u32 m0, s43, 0
    s_nop 0
    v_mfma_f32_16x16x32_bf16 v[104:107], a[152:155], a[52:55], v[104:107]
    ds_read_b64_tr_b16 a[112:113], v16 offset:0
    v_mfma_f32_16x16x32_bf16 v[136:139], a[152:155], a[56:59], v[136:139]
    ds_read_b64_tr_b16 a[114:115], v16 offset:1024
    v_mfma_f32_16x16x32_bf16 v[168:171], a[152:155], a[60:63], v[168:171]
    ds_read_b64_tr_b16 a[116:117], v16 offset:8
    v_mfma_f32_16x16x32_bf16 v[76:79], a[156:159], a[48:51], v[76:79]
    ds_read_b64_tr_b16 a[118:119], v16 offset:1032
    v_mfma_f32_16x16x32_bf16 v[108:111], a[156:159], a[52:55], v[108:111]
    ds_read_b64_tr_b16 a[120:121], v17 offset:0
    v_mfma_f32_16x16x32_bf16 v[140:143], a[156:159], a[56:59], v[140:143]
    ds_read_b64_tr_b16 a[122:123], v17 offset:1024
    buffer_load_dwordx4 v22, s[4:7], s46 offen offset:0 lds
    v_mfma_f32_16x16x32_bf16 v[172:175], a[156:159], a[60:63], v[172:175]
    ds_read_b64_tr_b16 a[124:125], v17 offset:8
    v_mfma_f32_16x16x32_bf16 v[80:83], a[160:163], a[48:51], v[80:83]
    ds_read_b64_tr_b16 a[126:127], v17 offset:1032
    v_mfma_f32_16x16x32_bf16 v[112:115], a[160:163], a[52:55], v[112:115]
    ds_read_b64_tr_b16 a[128:129], v18 offset:0
    v_mfma_f32_16x16x32_bf16 v[144:147], a[160:163], a[56:59], v[144:147]
    ds_read_b64_tr_b16 a[130:131], v18 offset:512
    v_mfma_f32_16x16x32_bf16 v[176:179], a[160:163], a[60:63], v[176:179]
    ds_read_b64_tr_b16 a[132:133], v19 offset:0
    v_mfma_f32_16x16x32_bf16 v[84:87], a[164:167], a[48:51], v[84:87]
    ds_read_b64_tr_b16 a[134:135], v19 offset:512
    v_mfma_f32_16x16x32_bf16 v[116:119], a[164:167], a[52:55], v[116:119]
    ds_read_b64_tr_b16 a[136:137], v20 offset:0
    buffer_load_dwordx4 v22, s[4:7], s46 offen offset:1024 lds
    v_mfma_f32_16x16x32_bf16 v[148:151], a[164:167], a[56:59], v[148:151]
    ds_read_b64_tr_b16 a[138:139], v20 offset:512
    v_mfma_f32_16x16x32_bf16 v[180:183], a[164:167], a[60:63], v[180:183]
    ds_read_b64_tr_b16 a[140:141], v21 offset:0
    v_mfma_f32_16x16x32_bf16 v[88:91], a[168:171], a[48:51], v[88:91]
    ds_read_b64_tr_b16 a[142:143], v21 offset:512
    v_mfma_f32_16x16x32_bf16 v[120:123], a[168:171], a[52:55], v[120:123]
    v_mfma_f32_16x16x32_bf16 v[152:155], a[168:171], a[56:59], v[152:155]
    v_mfma_f32_16x16x32_bf16 v[184:187], a[168:171], a[60:63], v[184:187]
    v_mfma_f32_16x16x32_bf16 v[92:95], a[172:175], a[48:51], v[92:95]
    buffer_load_dwordx4 v23, s[4:7], s46 offen offset:2048 lds
    v_mfma_f32_16x16x32_bf16 v[124:127], a[172:175], a[52:55], v[124:127]
    v_mfma_f32_16x16x32_bf16 v[156:159], a[172:175], a[56:59], v[156:159]
    v_mfma_f32_16x16x32_bf16 v[188:191], a[172:175], a[60:63], v[188:191]
    v_mfma_f32_16x16x32_bf16 v[192:195], a[176:179], a[48:51], v[192:195]
    v_mfma_f32_16x16x32_bf16 v[208:211], a[176:179], a[52:55], v[208:211]
    v_mfma_f32_16x16x32_bf16 v[224:227], a[176:179], a[56:59], v[224:227]
    buffer_load_dwordx4 v23, s[4:7], s46 offen offset:3072 lds
    v_mfma_f32_16x16x32_bf16 v[240:243], a[176:179], a[60:63], v[240:243]
    v_mfma_f32_16x16x32_bf16 v[196:199], a[180:183], a[48:51], v[196:199]
    v_mfma_f32_16x16x32_bf16 v[212:215], a[180:183], a[52:55], v[212:215]
    v_mfma_f32_16x16x32_bf16 v[228:231], a[180:183], a[56:59], v[228:231]
    v_mfma_f32_16x16x32_bf16 v[244:247], a[180:183], a[60:63], v[244:247]
    v_mfma_f32_16x16x32_bf16 v[200:203], a[184:187], a[48:51], v[200:203]
    v_mfma_f32_16x16x32_bf16 v[216:219], a[184:187], a[52:55], v[216:219]
    s_add_u32 s46, s46, 16384
    v_mfma_f32_16x16x32_bf16 v[232:235], a[184:187], a[56:59], v[232:235]
    v_mfma_f32_16x16x32_bf16 v[248:251], a[184:187], a[60:63], v[248:251]
    v_mfma_f32_16x16x32_bf16 v[204:207], a[188:191], a[48:51], v[204:207]
    v_mfma_f32_16x16x32_bf16 v[220:223], a[188:191], a[52:55], v[220:223]
    v_mfma_f32_16x16x32_bf16 v[236:239], a[188:191], a[56:59], v[236:239]
    v_mfma_f32_16x16x32_bf16 v[252:255], a[188:191], a[60:63], v[252:255]
    s_waitcnt vmcnt(18)
    s_waitcnt lgkmcnt(0)
    v_mfma_f32_16x16x32_bf16 v[64:67], a[96:99], a[64:67], v[64:67]
    v_mfma_f32_16x16x32_bf16 v[96:99], a[96:99], a[68:71], v[96:99]
    ds_read_b64_tr_b16 a[144:145], v14 offset:8192
    v_mfma_f32_16x16x32_bf16 v[128:131], a[96:99], a[72:75], v[128:131]
    ds_read_b64_tr_b16 a[146:147], v14 offset:9216
    v_mfma_f32_16x16x32_bf16 v[160:163], a[96:99], a[76:79], v[160:163]
    ds_read_b64_tr_b16 a[148:149], v14 offset:8200
    v_mfma_f32_16x16x32_bf16 v[68:71], a[100:103], a[64:67], v[68:71]
    ds_read_b64_tr_b16 a[150:151], v14 offset:9224
    v_mfma_f32_16x16x32_bf16 v[100:103], a[100:103], a[68:71], v[100:103]
    ds_read_b64_tr_b16 a[152:153], v15 offset:8192
    v_mfma_f32_16x16x32_bf16 v[132:135], a[100:103], a[72:75], v[132:135]
    ds_read_b64_tr_b16 a[154:155], v15 offset:9216
    v_mfma_f32_16x16x32_bf16 v[164:167], a[100:103], a[76:79], v[164:167]
    ds_read_b64_tr_b16 a[156:157], v15 offset:8200
    v_mfma_f32_16x16x32_bf16 v[72:75], a[104:107], a[64:67], v[72:75]
    ds_read_b64_tr_b16 a[158:159], v15 offset:9224
    s_add_u32 m0, s43, 16384
    s_nop 0
    v_mfma_f32_16x16x32_bf16 v[104:107], a[104:107], a[68:71], v[104:107]
    ds_read_b64_tr_b16 a[160:161], v16 offset:8192
    v_mfma_f32_16x16x32_bf16 v[136:139], a[104:107], a[72:75], v[136:139]
    ds_read_b64_tr_b16 a[162:163], v16 offset:9216
    v_mfma_f32_16x16x32_bf16 v[168:171], a[104:107], a[76:79], v[168:171]
    ds_read_b64_tr_b16 a[164:165], v16 offset:8200
    v_mfma_f32_16x16x32_bf16 v[76:79], a[108:111], a[64:67], v[76:79]
    ds_read_b64_tr_b16 a[166:167], v16 offset:9224
    v_mfma_f32_16x16x32_bf16 v[108:111], a[108:111], a[68:71], v[108:111]
    ds_read_b64_tr_b16 a[168:169], v17 offset:8192
    v_mfma_f32_16x16x32_bf16 v[140:143], a[108:111], a[72:75], v[140:143]
    ds_read_b64_tr_b16 a[170:171], v17 offset:9216
    buffer_load_dwordx4 v22, s[4:7], s46 offen offset:0 lds
    v_mfma_f32_16x16x32_bf16 v[172:175], a[108:111], a[76:79], v[172:175]
    ds_read_b64_tr_b16 a[172:173], v17 offset:8200
    v_mfma_f32_16x16x32_bf16 v[80:83], a[112:115], a[64:67], v[80:83]
    ds_read_b64_tr_b16 a[174:175], v17 offset:9224
    v_mfma_f32_16x16x32_bf16 v[112:115], a[112:115], a[68:71], v[112:115]
    ds_read_b64_tr_b16 a[176:177], v18 offset:4096
    v_mfma_f32_16x16x32_bf16 v[144:147], a[112:115], a[72:75], v[144:147]
    ds_read_b64_tr_b16 a[178:179], v18 offset:4608
    v_mfma_f32_16x16x32_bf16 v[176:179], a[112:115], a[76:79], v[176:179]
    ds_read_b64_tr_b16 a[180:181], v19 offset:4096
    v_mfma_f32_16x16x32_bf16 v[84:87], a[116:119], a[64:67], v[84:87]
    ds_read_b64_tr_b16 a[182:183], v19 offset:4608
    v_mfma_f32_16x16x32_bf16 v[116:119], a[116:119], a[68:71], v[116:119]
    ds_read_b64_tr_b16 a[184:185], v20 offset:4096
    buffer_load_dwordx4 v22, s[4:7], s46 offen offset:1024 lds
    v_mfma_f32_16x16x32_bf16 v[148:151], a[116:119], a[72:75], v[148:151]
    ds_read_b64_tr_b16 a[186:187], v20 offset:4608
    v_mfma_f32_16x16x32_bf16 v[180:183], a[116:119], a[76:79], v[180:183]
    ds_read_b64_tr_b16 a[188:189], v21 offset:4096
    v_mfma_f32_16x16x32_bf16 v[88:91], a[120:123], a[64:67], v[88:91]
    ds_read_b64_tr_b16 a[190:191], v21 offset:4608
    v_mfma_f32_16x16x32_bf16 v[120:123], a[120:123], a[68:71], v[120:123]
    v_mfma_f32_16x16x32_bf16 v[152:155], a[120:123], a[72:75], v[152:155]
    v_mfma_f32_16x16x32_bf16 v[184:187], a[120:123], a[76:79], v[184:187]
    v_mfma_f32_16x16x32_bf16 v[92:95], a[124:127], a[64:67], v[92:95]
    buffer_load_dwordx4 v23, s[4:7], s46 offen offset:2048 lds
    v_mfma_f32_16x16x32_bf16 v[124:127], a[124:127], a[68:71], v[124:127]
    v_mfma_f32_16x16x32_bf16 v[156:159], a[124:127], a[72:75], v[156:159]
    v_mfma_f32_16x16x32_bf16 v[188:191], a[124:127], a[76:79], v[188:191]
    v_mfma_f32_16x16x32_bf16 v[192:195], a[128:131], a[64:67], v[192:195]
    v_mfma_f32_16x16x32_bf16 v[208:211], a[128:131], a[68:71], v[208:211]
    v_mfma_f32_16x16x32_bf16 v[224:227], a[128:131], a[72:75], v[224:227]
    buffer_load_dwordx4 v23, s[4:7], s46 offen offset:3072 lds
    v_mfma_f32_16x16x32_bf16 v[240:243], a[128:131], a[76:79], v[240:243]
    v_mfma_f32_16x16x32_bf16 v[196:199], a[132:135], a[64:67], v[196:199]
    v_mfma_f32_16x16x32_bf16 v[212:215], a[132:135], a[68:71], v[212:215]
    v_mfma_f32_16x16x32_bf16 v[228:231], a[132:135], a[72:75], v[228:231]
    v_mfma_f32_16x16x32_bf16 v[244:247], a[132:135], a[76:79], v[244:247]
    v_mfma_f32_16x16x32_bf16 v[200:203], a[136:139], a[64:67], v[200:203]
    v_mfma_f32_16x16x32_bf16 v[216:219], a[136:139], a[68:71], v[216:219]
    s_add_u32 s46, s46, 16384
    v_mfma_f32_16x16x32_bf16 v[232:235], a[136:139], a[72:75], v[232:235]
    v_mfma_f32_16x16x32_bf16 v[248:251], a[136:139], a[76:79], v[248:251]
    v_mfma_f32_16x16x32_bf16 v[204:207], a[140:143], a[64:67], v[204:207]
    v_mfma_f32_16x16x32_bf16 v[220:223], a[140:143], a[68:71], v[220:223]
    v_mfma_f32_16x16x32_bf16 v[236:239], a[140:143], a[72:75], v[236:239]
    v_mfma_f32_16x16x32_bf16 v[252:255], a[140:143], a[76:79], v[252:255]
    s_waitcnt lgkmcnt(0)
    v_mfma_f32_16x16x32_bf16 v[64:67], a[144:147], a[80:83], v[64:67]
    s_waitcnt vmcnt(16)
    s_barrier
    v_mfma_f32_16x16x32_bf16 v[96:99], a[144:147], a[84:87], v[96:99]
    ds_read_b64_tr_b16 a[96:97], v14 offset:16384
    v_mfma_f32_16x16x32_bf16 v[128:131], a[144:147], a[88:91], v[128:131]
    ds_read_b64_tr_b16 a[98:99], v14 offset:17408
    v_mfma_f32_16x16x32_bf16 v[160:163], a[144:147], a[92:95], v[160:163]
    ds_read_b64_tr_b16 a[100:101], v14 offset:16392
    v_mfma_f32_16x16x32_bf16 v[68:71], a[148:151], a[80:83], v[68:71]
    ds_read_b64_tr_b16 a[102:103], v14 offset:17416
    v_mfma_f32_16x16x32_bf16 v[100:103], a[148:151], a[84:87], v[100:103]
    ds_read_b64_tr_b16 a[104:105], v15 offset:16384
    v_mfma_f32_16x16x32_bf16 v[132:135], a[148:151], a[88:91], v[132:135]
    ds_read_b64_tr_b16 a[106:107], v15 offset:17408
    v_mfma_f32_16x16x32_bf16 v[164:167], a[148:151], a[92:95], v[164:167]
    ds_read_b64_tr_b16 a[108:109], v15 offset:16392
    v_mfma_f32_16x16x32_bf16 v[72:75], a[152:155], a[80:83], v[72:75]
    ds_read_b64_tr_b16 a[110:111], v15 offset:17416
    s_add_u32 m0, s51, 32768
    s_nop 0
    v_mfma_f32_16x16x32_bf16 v[104:107], a[152:155], a[84:87], v[104:107]
    ds_read_b64_tr_b16 a[112:113], v16 offset:16384
    v_mfma_f32_16x16x32_bf16 v[136:139], a[152:155], a[88:91], v[136:139]
    ds_read_b64_tr_b16 a[114:115], v16 offset:17408
    v_mfma_f32_16x16x32_bf16 v[168:171], a[152:155], a[92:95], v[168:171]
    ds_read_b64_tr_b16 a[116:117], v16 offset:16392
    v_mfma_f32_16x16x32_bf16 v[76:79], a[156:159], a[80:83], v[76:79]
    ds_read_b64_tr_b16 a[118:119], v16 offset:17416
    v_mfma_f32_16x16x32_bf16 v[108:111], a[156:159], a[84:87], v[108:111]
    ds_read_b64_tr_b16 a[120:121], v17 offset:16384
    v_mfma_f32_16x16x32_bf16 v[140:143], a[156:159], a[88:91], v[140:143]
    ds_read_b64_tr_b16 a[122:123], v17 offset:17408
    buffer_load_dwordx4 v24, s[8:11], s47 offen offset:0 lds
    v_mfma_f32_16x16x32_bf16 v[172:175], a[156:159], a[92:95], v[172:175]
    ds_read_b64_tr_b16 a[124:125], v17 offset:16392
    v_mfma_f32_16x16x32_bf16 v[80:83], a[160:163], a[80:83], v[80:83]
    ds_read_b64_tr_b16 a[126:127], v17 offset:17416
    v_mfma_f32_16x16x32_bf16 v[112:115], a[160:163], a[84:87], v[112:115]
    ds_read_b64_tr_b16 a[128:129], v18 offset:8192
    v_mfma_f32_16x16x32_bf16 v[144:147], a[160:163], a[88:91], v[144:147]
    ds_read_b64_tr_b16 a[130:131], v18 offset:8704
    v_mfma_f32_16x16x32_bf16 v[176:179], a[160:163], a[92:95], v[176:179]
    ds_read_b64_tr_b16 a[132:133], v19 offset:8192
    v_mfma_f32_16x16x32_bf16 v[84:87], a[164:167], a[80:83], v[84:87]
    ds_read_b64_tr_b16 a[134:135], v19 offset:8704
    v_mfma_f32_16x16x32_bf16 v[116:119], a[164:167], a[84:87], v[116:119]
    ds_read_b64_tr_b16 a[136:137], v20 offset:8192
    buffer_load_dwordx4 v24, s[8:11], s47 offen offset:1024 lds
    v_mfma_f32_16x16x32_bf16 v[148:151], a[164:167], a[88:91], v[148:151]
    ds_read_b64_tr_b16 a[138:139], v20 offset:8704
    v_mfma_f32_16x16x32_bf16 v[180:183], a[164:167], a[92:95], v[180:183]
    ds_read_b64_tr_b16 a[140:141], v21 offset:8192
    v_mfma_f32_16x16x32_bf16 v[88:91], a[168:171], a[80:83], v[88:91]
    ds_read_b64_tr_b16 a[142:143], v21 offset:8704
    v_mfma_f32_16x16x32_bf16 v[120:123], a[168:171], a[84:87], v[120:123]
    v_mfma_f32_16x16x32_bf16 v[152:155], a[168:171], a[88:91], v[152:155]
    v_mfma_f32_16x16x32_bf16 v[184:187], a[168:171], a[92:95], v[184:187]
    v_mfma_f32_16x16x32_bf16 v[92:95], a[172:175], a[80:83], v[92:95]
    buffer_load_dwordx4 v25, s[8:11], s47 offen offset:2048 lds
    v_mfma_f32_16x16x32_bf16 v[124:127], a[172:175], a[84:87], v[124:127]
    v_mfma_f32_16x16x32_bf16 v[156:159], a[172:175], a[88:91], v[156:159]
    v_mfma_f32_16x16x32_bf16 v[188:191], a[172:175], a[92:95], v[188:191]
    v_mfma_f32_16x16x32_bf16 v[192:195], a[176:179], a[80:83], v[192:195]
    v_mfma_f32_16x16x32_bf16 v[208:211], a[176:179], a[84:87], v[208:211]
    v_mfma_f32_16x16x32_bf16 v[224:227], a[176:179], a[88:91], v[224:227]
    buffer_load_dwordx4 v25, s[8:11], s47 offen offset:3072 lds
    v_mfma_f32_16x16x32_bf16 v[240:243], a[176:179], a[92:95], v[240:243]
    v_mfma_f32_16x16x32_bf16 v[196:199], a[180:183], a[80:83], v[196:199]
    v_mfma_f32_16x16x32_bf16 v[212:215], a[180:183], a[84:87], v[212:215]
    v_mfma_f32_16x16x32_bf16 v[228:231], a[180:183], a[88:91], v[228:231]
    v_mfma_f32_16x16x32_bf16 v[244:247], a[180:183], a[92:95], v[244:247]
    v_mfma_f32_16x16x32_bf16 v[200:203], a[184:187], a[80:83], v[200:203]
    v_mfma_f32_16x16x32_bf16 v[216:219], a[184:187], a[84:87], v[216:219]
    s_add_u32 s47, s47, 16384
    v_mfma_f32_16x16x32_bf16 v[232:235], a[184:187], a[88:91], v[232:235]
    v_mfma_f32_16x16x32_bf16 v[248:251], a[184:187], a[92:95], v[248:251]
    v_mfma_f32_16x16x32_bf16 v[204:207], a[188:191], a[80:83], v[204:207]
    v_mfma_f32_16x16x32_bf16 v[220:223], a[188:191], a[84:87], v[220:223]
    v_mfma_f32_16x16x32_bf16 v[236:239], a[188:191], a[88:91], v[236:239]
    v_mfma_f32_16x16x32_bf16 v[252:255], a[188:191], a[92:95], v[252:255]
    s_waitcnt vmcnt(12)
    s_waitcnt lgkmcnt(0)
    v_mfma_f32_16x16x32_bf16 v[64:67], a[96:99], a[0:3], v[64:67]
    v_mfma_f32_16x16x32_bf16 v[96:99], a[96:99], a[4:7], v[96:99]
    ds_read_b64_tr_b16 a[144:145], v14 offset:24576
    v_mfma_f32_16x16x32_bf16 v[128:131], a[96:99], a[8:11], v[128:131]
    ds_read_b64_tr_b16 a[146:147], v14 offset:25600
    v_mfma_f32_16x16x32_bf16 v[160:163], a[96:99], a[12:15], v[160:163]
    ds_read_b64_tr_b16 a[148:149], v14 offset:24584
    v_mfma_f32_16x16x32_bf16 v[68:71], a[100:103], a[0:3], v[68:71]
    ds_read_b64_tr_b16 a[150:151], v14 offset:25608
    v_mfma_f32_16x16x32_bf16 v[100:103], a[100:103], a[4:7], v[100:103]
    ds_read_b64_tr_b16 a[152:153], v15 offset:24576
    v_mfma_f32_16x16x32_bf16 v[132:135], a[100:103], a[8:11], v[132:135]
    ds_read_b64_tr_b16 a[154:155], v15 offset:25600
    v_mfma_f32_16x16x32_bf16 v[164:167], a[100:103], a[12:15], v[164:167]
    ds_read_b64_tr_b16 a[156:157], v15 offset:24584
    v_mfma_f32_16x16x32_bf16 v[72:75], a[104:107], a[0:3], v[72:75]
    ds_read_b64_tr_b16 a[158:159], v15 offset:25608
    s_add_u32 m0, s43, 32768
    s_nop 0
    v_mfma_f32_16x16x32_bf16 v[104:107], a[104:107], a[4:7], v[104:107]
    ds_read_b64_tr_b16 a[160:161], v16 offset:24576
    v_mfma_f32_16x16x32_bf16 v[136:139], a[104:107], a[8:11], v[136:139]
    ds_read_b64_tr_b16 a[162:163], v16 offset:25600
    v_mfma_f32_16x16x32_bf16 v[168:171], a[104:107], a[12:15], v[168:171]
    ds_read_b64_tr_b16 a[164:165], v16 offset:24584
    v_mfma_f32_16x16x32_bf16 v[76:79], a[108:111], a[0:3], v[76:79]
    ds_read_b64_tr_b16 a[166:167], v16 offset:25608
    v_mfma_f32_16x16x32_bf16 v[108:111], a[108:111], a[4:7], v[108:111]
    ds_read_b64_tr_b16 a[168:169], v17 offset:24576
    v_mfma_f32_16x16x32_bf16 v[140:143], a[108:111], a[8:11], v[140:143]
    ds_read_b64_tr_b16 a[170:171], v17 offset:25600
    buffer_load_dwordx4 v22, s[4:7], s46 offen offset:0 lds
    v_mfma_f32_16x16x32_bf16 v[172:175], a[108:111], a[12:15], v[172:175]
    ds_read_b64_tr_b16 a[172:173], v17 offset:24584
    v_mfma_f32_16x16x32_bf16 v[80:83], a[112:115], a[0:3], v[80:83]
    ds_read_b64_tr_b16 a[174:175], v17 offset:25608
    v_mfma_f32_16x16x32_bf16 v[112:115], a[112:115], a[4:7], v[112:115]
    ds_read_b64_tr_b16 a[176:177], v18 offset:12288
    v_mfma_f32_16x16x32_bf16 v[144:147], a[112:115], a[8:11], v[144:147]
    ds_read_b64_tr_b16 a[178:179], v18 offset:12800
    v_mfma_f32_16x16x32_bf16 v[176:179], a[112:115], a[12:15], v[176:179]
    ds_read_b64_tr_b16 a[180:181], v19 offset:12288
    v_mfma_f32_16x16x32_bf16 v[84:87], a[116:119], a[0:3], v[84:87]
    ds_read_b64_tr_b16 a[182:183], v19 offset:12800
    v_mfma_f32_16x16x32_bf16 v[116:119], a[116:119], a[4:7], v[116:119]
    ds_read_b64_tr_b16 a[184:185], v20 offset:12288
    buffer_load_dwordx4 v22, s[4:7], s46 offen offset:1024 lds
    v_mfma_f32_16x16x32_bf16 v[148:151], a[116:119], a[8:11], v[148:151]
    ds_read_b64_tr_b16 a[186:187], v20 offset:12800
    v_mfma_f32_16x16x32_bf16 v[180:183], a[116:119], a[12:15], v[180:183]
    ds_read_b64_tr_b16 a[188:189], v21 offset:12288
    v_mfma_f32_16x16x32_bf16 v[88:91], a[120:123], a[0:3], v[88:91]
    ds_read_b64_tr_b16 a[190:191], v21 offset:12800
    v_mfma_f32_16x16x32_bf16 v[120:123], a[120:123], a[4:7], v[120:123]
    v_mfma_f32_16x16x32_bf16 v[152:155], a[120:123], a[8:11], v[152:155]
    v_mfma_f32_16x16x32_bf16 v[184:187], a[120:123], a[12:15], v[184:187]
    v_mfma_f32_16x16x32_bf16 v[92:95], a[124:127], a[0:3], v[92:95]
    buffer_load_dwordx4 v23, s[4:7], s46 offen offset:2048 lds
    v_mfma_f32_16x16x32_bf16 v[124:127], a[124:127], a[4:7], v[124:127]
    v_mfma_f32_16x16x32_bf16 v[156:159], a[124:127], a[8:11], v[156:159]
    v_mfma_f32_16x16x32_bf16 v[188:191], a[124:127], a[12:15], v[188:191]
    v_mfma_f32_16x16x32_bf16 v[192:195], a[128:131], a[0:3], v[192:195]
    v_mfma_f32_16x16x32_bf16 v[208:211], a[128:131], a[4:7], v[208:211]
    v_mfma_f32_16x16x32_bf16 v[224:227], a[128:131], a[8:11], v[224:227]
    buffer_load_dwordx4 v23, s[4:7], s46 offen offset:3072 lds
    v_mfma_f32_16x16x32_bf16 v[240:243], a[128:131], a[12:15], v[240:243]
    v_mfma_f32_16x16x32_bf16 v[196:199], a[132:135], a[0:3], v[196:199]
    v_mfma_f32_16x16x32_bf16 v[212:215], a[132:135], a[4:7], v[212:215]
    v_mfma_f32_16x16x32_bf16 v[228:231], a[132:135], a[8:11], v[228:231]
    v_mfma_f32_16x16x32_bf16 v[244:247], a[132:135], a[12:15], v[244:247]
    v_mfma_f32_16x16x32_bf16 v[200:203], a[136:139], a[0:3], v[200:203]
    v_mfma_f32_16x16x32_bf16 v[216:219], a[136:139], a[4:7], v[216:219]
    s_add_u32 s46, s46, 16384
    v_mfma_f32_16x16x32_bf16 v[232:235], a[136:139], a[8:11], v[232:235]
    v_mfma_f32_16x16x32_bf16 v[248:251], a[136:139], a[12:15], v[248:251]
    v_mfma_f32_16x16x32_bf16 v[204:207], a[140:143], a[0:3], v[204:207]
    v_mfma_f32_16x16x32_bf16 v[220:223], a[140:143], a[4:7], v[220:223]
    v_mfma_f32_16x16x32_bf16 v[236:239], a[140:143], a[8:11], v[236:239]
    v_mfma_f32_16x16x32_bf16 v[252:255], a[140:143], a[12:15], v[252:255]
    s_waitcnt lgkmcnt(0)
    v_mfma_f32_16x16x32_bf16 v[64:67], a[144:147], a[16:19], v[64:67]
    v_mfma_f32_16x16x32_bf16 v[96:99], a[144:147], a[20:23], v[96:99]
    v_mfma_f32_16x16x32_bf16 v[128:131], a[144:147], a[24:27], v[128:131]
    v_mfma_f32_16x16x32_bf16 v[160:163], a[144:147], a[28:31], v[160:163]
    v_mfma_f32_16x16x32_bf16 v[68:71], a[148:151], a[16:19], v[68:71]
    v_mfma_f32_16x16x32_bf16 v[100:103], a[148:151], a[20:23], v[100:103]
    v_mfma_f32_16x16x32_bf16 v[132:135], a[148:151], a[24:27], v[132:135]
    v_mfma_f32_16x16x32_bf16 v[164:167], a[148:151], a[28:31], v[164:167]
    v_mfma_f32_16x16x32_bf16 v[72:75], a[152:155], a[16:19], v[72:75]
    s_add_u32 m0, s51, 49152
    s_nop 0
    v_mfma_f32_16x16x32_bf16 v[104:107], a[152:155], a[20:23], v[104:107]
    v_mfma_f32_16x16x32_bf16 v[136:139], a[152:155], a[24:27], v[136:139]
    v_mfma_f32_16x16x32_bf16 v[168:171], a[152:155], a[28:31], v[168:171]
    v_mfma_f32_16x16x32_bf16 v[76:79], a[156:159], a[16:19], v[76:79]
    v_mfma_f32_16x16x32_bf16 v[108:111], a[156:159], a[20:23], v[108:111]
    v_mfma_f32_16x16x32_bf16 v[140:143], a[156:159], a[24:27], v[140:143]
    buffer_load_dwordx4 v24, s[8:11], s47 offen offset:0 lds
    v_mfma_f32_16x16x32_bf16 v[172:175], a[156:159], a[28:31], v[172:175]
    v_mfma_f32_16x16x32_bf16 v[80:83], a[160:163], a[16:19], v[80:83]
    v_mfma_f32_16x16x32_bf16 v[112:115], a[160:163], a[20:23], v[112:115]
    v_mfma_f32_16x16x32_bf16 v[144:147], a[160:163], a[24:27], v[144:147]
    v_mfma_f32_16x16x32_bf16 v[176:179], a[160:163], a[28:31], v[176:179]
    v_mfma_f32_16x16x32_bf16 v[84:87], a[164:167], a[16:19], v[84:87]
    v_mfma_f32_16x16x32_bf16 v[116:119], a[164:167], a[20:23], v[116:119]
    buffer_load_dwordx4 v24, s[8:11], s47 offen offset:1024 lds
    v_mfma_f32_16x16x32_bf16 v[148:151], a[164:167], a[24:27], v[148:151]
    v_mfma_f32_16x16x32_bf16 v[180:183], a[164:167], a[28:31], v[180:183]
    v_mfma_f32_16x16x32_bf16 v[88:91], a[168:171], a[16:19], v[88:91]
    v_mfma_f32_16x16x32_bf16 v[120:123], a[168:171], a[20:23], v[120:123]
    v_mfma_f32_16x16x32_bf16 v[152:155], a[168:171], a[24:27], v[152:155]
    v_mfma_f32_16x16x32_bf16 v[184:187], a[168:171], a[28:31], v[184:187]
    v_mfma_f32_16x16x32_bf16 v[92:95], a[172:175], a[16:19], v[92:95]
    buffer_load_dwordx4 v25, s[8:11], s47 offen offset:2048 lds
    v_mfma_f32_16x16x32_bf16 v[124:127], a[172:175], a[20:23], v[124:127]
    v_mfma_f32_16x16x32_bf16 v[156:159], a[172:175], a[24:27], v[156:159]
    v_mfma_f32_16x16x32_bf16 v[188:191], a[172:175], a[28:31], v[188:191]
    v_mfma_f32_16x16x32_bf16 v[192:195], a[176:179], a[16:19], v[192:195]
    v_mfma_f32_16x16x32_bf16 v[208:211], a[176:179], a[20:23], v[208:211]
    v_mfma_f32_16x16x32_bf16 v[224:227], a[176:179], a[24:27], v[224:227]
    buffer_load_dwordx4 v25, s[8:11], s47 offen offset:3072 lds
    v_mfma_f32_16x16x32_bf16 v[240:243], a[176:179], a[28:31], v[240:243]
    v_mfma_f32_16x16x32_bf16 v[196:199], a[180:183], a[16:19], v[196:199]
    v_mfma_f32_16x16x32_bf16 v[212:215], a[180:183], a[20:23], v[212:215]
    v_mfma_f32_16x16x32_bf16 v[228:231], a[180:183], a[24:27], v[228:231]
    v_mfma_f32_16x16x32_bf16 v[244:247], a[180:183], a[28:31], v[244:247]
    v_mfma_f32_16x16x32_bf16 v[200:203], a[184:187], a[16:19], v[200:203]
    v_mfma_f32_16x16x32_bf16 v[216:219], a[184:187], a[20:23], v[216:219]
    s_add_u32 s47, s47, 16384
    v_mfma_f32_16x16x32_bf16 v[232:235], a[184:187], a[24:27], v[232:235]
    v_mfma_f32_16x16x32_bf16 v[248:251], a[184:187], a[28:31], v[248:251]
    v_mfma_f32_16x16x32_bf16 v[204:207], a[188:191], a[16:19], v[204:207]
    v_mfma_f32_16x16x32_bf16 v[220:223], a[188:191], a[20:23], v[220:223]
    v_mfma_f32_16x16x32_bf16 v[236:239], a[188:191], a[24:27], v[236:239]
    v_mfma_f32_16x16x32_bf16 v[252:255], a[188:191], a[28:31], v[252:255]
    s_nop 7
    s_load_dwordx2 s[52:53], s[0:1], 32
    s_load_dwordx2 s[54:55], s[0:1], 64
    v_cvt_pk_bf16_f32 v64, v64, v65
    v_cvt_pk_bf16_f32 v65, v66, v67
    v_cvt_pk_bf16_f32 v66, v68, v69
    v_cvt_pk_bf16_f32 v67, v70, v71
    v_cvt_pk_bf16_f32 v68, v72, v73
    v_cvt_pk_bf16_f32 v69, v74, v75
    v_cvt_pk_bf16_f32 v70, v76, v77
    v_cvt_pk_bf16_f32 v71, v78, v79
    v_cvt_pk_bf16_f32 v72, v80, v81
    v_cvt_pk_bf16_f32 v73, v82, v83
    v_cvt_pk_bf16_f32 v74, v84, v85
    v_cvt_pk_bf16_f32 v75, v86, v87
    v_cvt_pk_bf16_f32 v76, v88, v89
    v_cvt_pk_bf16_f32 v77, v90, v91
    v_cvt_pk_bf16_f32 v78, v92, v93
    v_cvt_pk_bf16_f32 v79, v94, v95
    v_cvt_pk_bf16_f32 v80, v96, v97
    v_cvt_pk_bf16_f32 v81, v98, v99
    v_cvt_pk_bf16_f32 v82, v100, v101
    v_cvt_pk_bf16_f32 v83, v102, v103
    v_cvt_pk_bf16_f32 v84, v104, v105
    v_cvt_pk_bf16_f32 v85, v106, v107
    v_cvt_pk_bf16_f32 v86, v108, v109
    v_cvt_pk_bf16_f32 v87, v110, v111
    v_cvt_pk_bf16_f32 v88, v112, v113
    v_cvt_pk_bf16_f32 v89, v114, v115
    v_cvt_pk_bf16_f32 v90, v116, v117
    v_cvt_pk_bf16_f32 v91, v118, v119
    v_cvt_pk_bf16_f32 v92, v120, v121
    v_cvt_pk_bf16_f32 v93, v122, v123
    v_cvt_pk_bf16_f32 v94, v124, v125
    v_cvt_pk_bf16_f32 v95, v126, v127
    v_cvt_pk_bf16_f32 v96, v128, v129
    v_cvt_pk_bf16_f32 v97, v130, v131
    v_cvt_pk_bf16_f32 v98, v132, v133
    v_cvt_pk_bf16_f32 v99, v134, v135
    v_cvt_pk_bf16_f32 v100, v136, v137
    v_cvt_pk_bf16_f32 v101, v138, v139
    v_cvt_pk_bf16_f32 v102, v140, v141
    v_cvt_pk_bf16_f32 v103, v142, v143
    v_cvt_pk_bf16_f32 v104, v144, v145
    v_cvt_pk_bf16_f32 v105, v146, v147
    v_cvt_pk_bf16_f32 v106, v148, v149
    v_cvt_pk_bf16_f32 v107, v150, v151
    v_cvt_pk_bf16_f32 v108, v152, v153
    v_cvt_pk_bf16_f32 v109, v154, v155
    v_cvt_pk_bf16_f32 v110, v156, v157
    v_cvt_pk_bf16_f32 v111, v158, v159
    v_cvt_pk_bf16_f32 v112, v160, v161
    v_cvt_pk_bf16_f32 v113, v162, v163
    v_cvt_pk_bf16_f32 v114, v164, v165
    v_cvt_pk_bf16_f32 v115, v166, v167
    v_cvt_pk_bf16_f32 v116, v168, v169
    v_cvt_pk_bf16_f32 v117, v170, v171
    v_cvt_pk_bf16_f32 v118, v172, v173
    v_cvt_pk_bf16_f32 v119, v174, v175
    v_cvt_pk_bf16_f32 v120, v176, v177
    v_cvt_pk_bf16_f32 v121, v178, v179
    v_cvt_pk_bf16_f32 v122, v180, v181
    v_cvt_pk_bf16_f32 v123, v182, v183
    v_cvt_pk_bf16_f32 v124, v184, v185
    v_cvt_pk_bf16_f32 v125, v186, v187
    v_cvt_pk_bf16_f32 v126, v188, v189
    v_cvt_pk_bf16_f32 v127, v190, v191
    s_waitcnt lgkmcnt(0)
    s_mov_b32 s12, s52
    s_and_b32 s13, s53, 0xffff
    s_mov_b32 s14, 0x500000
    s_mov_b32 s15, 0x20000
    s_mov_b32 s16, s54
    s_and_b32 s17, s55, 0xffff
    s_mov_b32 s18, 0x21c000
    s_mov_b32 s19, 0x20000
    s_lshl_b32 s52, s2, 2
    s_add_u32 s52, s52, s42
    s_mul_i32 s56, s52, 5120
    s_add_u32 s57, s56, 4096
    s_mul_i32 s58, s52, 2176
    v_lshlrev_b32 v59, 6, v1
    s_cmp_ge_u32 s40, 27
    s_cbranch_scc1 attn_kernel_noh
    v_mov_b32 v56, 0x3f800000
    v_mov_b32 v57, 0x3f800000
    v_mov_b32 v60, 0xbdd2d3e8
    v_mov_b32 v61, 0xbdd2d3e8
    v_mov_b32 v62, 0xc0135761
    v_mov_b32 v63, 0xc0135761
    v_lshlrev_b32 v160, 16, v38
    v_and_b32 v161, 0xffff0000, v38
    v_lshlrev_b32 v162, 16, v39
    v_and_b32 v163, 0xffff0000, v39
    v_lshlrev_b32 v164, 16, v40
    v_and_b32 v165, 0xffff0000, v40
    v_lshlrev_b32 v166, 16, v41
    v_and_b32 v167, 0xffff0000, v41
    v_lshlrev_b32 v168, 16, v42
    v_and_b32 v169, 0xffff0000, v42
    v_lshlrev_b32 v170, 16, v43
    v_and_b32 v171, 0xffff0000, v43
    v_lshlrev_b32 v172, 16, v44
    v_and_b32 v173, 0xffff0000, v44
    v_lshlrev_b32 v174, 16, v45
    v_and_b32 v175, 0xffff0000, v45
    v_pk_fma_f32 v[128:129], v[192:193], v[32:33], v[160:161] op_sel:[0,1,0] op_sel_hi:[1,1,1]
    v_pk_fma_f32 v[130:131], v[194:195], v[32:33], v[162:163] op_sel:[0,1,0] op_sel_hi:[1,1,1]
    v_pk_fma_f32 v[132:133], v[196:197], v[32:33], v[164:165] op_sel:[0,1,0] op_sel_hi:[1,1,1]
    v_pk_fma_f32 v[134:135], v[198:199], v[32:33], v[166:167] op_sel:[0,1,0] op_sel_hi:[1,1,1]
    v_pk_mul_f32 v[136:137], v[128:129], v[128:129]
    v_pk_mul_f32 v[138:139], v[130:131], v[130:131]
    v_pk_mul_f32 v[140:141], v[132:133], v[132:133]
    v_pk_mul_f32 v[142:143], v[134:135], v[134:135]
    v_pk_fma_f32 v[136:137], v[136:137], v[60:61], v[62:63]
    v_pk_fma_f32 v[138:139], v[138:139], v[60:61], v[62:63]
    v_pk_fma_f32 v[140:141], v[140:141], v[60:61], v[62:63]
    v_pk_fma_f32 v[142:143], v[142:143], v[60:61], v[62:63]
    v_pk_mul_f32 v[136:137], v[136:137], v[128:129]
    v_pk_mul_f32 v[138:139], v[138:139], v[130:131]
    v_pk_mul_f32 v[140:141], v[140:141], v[132:133]
    v_pk_mul_f32 v[142:143], v[142:143], v[134:135]
    v_exp_f32 v136, v136
    v_exp_f32 v137, v137
    v_exp_f32 v138, v138
    v_exp_f32 v139, v139
    v_exp_f32 v140, v140
    v_exp_f32 v141, v141
    v_exp_f32 v142, v142
    v_exp_f32 v143, v143
    v_pk_add_f32 v[136:137], v[136:137], v[56:57]
    v_pk_add_f32 v[138:139], v[138:139], v[56:57]
    v_pk_add_f32 v[140:141], v[140:141], v[56:57]
    v_pk_add_f32 v[142:143], v[142:143], v[56:57]
    v_rcp_f32 v136, v136
    v_rcp_f32 v137, v137
    v_rcp_f32 v138, v138
    v_rcp_f32 v139, v139
    v_rcp_f32 v140, v140
    v_rcp_f32 v141, v141
    v_rcp_f32 v142, v142
    v_rcp_f32 v143, v143
    v_pk_mul_f32 v[128:129], v[128:129], v[136:137]
    v_pk_mul_f32 v[130:131], v[130:131], v[138:139]
    v_pk_mul_f32 v[132:133], v[132:133], v[140:141]
    v_pk_mul_f32 v[134:135], v[134:135], v[142:143]
    v_cvt_pk_bf16_f32 v176, v128, v129
    v_cvt_pk_bf16_f32 v177, v130, v131
    v_cvt_pk_bf16_f32 v178, v132, v133
    v_cvt_pk_bf16_f32 v179, v134, v135
    buffer_store_dwordx4 v[176:179], v32, s[24:27], s60 offen offset:0 sc1
    v_pk_fma_f32 v[128:129], v[200:201], v[32:33], v[168:169] op_sel:[0,1,0] op_sel_hi:[1,1,1]
    v_pk_fma_f32 v[130:131], v[202:203], v[32:33], v[170:171] op_sel:[0,1,0] op_sel_hi:[1,1,1]
    v_pk_fma_f32 v[132:133], v[204:205], v[32:33], v[172:173] op_sel:[0,1,0] op_sel_hi:[1,1,1]
    v_pk_fma_f32 v[134:135], v[206:207], v[32:33], v[174:175] op_sel:[0,1,0] op_sel_hi:[1,1,1]
    v_pk_mul_f32 v[136:137], v[128:129], v[128:129]
    v_pk_mul_f32 v[138:139], v[130:131], v[130:131]
    v_pk_mul_f32 v[140:141], v[132:133], v[132:133]
    v_pk_mul_f32 v[142:143], v[134:135], v[134:135]
    v_pk_fma_f32 v[136:137], v[136:137], v[60:61], v[62:63]
    v_pk_fma_f32 v[138:139], v[138:139], v[60:61], v[62:63]
    v_pk_fma_f32 v[140:141], v[140:141], v[60:61], v[62:63]
    v_pk_fma_f32 v[142:143], v[142:143], v[60:61], v[62:63]
    v_pk_mul_f32 v[136:137], v[136:137], v[128:129]
    v_pk_mul_f32 v[138:139], v[138:139], v[130:131]
    v_pk_mul_f32 v[140:141], v[140:141], v[132:133]
    v_pk_mul_f32 v[142:143], v[142:143], v[134:135]
    v_exp_f32 v136, v136
    v_exp_f32 v137, v137
    v_exp_f32 v138, v138
    v_exp_f32 v139, v139
    v_exp_f32 v140, v140
    v_exp_f32 v141, v141
    v_exp_f32 v142, v142
    v_exp_f32 v143, v143
    v_pk_add_f32 v[136:137], v[136:137], v[56:57]
    v_pk_add_f32 v[138:139], v[138:139], v[56:57]
    v_pk_add_f32 v[140:141], v[140:141], v[56:57]
    v_pk_add_f32 v[142:143], v[142:143], v[56:57]
    v_rcp_f32 v136, v136
    v_rcp_f32 v137, v137
    v_rcp_f32 v138, v138
    v_rcp_f32 v139, v139
    v_rcp_f32 v140, v140
    v_rcp_f32 v141, v141
    v_rcp_f32 v142, v142
    v_rcp_f32 v143, v143
    v_pk_mul_f32 v[128:129], v[128:129], v[136:137]
    v_pk_mul_f32 v[130:131], v[130:131], v[138:139]
    v_pk_mul_f32 v[132:133], v[132:133], v[140:141]
    v_pk_mul_f32 v[134:135], v[134:135], v[142:143]
    v_cvt_pk_bf16_f32 v180, v128, v129
    v_cvt_pk_bf16_f32 v181, v130, v131
    v_cvt_pk_bf16_f32 v182, v132, v133
    v_cvt_pk_bf16_f32 v183, v134, v135
    buffer_store_dwordx4 v[180:183], v32, s[24:27], s60 offen offset:1024 sc1
    s_add_u32 s60, s60, 55296
    v_pk_fma_f32 v[128:129], v[208:209], v[34:35], v[160:161] op_sel_hi:[1,0,1]
    v_pk_fma_f32 v[130:131], v[210:211], v[34:35], v[162:163] op_sel_hi:[1,0,1]
    v_pk_fma_f32 v[132:133], v[212:213], v[34:35], v[164:165] op_sel_hi:[1,0,1]
    v_pk_fma_f32 v[134:135], v[214:215], v[34:35], v[166:167] op_sel_hi:[1,0,1]
    v_pk_mul_f32 v[136:137], v[128:129], v[128:129]
    v_pk_mul_f32 v[138:139], v[130:131], v[130:131]
    v_pk_mul_f32 v[140:141], v[132:133], v[132:133]
    v_pk_mul_f32 v[142:143], v[134:135], v[134:135]
    v_pk_fma_f32 v[136:137], v[136:137], v[60:61], v[62:63]
    v_pk_fma_f32 v[138:139], v[138:139], v[60:61], v[62:63]
    v_pk_fma_f32 v[140:141], v[140:141], v[60:61], v[62:63]
    v_pk_fma_f32 v[142:143], v[142:143], v[60:61], v[62:63]
    v_pk_mul_f32 v[136:137], v[136:137], v[128:129]
    v_pk_mul_f32 v[138:139], v[138:139], v[130:131]
    v_pk_mul_f32 v[140:141], v[140:141], v[132:133]
    v_pk_mul_f32 v[142:143], v[142:143], v[134:135]
    v_exp_f32 v136, v136
    v_exp_f32 v137, v137
    v_exp_f32 v138, v138
    v_exp_f32 v139, v139
    v_exp_f32 v140, v140
    v_exp_f32 v141, v141
    v_exp_f32 v142, v142
    v_exp_f32 v143, v143
    v_pk_add_f32 v[136:137], v[136:137], v[56:57]
    v_pk_add_f32 v[138:139], v[138:139], v[56:57]
    v_pk_add_f32 v[140:141], v[140:141], v[56:57]
    v_pk_add_f32 v[142:143], v[142:143], v[56:57]
    v_rcp_f32 v136, v136
    v_rcp_f32 v137, v137
    v_rcp_f32 v138, v138
    v_rcp_f32 v139, v139
    v_rcp_f32 v140, v140
    v_rcp_f32 v141, v141
    v_rcp_f32 v142, v142
    v_rcp_f32 v143, v143
    v_pk_mul_f32 v[128:129], v[128:129], v[136:137]
    v_pk_mul_f32 v[130:131], v[130:131], v[138:139]
    v_pk_mul_f32 v[132:133], v[132:133], v[140:141]
    v_pk_mul_f32 v[134:135], v[134:135], v[142:143]
    v_cvt_pk_bf16_f32 v184, v128, v129
    v_cvt_pk_bf16_f32 v185, v130, v131
    v_cvt_pk_bf16_f32 v186, v132, v133
    v_cvt_pk_bf16_f32 v187, v134, v135
    buffer_store_dwordx4 v[184:187], v32, s[24:27], s60 offen offset:0 sc1
    v_pk_fma_f32 v[128:129], v[216:217], v[34:35], v[168:169] op_sel_hi:[1,0,1]
    v_pk_fma_f32 v[130:131], v[218:219], v[34:35], v[170:171] op_sel_hi:[1,0,1]
    v_pk_fma_f32 v[132:133], v[220:221], v[34:35], v[172:173] op_sel_hi:[1,0,1]
    v_pk_fma_f32 v[134:135], v[222:223], v[34:35], v[174:175] op_sel_hi:[1,0,1]
    v_pk_mul_f32 v[136:137], v[128:129], v[128:129]
    v_pk_mul_f32 v[138:139], v[130:131], v[130:131]
    v_pk_mul_f32 v[140:141], v[132:133], v[132:133]
    v_pk_mul_f32 v[142:143], v[134:135], v[134:135]
    v_pk_fma_f32 v[136:137], v[136:137], v[60:61], v[62:63]
    v_pk_fma_f32 v[138:139], v[138:139], v[60:61], v[62:63]
    v_pk_fma_f32 v[140:141], v[140:141], v[60:61], v[62:63]
    v_pk_fma_f32 v[142:143], v[142:143], v[60:61], v[62:63]
    v_pk_mul_f32 v[136:137], v[136:137], v[128:129]
    v_pk_mul_f32 v[138:139], v[138:139], v[130:131]
    v_pk_mul_f32 v[140:141], v[140:141], v[132:133]
    v_pk_mul_f32 v[142:143], v[142:143], v[134:135]
    v_exp_f32 v136, v136
    v_exp_f32 v137, v137
    v_exp_f32 v138, v138
    v_exp_f32 v139, v139
    v_exp_f32 v140, v140
    v_exp_f32 v141, v141
    v_exp_f32 v142, v142
    v_exp_f32 v143, v143
    v_pk_add_f32 v[136:137], v[136:137], v[56:57]
    v_pk_add_f32 v[138:139], v[138:139], v[56:57]
    v_pk_add_f32 v[140:141], v[140:141], v[56:57]
    v_pk_add_f32 v[142:143], v[142:143], v[56:57]
    v_rcp_f32 v136, v136
    v_rcp_f32 v137, v137
    v_rcp_f32 v138, v138
    v_rcp_f32 v139, v139
    v_rcp_f32 v140, v140
    v_rcp_f32 v141, v141
    v_rcp_f32 v142, v142
    v_rcp_f32 v143, v143
    v_pk_mul_f32 v[128:129], v[128:129], v[136:137]
    v_pk_mul_f32 v[130:131], v[130:131], v[138:139]
    v_pk_mul_f32 v[132:133], v[132:133], v[140:141]
    v_pk_mul_f32 v[134:135], v[134:135], v[142:143]
    v_cvt_pk_bf16_f32 v188, v128, v129
    v_cvt_pk_bf16_f32 v189, v130, v131
    v_cvt_pk_bf16_f32 v190, v132, v133
    v_cvt_pk_bf16_f32 v191, v134, v135
    buffer_store_dwordx4 v[188:191], v32, s[24:27], s60 offen offset:1024 sc1
    s_add_u32 s60, s60, 55296
    v_pk_fma_f32 v[128:129], v[224:225], v[34:35], v[160:161] op_sel:[0,1,0] op_sel_hi:[1,1,1]
    v_pk_fma_f32 v[130:131], v[226:227], v[34:35], v[162:163] op_sel:[0,1,0] op_sel_hi:[1,1,1]
    v_pk_fma_f32 v[132:133], v[228:229], v[34:35], v[164:165] op_sel:[0,1,0] op_sel_hi:[1,1,1]
    v_pk_fma_f32 v[134:135], v[230:231], v[34:35], v[166:167] op_sel:[0,1,0] op_sel_hi:[1,1,1]
    v_pk_mul_f32 v[136:137], v[128:129], v[128:129]
    v_pk_mul_f32 v[138:139], v[130:131], v[130:131]
    v_pk_mul_f32 v[140:141], v[132:133], v[132:133]
    v_pk_mul_f32 v[142:143], v[134:135], v[134:135]
    v_pk_fma_f32 v[136:137], v[136:137], v[60:61], v[62:63]
    v_pk_fma_f32 v[138:139], v[138:139], v[60:61], v[62:63]
    v_pk_fma_f32 v[140:141], v[140:141], v[60:61], v[62:63]
    v_pk_fma_f32 v[142:143], v[142:143], v[60:61], v[62:63]
    v_pk_mul_f32 v[136:137], v[136:137], v[128:129]
    v_pk_mul_f32 v[138:139], v[138:139], v[130:131]
    v_pk_mul_f32 v[140:141], v[140:141], v[132:133]
    v_pk_mul_f32 v[142:143], v[142:143], v[134:135]
    v_exp_f32 v136, v136
    v_exp_f32 v137, v137
    v_exp_f32 v138, v138
    v_exp_f32 v139, v139
    v_exp_f32 v140, v140
    v_exp_f32 v141, v141
    v_exp_f32 v142, v142
    v_exp_f32 v143, v143
    v_pk_add_f32 v[136:137], v[136:137], v[56:57]
    v_pk_add_f32 v[138:139], v[138:139], v[56:57]
    v_pk_add_f32 v[140:141], v[140:141], v[56:57]
    v_pk_add_f32 v[142:143], v[142:143], v[56:57]
    v_rcp_f32 v136, v136
    v_rcp_f32 v137, v137
    v_rcp_f32 v138, v138
    v_rcp_f32 v139, v139
    v_rcp_f32 v140, v140
    v_rcp_f32 v141, v141
    v_rcp_f32 v142, v142
    v_rcp_f32 v143, v143
    v_pk_mul_f32 v[128:129], v[128:129], v[136:137]
    v_pk_mul_f32 v[130:131], v[130:131], v[138:139]
    v_pk_mul_f32 v[132:133], v[132:133], v[140:141]
    v_pk_mul_f32 v[134:135], v[134:135], v[142:143]
    v_cvt_pk_bf16_f32 v176, v128, v129
    v_cvt_pk_bf16_f32 v177, v130, v131
    v_cvt_pk_bf16_f32 v178, v132, v133
    v_cvt_pk_bf16_f32 v179, v134, v135
    buffer_store_dwordx4 v[176:179], v32, s[24:27], s60 offen offset:0 sc1
    v_pk_fma_f32 v[128:129], v[232:233], v[34:35], v[168:169] op_sel:[0,1,0] op_sel_hi:[1,1,1]
    v_pk_fma_f32 v[130:131], v[234:235], v[34:35], v[170:171] op_sel:[0,1,0] op_sel_hi:[1,1,1]
    v_pk_fma_f32 v[132:133], v[236:237], v[34:35], v[172:173] op_sel:[0,1,0] op_sel_hi:[1,1,1]
    v_pk_fma_f32 v[134:135], v[238:239], v[34:35], v[174:175] op_sel:[0,1,0] op_sel_hi:[1,1,1]
    v_pk_mul_f32 v[136:137], v[128:129], v[128:129]
    v_pk_mul_f32 v[138:139], v[130:131], v[130:131]
    v_pk_mul_f32 v[140:141], v[132:133], v[132:133]
    v_pk_mul_f32 v[142:143], v[134:135], v[134:135]
    v_pk_fma_f32 v[136:137], v[136:137], v[60:61], v[62:63]
    v_pk_fma_f32 v[138:139], v[138:139], v[60:61], v[62:63]
    v_pk_fma_f32 v[140:141], v[140:141], v[60:61], v[62:63]
    v_pk_fma_f32 v[142:143], v[142:143], v[60:61], v[62:63]
    v_pk_mul_f32 v[136:137], v[136:137], v[128:129]
    v_pk_mul_f32 v[138:139], v[138:139], v[130:131]
    v_pk_mul_f32 v[140:141], v[140:141], v[132:133]
    v_pk_mul_f32 v[142:143], v[142:143], v[134:135]
    v_exp_f32 v136, v136
    v_exp_f32 v137, v137
    v_exp_f32 v138, v138
    v_exp_f32 v139, v139
    v_exp_f32 v140, v140
    v_exp_f32 v141, v141
    v_exp_f32 v142, v142
    v_exp_f32 v143, v143
    v_pk_add_f32 v[136:137], v[136:137], v[56:57]
    v_pk_add_f32 v[138:139], v[138:139], v[56:57]
    v_pk_add_f32 v[140:141], v[140:141], v[56:57]
    v_pk_add_f32 v[142:143], v[142:143], v[56:57]
    v_rcp_f32 v136, v136
    v_rcp_f32 v137, v137
    v_rcp_f32 v138, v138
    v_rcp_f32 v139, v139
    v_rcp_f32 v140, v140
    v_rcp_f32 v141, v141
    v_rcp_f32 v142, v142
    v_rcp_f32 v143, v143
    v_pk_mul_f32 v[128:129], v[128:129], v[136:137]
    v_pk_mul_f32 v[130:131], v[130:131], v[138:139]
    v_pk_mul_f32 v[132:133], v[132:133], v[140:141]
    v_pk_mul_f32 v[134:135], v[134:135], v[142:143]
    v_cvt_pk_bf16_f32 v180, v128, v129
    v_cvt_pk_bf16_f32 v181, v130, v131
    v_cvt_pk_bf16_f32 v182, v132, v133
    v_cvt_pk_bf16_f32 v183, v134, v135
    buffer_store_dwordx4 v[180:183], v32, s[24:27], s60 offen offset:1024 sc1
    s_add_u32 s60, s60, 55296
    v_pk_fma_f32 v[128:129], v[240:241], v[36:37], v[160:161] op_sel_hi:[1,0,1]
    v_pk_fma_f32 v[130:131], v[242:243], v[36:37], v[162:163] op_sel_hi:[1,0,1]
    v_pk_fma_f32 v[132:133], v[244:245], v[36:37], v[164:165] op_sel_hi:[1,0,1]
    v_pk_fma_f32 v[134:135], v[246:247], v[36:37], v[166:167] op_sel_hi:[1,0,1]
    v_pk_mul_f32 v[136:137], v[128:129], v[128:129]
    v_pk_mul_f32 v[138:139], v[130:131], v[130:131]
    v_pk_mul_f32 v[140:141], v[132:133], v[132:133]
    v_pk_mul_f32 v[142:143], v[134:135], v[134:135]
    v_pk_fma_f32 v[136:137], v[136:137], v[60:61], v[62:63]
    v_pk_fma_f32 v[138:139], v[138:139], v[60:61], v[62:63]
    v_pk_fma_f32 v[140:141], v[140:141], v[60:61], v[62:63]
    v_pk_fma_f32 v[142:143], v[142:143], v[60:61], v[62:63]
    v_pk_mul_f32 v[136:137], v[136:137], v[128:129]
    v_pk_mul_f32 v[138:139], v[138:139], v[130:131]
    v_pk_mul_f32 v[140:141], v[140:141], v[132:133]
    v_pk_mul_f32 v[142:143], v[142:143], v[134:135]
    v_exp_f32 v136, v136
    v_exp_f32 v137, v137
    v_exp_f32 v138, v138
    v_exp_f32 v139, v139
    v_exp_f32 v140, v140
    v_exp_f32 v141, v141
    v_exp_f32 v142, v142
    v_exp_f32 v143, v143
    v_pk_add_f32 v[136:137], v[136:137], v[56:57]
    v_pk_add_f32 v[138:139], v[138:139], v[56:57]
    v_pk_add_f32 v[140:141], v[140:141], v[56:57]
    v_pk_add_f32 v[142:143], v[142:143], v[56:57]
    v_rcp_f32 v136, v136
    v_rcp_f32 v137, v137
    v_rcp_f32 v138, v138
    v_rcp_f32 v139, v139
    v_rcp_f32 v140, v140
    v_rcp_f32 v141, v141
    v_rcp_f32 v142, v142
    v_rcp_f32 v143, v143
    v_pk_mul_f32 v[128:129], v[128:129], v[136:137]
    v_pk_mul_f32 v[130:131], v[130:131], v[138:139]
    v_pk_mul_f32 v[132:133], v[132:133], v[140:141]
    v_pk_mul_f32 v[134:135], v[134:135], v[142:143]
    v_cvt_pk_bf16_f32 v184, v128, v129
    v_cvt_pk_bf16_f32 v185, v130, v131
    v_cvt_pk_bf16_f32 v186, v132, v133
    v_cvt_pk_bf16_f32 v187, v134, v135
    buffer_store_dwordx4 v[184:187], v32, s[24:27], s60 offen offset:0 sc1
    v_pk_fma_f32 v[128:129], v[248:249], v[36:37], v[168:169] op_sel_hi:[1,0,1]
    v_pk_fma_f32 v[130:131], v[250:251], v[36:37], v[170:171] op_sel_hi:[1,0,1]
    v_pk_fma_f32 v[132:133], v[252:253], v[36:37], v[172:173] op_sel_hi:[1,0,1]
    v_pk_fma_f32 v[134:135], v[254:255], v[36:37], v[174:175] op_sel_hi:[1,0,1]
    v_pk_mul_f32 v[136:137], v[128:129], v[128:129]
    v_pk_mul_f32 v[138:139], v[130:131], v[130:131]
    v_pk_mul_f32 v[140:141], v[132:133], v[132:133]
    v_pk_mul_f32 v[142:143], v[134:135], v[134:135]
    v_pk_fma_f32 v[136:137], v[136:137], v[60:61], v[62:63]
    v_pk_fma_f32 v[138:139], v[138:139], v[60:61], v[62:63]
    v_pk_fma_f32 v[140:141], v[140:141], v[60:61], v[62:63]
    v_pk_fma_f32 v[142:143], v[142:143], v[60:61], v[62:63]
    v_pk_mul_f32 v[136:137], v[136:137], v[128:129]
    v_pk_mul_f32 v[138:139], v[138:139], v[130:131]
    v_pk_mul_f32 v[140:141], v[140:141], v[132:133]
    v_pk_mul_f32 v[142:143], v[142:143], v[134:135]
    v_exp_f32 v136, v136
    v_exp_f32 v137, v137
    v_exp_f32 v138, v138
    v_exp_f32 v139, v139
    v_exp_f32 v140, v140
    v_exp_f32 v141, v141
    v_exp_f32 v142, v142
    v_exp_f32 v143, v143
    v_pk_add_f32 v[136:137], v[136:137], v[56:57]
    v_pk_add_f32 v[138:139], v[138:139], v[56:57]
    v_pk_add_f32 v[140:141], v[140:141], v[56:57]
    v_pk_add_f32 v[142:143], v[142:143], v[56:57]
    v_rcp_f32 v136, v136
    v_rcp_f32 v137, v137
    v_rcp_f32 v138, v138
    v_rcp_f32 v139, v139
    v_rcp_f32 v140, v140
    v_rcp_f32 v141, v141
    v_rcp_f32 v142, v142
    v_rcp_f32 v143, v143
    v_pk_mul_f32 v[128:129], v[128:129], v[136:137]
    v_pk_mul_f32 v[130:131], v[130:131], v[138:139]
    v_pk_mul_f32 v[132:133], v[132:133], v[140:141]
    v_pk_mul_f32 v[134:135], v[134:135], v[142:143]
    v_cvt_pk_bf16_f32 v188, v128, v129
    v_cvt_pk_bf16_f32 v189, v130, v131
    v_cvt_pk_bf16_f32 v190, v132, v133
    v_cvt_pk_bf16_f32 v191, v134, v135
    buffer_store_dwordx4 v[188:191], v32, s[24:27], s60 offen offset:1024 sc1
attn_kernel_noh:
    v_mov_b32 v224, 0
    v_mov_b32 v225, 0
    v_mov_b32 v226, 0
    v_mov_b32 v227, 0
    v_mov_b32 v228, 0
    v_mov_b32 v229, 0
    v_mov_b32 v230, 0
    v_mov_b32 v231, 0
    v_mov_b32 v232, 0
    v_mov_b32 v233, 0
    v_mov_b32 v234, 0
    v_mov_b32 v235, 0
    v_mov_b32 v236, 0
    v_mov_b32 v237, 0
    v_mov_b32 v238, 0
    v_mov_b32 v239, 0
    v_and_b32 v48, 3, v1
    v_cmp_eq_u32 vcc, 0, v48
    v_mov_b32 v49, 0x3f803f80
    v_mov_b32 v50, 0
    v_cndmask_b32 v49, v50, v49, vcc
    v_accvgpr_write_b32 a208, v49
    v_accvgpr_write_b32 a209, v49
    v_accvgpr_write_b32 a210, v49
    v_accvgpr_write_b32 a211, v49
attn_kernel_att:
    s_waitcnt vmcnt(16)
    s_barrier
    ds_read_b128 a[128:131], v2 offset:0
    ds_read_b128 a[144:147], v2 offset:1024
    ds_read_b128 a[132:135], v3 offset:0
    ds_read_b128 a[148:151], v3 offset:1024
    ds_read_b128 a[136:139], v4 offset:0
    ds_read_b128 a[152:155], v4 offset:1024
    ds_read_b128 a[140:143], v5 offset:0
    ds_read_b128 a[156:159], v5 offset:1024
    s_waitcnt lgkmcnt(7)
    v_mfma_f32_16x16x32_bf16 v[128:131], a[128:131], v[64:67], v[224:227]
    s_waitcnt lgkmcnt(6)
    v_mfma_f32_16x16x32_bf16 v[132:135], a[144:147], v[64:67], v[224:227]
    v_mfma_f32_16x16x32_bf16 v[136:139], a[128:131], v[80:83], v[228:231]
    v_mfma_f32_16x16x32_bf16 v[140:143], a[144:147], v[80:83], v[228:231]
    v_mfma_f32_16x16x32_bf16 v[144:147], a[128:131], v[96:99], v[232:235]
    v_mfma_f32_16x16x32_bf16 v[148:151], a[144:147], v[96:99], v[232:235]
    v_mfma_f32_16x16x32_bf16 v[152:155], a[128:131], v[112:115], v[236:239]
    v_mfma_f32_16x16x32_bf16 v[156:159], a[144:147], v[112:115], v[236:239]
    s_waitcnt lgkmcnt(5)
    v_mfma_f32_16x16x32_bf16 v[128:131], a[132:135], v[68:71], v[128:131]
    s_waitcnt lgkmcnt(4)
    v_mfma_f32_16x16x32_bf16 v[132:135], a[148:151], v[68:71], v[132:135]
    v_mfma_f32_16x16x32_bf16 v[136:139], a[132:135], v[84:87], v[136:139]
    v_mfma_f32_16x16x32_bf16 v[140:143], a[148:151], v[84:87], v[140:143]
    v_mfma_f32_16x16x32_bf16 v[144:147], a[132:135], v[100:103], v[144:147]
    v_mfma_f32_16x16x32_bf16 v[148:151], a[148:151], v[100:103], v[148:151]
    v_mfma_f32_16x16x32_bf16 v[152:155], a[132:135], v[116:119], v[152:155]
    v_mfma_f32_16x16x32_bf16 v[156:159], a[148:151], v[116:119], v[156:159]
    s_waitcnt lgkmcnt(3)
    v_mfma_f32_16x16x32_bf16 v[128:131], a[136:139], v[72:75], v[128:131]
    s_waitcnt lgkmcnt(2)
    v_mfma_f32_16x16x32_bf16 v[132:135], a[152:155], v[72:75], v[132:135]
    v_mfma_f32_16x16x32_bf16 v[136:139], a[136:139], v[88:91], v[136:139]
    v_mfma_f32_16x16x32_bf16 v[140:143], a[152:155], v[88:91], v[140:143]
    v_mfma_f32_16x16x32_bf16 v[144:147], a[136:139], v[104:107], v[144:147]
    v_mfma_f32_16x16x32_bf16 v[148:151], a[152:155], v[104:107], v[148:151]
    v_mfma_f32_16x16x32_bf16 v[152:155], a[136:139], v[120:123], v[152:155]
    v_mfma_f32_16x16x32_bf16 v[156:159], a[152:155], v[120:123], v[156:159]
    s_waitcnt lgkmcnt(1)
    v_mfma_f32_16x16x32_bf16 v[128:131], a[140:143], v[76:79], v[128:131]
    s_waitcnt lgkmcnt(0)
    v_mfma_f32_16x16x32_bf16 v[132:135], a[156:159], v[76:79], v[132:135]
    v_mfma_f32_16x16x32_bf16 v[136:139], a[140:143], v[92:95], v[136:139]
    v_mfma_f32_16x16x32_bf16 v[140:143], a[156:159], v[92:95], v[140:143]
    v_mfma_f32_16x16x32_bf16 v[144:147], a[140:143], v[108:111], v[144:147]
    v_mfma_f32_16x16x32_bf16 v[148:151], a[156:159], v[108:111], v[148:151]
    v_mfma_f32_16x16x32_bf16 v[152:155], a[140:143], v[124:127], v[152:155]
    v_mfma_f32_16x16x32_bf16 v[156:159], a[156:159], v[124:127], v[156:159]
    ds_read_b128 a[128:131], v2 offset:8192
    ds_read_b128 a[144:147], v2 offset:9216
    ds_read_b128 a[132:135], v3 offset:8192
    ds_read_b128 a[148:151], v3 offset:9216
    ds_read_b128 a[136:139], v4 offset:8192
    ds_read_b128 a[152:155], v4 offset:9216
    ds_read_b128 a[140:143], v5 offset:8192
    ds_read_b128 a[156:159], v5 offset:9216
    s_nop 7
    s_waitcnt lgkmcnt(0)
    v_mfma_f32_16x16x32_bf16 v[160:163], a[128:131], v[64:67], v[224:227]
    s_waitcnt vmcnt(8)
    s_barrier
    v_exp_f32 v128, v128
    v_mfma_f32_16x16x32_bf16 v[164:167], a[144:147], v[64:67], v[224:227]
    v_mfma_f32_16x16x32_bf16 v[168:171], a[128:131], v[80:83], v[228:231]
    v_exp_f32 v129, v129
    v_mfma_f32_16x16x32_bf16 v[172:175], a[144:147], v[80:83], v[228:231]
    v_cvt_pk_bf16_f32 v192, v128, v129
    v_mfma_f32_16x16x32_bf16 v[176:179], a[128:131], v[96:99], v[232:235]
    v_exp_f32 v130, v130
    v_mfma_f32_16x16x32_bf16 v[180:183], a[144:147], v[96:99], v[232:235]
    v_mfma_f32_16x16x32_bf16 v[184:187], a[128:131], v[112:115], v[236:239]
    v_exp_f32 v131, v131
    v_mfma_f32_16x16x32_bf16 v[188:191], a[144:147], v[112:115], v[236:239]
    v_cvt_pk_bf16_f32 v193, v130, v131
    v_mfma_f32_16x16x32_bf16 v[160:163], a[132:135], v[68:71], v[160:163]
    v_exp_f32 v132, v132
    v_mfma_f32_16x16x32_bf16 v[164:167], a[148:151], v[68:71], v[164:167]
    v_mfma_f32_16x16x32_bf16 v[168:171], a[132:135], v[84:87], v[168:171]
    v_exp_f32 v133, v133
    v_mfma_f32_16x16x32_bf16 v[172:175], a[148:151], v[84:87], v[172:175]
    v_cvt_pk_bf16_f32 v194, v132, v133
    v_mfma_f32_16x16x32_bf16 v[176:179], a[132:135], v[100:103], v[176:179]
    v_exp_f32 v134, v134
    v_mfma_f32_16x16x32_bf16 v[180:183], a[148:151], v[100:103], v[180:183]
    v_mfma_f32_16x16x32_bf16 v[184:187], a[132:135], v[116:119], v[184:187]
    v_exp_f32 v135, v135
    v_mfma_f32_16x16x32_bf16 v[188:191], a[148:151], v[116:119], v[188:191]
    v_cvt_pk_bf16_f32 v195, v134, v135
    v_mfma_f32_16x16x32_bf16 v[160:163], a[136:139], v[72:75], v[160:163]
    v_exp_f32 v136, v136
    v_mfma_f32_16x16x32_bf16 v[164:167], a[152:155], v[72:75], v[164:167]
    v_mfma_f32_16x16x32_bf16 v[168:171], a[136:139], v[88:91], v[168:171]
    v_exp_f32 v137, v137
    v_mfma_f32_16x16x32_bf16 v[172:175], a[152:155], v[88:91], v[172:175]
    v_cvt_pk_bf16_f32 v196, v136, v137
    v_mfma_f32_16x16x32_bf16 v[176:179], a[136:139], v[104:107], v[176:179]
    v_exp_f32 v138, v138
    v_mfma_f32_16x16x32_bf16 v[180:183], a[152:155], v[104:107], v[180:183]
    v_mfma_f32_16x16x32_bf16 v[184:187], a[136:139], v[120:123], v[184:187]
    v_exp_f32 v139, v139
    v_mfma_f32_16x16x32_bf16 v[188:191], a[152:155], v[120:123], v[188:191]
    v_cvt_pk_bf16_f32 v197, v138, v139
    v_mfma_f32_16x16x32_bf16 v[160:163], a[140:143], v[76:79], v[160:163]
    v_exp_f32 v140, v140
    v_mfma_f32_16x16x32_bf16 v[164:167], a[156:159], v[76:79], v[164:167]
    v_mfma_f32_16x16x32_bf16 v[168:171], a[140:143], v[92:95], v[168:171]
    v_exp_f32 v141, v141
    v_mfma_f32_16x16x32_bf16 v[172:175], a[156:159], v[92:95], v[172:175]
    v_cvt_pk_bf16_f32 v198, v140, v141
    v_mfma_f32_16x16x32_bf16 v[176:179], a[140:143], v[108:111], v[176:179]
    v_exp_f32 v142, v142
    v_mfma_f32_16x16x32_bf16 v[180:183], a[156:159], v[108:111], v[180:183]
    v_mfma_f32_16x16x32_bf16 v[184:187], a[140:143], v[124:127], v[184:187]
    v_exp_f32 v143, v143
    v_mfma_f32_16x16x32_bf16 v[188:191], a[156:159], v[124:127], v[188:191]
    v_cvt_pk_bf16_f32 v199, v142, v143
    v_exp_f32 v144, v144
    v_exp_f32 v145, v145
    s_nop 0
    v_cvt_pk_bf16_f32 v200, v144, v145
    v_exp_f32 v146, v146
    s_add_u32 m0, s43, 49152
    buffer_load_dwordx4 v22, s[4:7], s46 offen offset:0 lds
    v_exp_f32 v147, v147
    s_nop 0
    v_cvt_pk_bf16_f32 v201, v146, v147
    ds_read_b128 a[128:131], v2 offset:16384
    ds_read_b128 a[144:147], v2 offset:17408
    v_exp_f32 v148, v148
    buffer_load_dwordx4 v22, s[4:7], s46 offen offset:1024 lds
    v_exp_f32 v149, v149
    s_nop 0
    v_cvt_pk_bf16_f32 v202, v148, v149
    v_exp_f32 v150, v150
    buffer_load_dwordx4 v23, s[4:7], s46 offen offset:2048 lds
    v_exp_f32 v151, v151
    s_nop 0
    v_cvt_pk_bf16_f32 v203, v150, v151
    ds_read_b128 a[132:135], v3 offset:16384
    ds_read_b128 a[148:151], v3 offset:17408
    v_exp_f32 v152, v152
    buffer_load_dwordx4 v23, s[4:7], s46 offen offset:3072 lds
    s_add_u32 s46, s46, 16384
    v_exp_f32 v153, v153
    s_nop 0
    v_cvt_pk_bf16_f32 v204, v152, v153
    v_exp_f32 v154, v154
    v_exp_f32 v155, v155
    s_nop 0
    v_cvt_pk_bf16_f32 v205, v154, v155
    ds_read_b128 a[136:139], v4 offset:16384
    ds_read_b128 a[152:155], v4 offset:17408
    v_exp_f32 v156, v156
    v_exp_f32 v157, v157
    s_nop 0
    v_cvt_pk_bf16_f32 v206, v156, v157
    v_exp_f32 v158, v158
    v_exp_f32 v159, v159
    s_nop 0
    v_cvt_pk_bf16_f32 v207, v158, v159
    ds_read_b128 a[140:143], v5 offset:16384
    ds_read_b128 a[156:159], v5 offset:17408
    s_waitcnt lgkmcnt(2)
    v_mfma_f32_16x16x32_bf16 v[128:131], a[128:131], v[64:67], v[224:227]
    v_exp_f32 v160, v160
    v_mfma_f32_16x16x32_bf16 v[132:135], a[144:147], v[64:67], v[224:227]
    ds_read_b64_tr_b16 a[160:161], v6 offset:32768
    ds_read_b64_tr_b16 a[162:163], v6 offset:33792
    v_mfma_f32_16x16x32_bf16 v[136:139], a[128:131], v[80:83], v[228:231]
    v_exp_f32 v161, v161
    v_mfma_f32_16x16x32_bf16 v[140:143], a[144:147], v[80:83], v[228:231]
    v_cvt_pk_bf16_f32 v208, v160, v161
    v_mfma_f32_16x16x32_bf16 v[144:147], a[128:131], v[96:99], v[232:235]
    v_exp_f32 v162, v162
    v_mfma_f32_16x16x32_bf16 v[148:151], a[144:147], v[96:99], v[232:235]
    ds_read_b64_tr_b16 a[164:165], v7 offset:32768
    ds_read_b64_tr_b16 a[166:167], v7 offset:33792
    v_mfma_f32_16x16x32_bf16 v[152:155], a[128:131], v[112:115], v[236:239]
    v_exp_f32 v163, v163
    v_mfma_f32_16x16x32_bf16 v[156:159], a[144:147], v[112:115], v[236:239]
    v_cvt_pk_bf16_f32 v209, v162, v163
    v_mfma_f32_16x16x32_bf16 v[128:131], a[132:135], v[68:71], v[128:131]
    v_exp_f32 v164, v164
    v_mfma_f32_16x16x32_bf16 v[132:135], a[148:151], v[68:71], v[132:135]
    ds_read_b64_tr_b16 a[168:169], v8 offset:32768
    ds_read_b64_tr_b16 a[170:171], v8 offset:33792
    v_mfma_f32_16x16x32_bf16 v[136:139], a[132:135], v[84:87], v[136:139]
    v_exp_f32 v165, v165
    v_mfma_f32_16x16x32_bf16 v[140:143], a[148:151], v[84:87], v[140:143]
    v_cvt_pk_bf16_f32 v210, v164, v165
    v_mfma_f32_16x16x32_bf16 v[144:147], a[132:135], v[100:103], v[144:147]
    v_exp_f32 v166, v166
    v_mfma_f32_16x16x32_bf16 v[148:151], a[148:151], v[100:103], v[148:151]
    ds_read_b64_tr_b16 a[172:173], v9 offset:32768
    ds_read_b64_tr_b16 a[174:175], v9 offset:33792
    v_mfma_f32_16x16x32_bf16 v[152:155], a[132:135], v[116:119], v[152:155]
    v_exp_f32 v167, v167
    v_mfma_f32_16x16x32_bf16 v[156:159], a[148:151], v[116:119], v[156:159]
    v_cvt_pk_bf16_f32 v211, v166, v167
    v_mfma_f32_16x16x32_bf16 v[128:131], a[136:139], v[72:75], v[128:131]
    v_exp_f32 v168, v168
    v_mfma_f32_16x16x32_bf16 v[132:135], a[152:155], v[72:75], v[132:135]
    ds_read_b64_tr_b16 a[176:177], v10 offset:32768
    ds_read_b64_tr_b16 a[178:179], v10 offset:33792
    v_mfma_f32_16x16x32_bf16 v[136:139], a[136:139], v[88:91], v[136:139]
    v_exp_f32 v169, v169
    v_mfma_f32_16x16x32_bf16 v[140:143], a[152:155], v[88:91], v[140:143]
    v_cvt_pk_bf16_f32 v212, v168, v169
    v_mfma_f32_16x16x32_bf16 v[144:147], a[136:139], v[104:107], v[144:147]
    v_exp_f32 v170, v170
    v_mfma_f32_16x16x32_bf16 v[148:151], a[152:155], v[104:107], v[148:151]
    ds_read_b64_tr_b16 a[180:181], v11 offset:32768
    ds_read_b64_tr_b16 a[182:183], v11 offset:33792
    v_mfma_f32_16x16x32_bf16 v[152:155], a[136:139], v[120:123], v[152:155]
    v_exp_f32 v171, v171
    v_mfma_f32_16x16x32_bf16 v[156:159], a[152:155], v[120:123], v[156:159]
    v_cvt_pk_bf16_f32 v213, v170, v171
    s_waitcnt lgkmcnt(2)
    v_mfma_f32_16x16x32_bf16 v[128:131], a[140:143], v[76:79], v[128:131]
    v_exp_f32 v172, v172
    v_mfma_f32_16x16x32_bf16 v[132:135], a[156:159], v[76:79], v[132:135]
    ds_read_b64_tr_b16 a[184:185], v12 offset:32768
    ds_read_b64_tr_b16 a[186:187], v12 offset:33792
    v_mfma_f32_16x16x32_bf16 v[136:139], a[140:143], v[92:95], v[136:139]
    v_exp_f32 v173, v173
    v_mfma_f32_16x16x32_bf16 v[140:143], a[156:159], v[92:95], v[140:143]
    v_cvt_pk_bf16_f32 v214, v172, v173
    v_mfma_f32_16x16x32_bf16 v[144:147], a[140:143], v[108:111], v[144:147]
    v_exp_f32 v174, v174
    v_mfma_f32_16x16x32_bf16 v[148:151], a[156:159], v[108:111], v[148:151]
    ds_read_b64_tr_b16 a[188:189], v13 offset:32768
    ds_read_b64_tr_b16 a[190:191], v13 offset:33792
    v_mfma_f32_16x16x32_bf16 v[152:155], a[140:143], v[124:127], v[152:155]
    v_exp_f32 v175, v175
    v_mfma_f32_16x16x32_bf16 v[156:159], a[156:159], v[124:127], v[156:159]
    v_cvt_pk_bf16_f32 v215, v174, v175
    v_mfma_f32_16x16x32_bf16 a[0:3], a[160:163], v[192:195], 0
    v_exp_f32 v176, v176
    v_mfma_f32_16x16x32_bf16 a[16:19], a[164:167], v[192:195], 0
    v_mfma_f32_16x16x32_bf16 a[32:35], a[168:171], v[192:195], 0
    v_exp_f32 v177, v177
    v_mfma_f32_16x16x32_bf16 a[48:51], a[172:175], v[192:195], 0
    v_cvt_pk_bf16_f32 v216, v176, v177
    v_mfma_f32_16x16x32_bf16 a[64:67], a[176:179], v[192:195], 0
    v_exp_f32 v178, v178
    s_add_u32 m0, s51, 0
    s_waitcnt lgkmcnt(0)
    v_mfma_f32_16x16x32_bf16 a[80:83], a[180:183], v[192:195], 0
    buffer_load_dwordx4 v24, s[8:11], s47 offen offset:0 lds
    v_mfma_f32_16x16x32_bf16 a[96:99], a[184:187], v[192:195], 0
    v_exp_f32 v179, v179
    v_mfma_f32_16x16x32_bf16 a[112:115], a[188:191], v[192:195], 0
    v_cvt_pk_bf16_f32 v217, v178, v179
    v_mfma_f32_16x16x32_bf16 a[192:195], a[208:211], v[192:195], 0
    ds_read_b128 a[128:131], v2 offset:24576
    ds_read_b128 a[144:147], v2 offset:25600
    v_mfma_f32_16x16x32_bf16 a[4:7], a[160:163], v[196:199], 0
    v_exp_f32 v180, v180
    v_mfma_f32_16x16x32_bf16 a[20:23], a[164:167], v[196:199], 0
    buffer_load_dwordx4 v24, s[8:11], s47 offen offset:1024 lds
    v_mfma_f32_16x16x32_bf16 a[36:39], a[168:171], v[196:199], 0
    v_exp_f32 v181, v181
    v_mfma_f32_16x16x32_bf16 a[52:55], a[172:175], v[196:199], 0
    v_cvt_pk_bf16_f32 v218, v180, v181
    v_mfma_f32_16x16x32_bf16 a[68:71], a[176:179], v[196:199], 0
    v_exp_f32 v182, v182
    v_mfma_f32_16x16x32_bf16 a[84:87], a[180:183], v[196:199], 0
    buffer_load_dwordx4 v25, s[8:11], s47 offen offset:2048 lds
    v_mfma_f32_16x16x32_bf16 a[100:103], a[184:187], v[196:199], 0
    v_exp_f32 v183, v183
    v_mfma_f32_16x16x32_bf16 a[116:119], a[188:191], v[196:199], 0
    v_cvt_pk_bf16_f32 v219, v182, v183
    v_mfma_f32_16x16x32_bf16 a[196:199], a[208:211], v[196:199], 0
    ds_read_b128 a[132:135], v3 offset:24576
    ds_read_b128 a[148:151], v3 offset:25600
    v_mfma_f32_16x16x32_bf16 a[8:11], a[160:163], v[200:203], 0
    v_exp_f32 v184, v184
    v_mfma_f32_16x16x32_bf16 a[24:27], a[164:167], v[200:203], 0
    buffer_load_dwordx4 v25, s[8:11], s47 offen offset:3072 lds
    s_add_u32 s47, s47, 16384
    v_mfma_f32_16x16x32_bf16 a[40:43], a[168:171], v[200:203], 0
    v_exp_f32 v185, v185
    v_mfma_f32_16x16x32_bf16 a[56:59], a[172:175], v[200:203], 0
    v_cvt_pk_bf16_f32 v220, v184, v185
    buffer_load_dword v56, v59, s[12:15], s56 offen
    v_mfma_f32_16x16x32_bf16 a[72:75], a[176:179], v[200:203], 0
    v_exp_f32 v186, v186
    v_mfma_f32_16x16x32_bf16 a[88:91], a[180:183], v[200:203], 0
    v_mfma_f32_16x16x32_bf16 a[104:107], a[184:187], v[200:203], 0
    v_exp_f32 v187, v187
    v_mfma_f32_16x16x32_bf16 a[120:123], a[188:191], v[200:203], 0
    v_cvt_pk_bf16_f32 v221, v186, v187
    v_mfma_f32_16x16x32_bf16 a[200:203], a[208:211], v[200:203], 0
    ds_read_b128 a[136:139], v4 offset:24576
    ds_read_b128 a[152:155], v4 offset:25600
    v_mfma_f32_16x16x32_bf16 a[12:15], a[160:163], v[204:207], 0
    v_exp_f32 v188, v188
    v_mfma_f32_16x16x32_bf16 a[28:31], a[164:167], v[204:207], 0
    v_mfma_f32_16x16x32_bf16 a[44:47], a[168:171], v[204:207], 0
    v_exp_f32 v189, v189
    v_mfma_f32_16x16x32_bf16 a[60:63], a[172:175], v[204:207], 0
    v_cvt_pk_bf16_f32 v222, v188, v189
    v_mfma_f32_16x16x32_bf16 a[76:79], a[176:179], v[204:207], 0
    v_exp_f32 v190, v190
    v_mfma_f32_16x16x32_bf16 a[92:95], a[180:183], v[204:207], 0
    v_mfma_f32_16x16x32_bf16 a[108:111], a[184:187], v[204:207], 0
    v_exp_f32 v191, v191
    v_mfma_f32_16x16x32_bf16 a[124:127], a[188:191], v[204:207], 0
    v_cvt_pk_bf16_f32 v223, v190, v191
    v_mfma_f32_16x16x32_bf16 a[204:207], a[208:211], v[204:207], 0
    ds_read_b128 a[140:143], v5 offset:24576
    ds_read_b128 a[156:159], v5 offset:25600
    s_waitcnt lgkmcnt(2)
    v_mfma_f32_16x16x32_bf16 v[160:163], a[128:131], v[64:67], v[224:227]
    s_waitcnt vmcnt(9)
    s_barrier
    v_exp_f32 v128, v128
    v_mfma_f32_16x16x32_bf16 v[164:167], a[144:147], v[64:67], v[224:227]
    ds_read_b64_tr_b16 a[160:161], v6 offset:40960
    ds_read_b64_tr_b16 a[162:163], v6 offset:41984
    v_mfma_f32_16x16x32_bf16 v[168:171], a[128:131], v[80:83], v[228:231]
    v_exp_f32 v129, v129
    v_mfma_f32_16x16x32_bf16 v[172:175], a[144:147], v[80:83], v[228:231]
    v_cvt_pk_bf16_f32 v192, v128, v129
    v_mfma_f32_16x16x32_bf16 v[176:179], a[128:131], v[96:99], v[232:235]
    v_exp_f32 v130, v130
    v_mfma_f32_16x16x32_bf16 v[180:183], a[144:147], v[96:99], v[232:235]
    ds_read_b64_tr_b16 a[164:165], v7 offset:40960
    ds_read_b64_tr_b16 a[166:167], v7 offset:41984
    v_mfma_f32_16x16x32_bf16 v[184:187], a[128:131], v[112:115], v[236:239]
    v_exp_f32 v131, v131
    v_mfma_f32_16x16x32_bf16 v[188:191], a[144:147], v[112:115], v[236:239]
    v_cvt_pk_bf16_f32 v193, v130, v131
    v_mfma_f32_16x16x32_bf16 v[160:163], a[132:135], v[68:71], v[160:163]
    v_exp_f32 v132, v132
    v_mfma_f32_16x16x32_bf16 v[164:167], a[148:151], v[68:71], v[164:167]
    ds_read_b64_tr_b16 a[168:169], v8 offset:40960
    ds_read_b64_tr_b16 a[170:171], v8 offset:41984
    v_mfma_f32_16x16x32_bf16 v[168:171], a[132:135], v[84:87], v[168:171]
    v_exp_f32 v133, v133
    v_mfma_f32_16x16x32_bf16 v[172:175], a[148:151], v[84:87], v[172:175]
    v_cvt_pk_bf16_f32 v194, v132, v133
    v_mfma_f32_16x16x32_bf16 v[176:179], a[132:135], v[100:103], v[176:179]
    v_exp_f32 v134, v134
    v_mfma_f32_16x16x32_bf16 v[180:183], a[148:151], v[100:103], v[180:183]
    ds_read_b64_tr_b16 a[172:173], v9 offset:40960
    ds_read_b64_tr_b16 a[174:175], v9 offset:41984
    v_mfma_f32_16x16x32_bf16 v[184:187], a[132:135], v[116:119], v[184:187]
    v_exp_f32 v135, v135
    v_mfma_f32_16x16x32_bf16 v[188:191], a[148:151], v[116:119], v[188:191]
    v_cvt_pk_bf16_f32 v195, v134, v135
    v_mfma_f32_16x16x32_bf16 v[160:163], a[136:139], v[72:75], v[160:163]
    v_exp_f32 v136, v136
    v_mfma_f32_16x16x32_bf16 v[164:167], a[152:155], v[72:75], v[164:167]
    ds_read_b64_tr_b16 a[176:177], v10 offset:40960
    ds_read_b64_tr_b16 a[178:179], v10 offset:41984
    v_mfma_f32_16x16x32_bf16 v[168:171], a[136:139], v[88:91], v[168:171]
    v_exp_f32 v137, v137
    v_mfma_f32_16x16x32_bf16 v[172:175], a[152:155], v[88:91], v[172:175]
    v_cvt_pk_bf16_f32 v196, v136, v137
    v_mfma_f32_16x16x32_bf16 v[176:179], a[136:139], v[104:107], v[176:179]
    v_exp_f32 v138, v138
    v_mfma_f32_16x16x32_bf16 v[180:183], a[152:155], v[104:107], v[180:183]
    ds_read_b64_tr_b16 a[180:181], v11 offset:40960
    ds_read_b64_tr_b16 a[182:183], v11 offset:41984
    v_mfma_f32_16x16x32_bf16 v[184:187], a[136:139], v[120:123], v[184:187]
    v_exp_f32 v139, v139
    v_mfma_f32_16x16x32_bf16 v[188:191], a[152:155], v[120:123], v[188:191]
    v_cvt_pk_bf16_f32 v197, v138, v139
    s_waitcnt lgkmcnt(2)
    v_mfma_f32_16x16x32_bf16 v[160:163], a[140:143], v[76:79], v[160:163]
    v_exp_f32 v140, v140
    v_mfma_f32_16x16x32_bf16 v[164:167], a[156:159], v[76:79], v[164:167]
    ds_read_b64_tr_b16 a[184:185], v12 offset:40960
    ds_read_b64_tr_b16 a[186:187], v12 offset:41984
    v_mfma_f32_16x16x32_bf16 v[168:171], a[140:143], v[92:95], v[168:171]
    v_exp_f32 v141, v141
    v_mfma_f32_16x16x32_bf16 v[172:175], a[156:159], v[92:95], v[172:175]
    v_cvt_pk_bf16_f32 v198, v140, v141
    v_mfma_f32_16x16x32_bf16 v[176:179], a[140:143], v[108:111], v[176:179]
    v_exp_f32 v142, v142
    v_mfma_f32_16x16x32_bf16 v[180:183], a[156:159], v[108:111], v[180:183]
    ds_read_b64_tr_b16 a[188:189], v13 offset:40960
    ds_read_b64_tr_b16 a[190:191], v13 offset:41984
    v_mfma_f32_16x16x32_bf16 v[184:187], a[140:143], v[124:127], v[184:187]
    v_exp_f32 v143, v143
    v_mfma_f32_16x16x32_bf16 v[188:191], a[156:159], v[124:127], v[188:191]
    v_cvt_pk_bf16_f32 v199, v142, v143
    v_mfma_f32_16x16x32_bf16 a[0:3], a[160:163], v[208:211], a[0:3]
    v_exp_f32 v144, v144
    v_mfma_f32_16x16x32_bf16 a[16:19], a[164:167], v[208:211], a[16:19]
    v_mfma_f32_16x16x32_bf16 a[32:35], a[168:171], v[208:211], a[32:35]
    v_exp_f32 v145, v145
    v_mfma_f32_16x16x32_bf16 a[48:51], a[172:175], v[208:211], a[48:51]
    v_cvt_pk_bf16_f32 v200, v144, v145
    v_mfma_f32_16x16x32_bf16 a[64:67], a[176:179], v[208:211], a[64:67]
    v_exp_f32 v146, v146
    s_add_u32 m0, s43, 0
    s_waitcnt lgkmcnt(0)
    v_mfma_f32_16x16x32_bf16 a[80:83], a[180:183], v[208:211], a[80:83]
    buffer_load_dwordx4 v22, s[4:7], s46 offen offset:0 lds
    v_mfma_f32_16x16x32_bf16 a[96:99], a[184:187], v[208:211], a[96:99]
    v_exp_f32 v147, v147
    v_mfma_f32_16x16x32_bf16 a[112:115], a[188:191], v[208:211], a[112:115]
    v_cvt_pk_bf16_f32 v201, v146, v147
    v_mfma_f32_16x16x32_bf16 a[192:195], a[208:211], v[208:211], a[192:195]
    ds_read_b128 a[128:131], v2 offset:32768
    ds_read_b128 a[144:147], v2 offset:33792
    v_mfma_f32_16x16x32_bf16 a[4:7], a[160:163], v[212:215], a[4:7]
    v_exp_f32 v148, v148
    v_mfma_f32_16x16x32_bf16 a[20:23], a[164:167], v[212:215], a[20:23]
    buffer_load_dwordx4 v22, s[4:7], s46 offen offset:1024 lds
    v_mfma_f32_16x16x32_bf16 a[36:39], a[168:171], v[212:215], a[36:39]
    v_exp_f32 v149, v149
    v_mfma_f32_16x16x32_bf16 a[52:55], a[172:175], v[212:215], a[52:55]
    v_cvt_pk_bf16_f32 v202, v148, v149
    v_mfma_f32_16x16x32_bf16 a[68:71], a[176:179], v[212:215], a[68:71]
    v_exp_f32 v150, v150
    v_mfma_f32_16x16x32_bf16 a[84:87], a[180:183], v[212:215], a[84:87]
    buffer_load_dwordx4 v23, s[4:7], s46 offen offset:2048 lds
    v_mfma_f32_16x16x32_bf16 a[100:103], a[184:187], v[212:215], a[100:103]
    v_exp_f32 v151, v151
    v_mfma_f32_16x16x32_bf16 a[116:119], a[188:191], v[212:215], a[116:119]
    v_cvt_pk_bf16_f32 v203, v150, v151
    v_mfma_f32_16x16x32_bf16 a[196:199], a[208:211], v[212:215], a[196:199]
    ds_read_b128 a[132:135], v3 offset:32768
    ds_read_b128 a[148:151], v3 offset:33792
    v_mfma_f32_16x16x32_bf16 a[8:11], a[160:163], v[216:219], a[8:11]
    v_exp_f32 v152, v152
    v_mfma_f32_16x16x32_bf16 a[24:27], a[164:167], v[216:219], a[24:27]
    buffer_load_dwordx4 v23, s[4:7], s46 offen offset:3072 lds
    s_add_u32 s46, s46, 16384
    v_mfma_f32_16x16x32_bf16 a[40:43], a[168:171], v[216:219], a[40:43]
    v_exp_f32 v153, v153
    v_mfma_f32_16x16x32_bf16 a[56:59], a[172:175], v[216:219], a[56:59]
    v_cvt_pk_bf16_f32 v204, v152, v153
    v_mfma_f32_16x16x32_bf16 a[72:75], a[176:179], v[216:219], a[72:75]
    v_exp_f32 v154, v154
    v_mfma_f32_16x16x32_bf16 a[88:91], a[180:183], v[216:219], a[88:91]
    v_mfma_f32_16x16x32_bf16 a[104:107], a[184:187], v[216:219], a[104:107]
    v_exp_f32 v155, v155
    v_mfma_f32_16x16x32_bf16 a[120:123], a[188:191], v[216:219], a[120:123]
    v_cvt_pk_bf16_f32 v205, v154, v155
    v_mfma_f32_16x16x32_bf16 a[200:203], a[208:211], v[216:219], a[200:203]
    ds_read_b128 a[136:139], v4 offset:32768
    ds_read_b128 a[152:155], v4 offset:33792
    v_mfma_f32_16x16x32_bf16 a[12:15], a[160:163], v[220:223], a[12:15]
    v_exp_f32 v156, v156
    v_mfma_f32_16x16x32_bf16 a[28:31], a[164:167], v[220:223], a[28:31]
    v_mfma_f32_16x16x32_bf16 a[44:47], a[168:171], v[220:223], a[44:47]
    v_exp_f32 v157, v157
    v_mfma_f32_16x16x32_bf16 a[60:63], a[172:175], v[220:223], a[60:63]
    v_cvt_pk_bf16_f32 v206, v156, v157
    v_mfma_f32_16x16x32_bf16 a[76:79], a[176:179], v[220:223], a[76:79]
    v_exp_f32 v158, v158
    v_mfma_f32_16x16x32_bf16 a[92:95], a[180:183], v[220:223], a[92:95]
    v_mfma_f32_16x16x32_bf16 a[108:111], a[184:187], v[220:223], a[108:111]
    v_exp_f32 v159, v159
    v_mfma_f32_16x16x32_bf16 a[124:127], a[188:191], v[220:223], a[124:127]
    v_cvt_pk_bf16_f32 v207, v158, v159
    v_mfma_f32_16x16x32_bf16 a[204:207], a[208:211], v[220:223], a[204:207]
    ds_read_b128 a[140:143], v5 offset:32768
    ds_read_b128 a[156:159], v5 offset:33792
    s_waitcnt lgkmcnt(2)
    v_mfma_f32_16x16x32_bf16 v[128:131], a[128:131], v[64:67], v[224:227]
    v_exp_f32 v160, v160
    v_mfma_f32_16x16x32_bf16 v[132:135], a[144:147], v[64:67], v[224:227]
    ds_read_b64_tr_b16 a[160:161], v6 offset:49152
    ds_read_b64_tr_b16 a[162:163], v6 offset:50176
    v_mfma_f32_16x16x32_bf16 v[136:139], a[128:131], v[80:83], v[228:231]
    v_exp_f32 v161, v161
    v_mfma_f32_16x16x32_bf16 v[140:143], a[144:147], v[80:83], v[228:231]
    v_cvt_pk_bf16_f32 v208, v160, v161
    v_mfma_f32_16x16x32_bf16 v[144:147], a[128:131], v[96:99], v[232:235]
    v_exp_f32 v162, v162
    v_mfma_f32_16x16x32_bf16 v[148:151], a[144:147], v[96:99], v[232:235]
    ds_read_b64_tr_b16 a[164:165], v7 offset:49152
    ds_read_b64_tr_b16 a[166:167], v7 offset:50176
    v_mfma_f32_16x16x32_bf16 v[152:155], a[128:131], v[112:115], v[236:239]
    v_exp_f32 v163, v163
    v_mfma_f32_16x16x32_bf16 v[156:159], a[144:147], v[112:115], v[236:239]
    v_cvt_pk_bf16_f32 v209, v162, v163
    v_mfma_f32_16x16x32_bf16 v[128:131], a[132:135], v[68:71], v[128:131]
    v_exp_f32 v164, v164
    v_mfma_f32_16x16x32_bf16 v[132:135], a[148:151], v[68:71], v[132:135]
    ds_read_b64_tr_b16 a[168:169], v8 offset:49152
    ds_read_b64_tr_b16 a[170:171], v8 offset:50176
    v_mfma_f32_16x16x32_bf16 v[136:139], a[132:135], v[84:87], v[136:139]
    v_exp_f32 v165, v165
    v_mfma_f32_16x16x32_bf16 v[140:143], a[148:151], v[84:87], v[140:143]
    v_cvt_pk_bf16_f32 v210, v164, v165
    v_mfma_f32_16x16x32_bf16 v[144:147], a[132:135], v[100:103], v[144:147]
    v_exp_f32 v166, v166
    v_mfma_f32_16x16x32_bf16 v[148:151], a[148:151], v[100:103], v[148:151]
    ds_read_b64_tr_b16 a[172:173], v9 offset:49152
    ds_read_b64_tr_b16 a[174:175], v9 offset:50176
    v_mfma_f32_16x16x32_bf16 v[152:155], a[132:135], v[116:119], v[152:155]
    v_exp_f32 v167, v167
    v_mfma_f32_16x16x32_bf16 v[156:159], a[148:151], v[116:119], v[156:159]
    v_cvt_pk_bf16_f32 v211, v166, v167
    v_mfma_f32_16x16x32_bf16 v[128:131], a[136:139], v[72:75], v[128:131]
    v_exp_f32 v168, v168
    v_mfma_f32_16x16x32_bf16 v[132:135], a[152:155], v[72:75], v[132:135]
    ds_read_b64_tr_b16 a[176:177], v10 offset:49152
    ds_read_b64_tr_b16 a[178:179], v10 offset:50176
    v_mfma_f32_16x16x32_bf16 v[136:139], a[136:139], v[88:91], v[136:139]
    v_exp_f32 v169, v169
    v_mfma_f32_16x16x32_bf16 v[140:143], a[152:155], v[88:91], v[140:143]
    v_cvt_pk_bf16_f32 v212, v168, v169
    v_mfma_f32_16x16x32_bf16 v[144:147], a[136:139], v[104:107], v[144:147]
    v_exp_f32 v170, v170
    v_mfma_f32_16x16x32_bf16 v[148:151], a[152:155], v[104:107], v[148:151]
    ds_read_b64_tr_b16 a[180:181], v11 offset:49152
    ds_read_b64_tr_b16 a[182:183], v11 offset:50176
    v_mfma_f32_16x16x32_bf16 v[152:155], a[136:139], v[120:123], v[152:155]
    v_exp_f32 v171, v171
    v_mfma_f32_16x16x32_bf16 v[156:159], a[152:155], v[120:123], v[156:159]
    v_cvt_pk_bf16_f32 v213, v170, v171
    s_waitcnt lgkmcnt(2)
    v_mfma_f32_16x16x32_bf16 v[128:131], a[140:143], v[76:79], v[128:131]
    v_exp_f32 v172, v172
    v_mfma_f32_16x16x32_bf16 v[132:135], a[156:159], v[76:79], v[132:135]
    ds_read_b64_tr_b16 a[184:185], v12 offset:49152
    ds_read_b64_tr_b16 a[186:187], v12 offset:50176
    v_mfma_f32_16x16x32_bf16 v[136:139], a[140:143], v[92:95], v[136:139]
    v_exp_f32 v173, v173
    v_mfma_f32_16x16x32_bf16 v[140:143], a[156:159], v[92:95], v[140:143]
    v_cvt_pk_bf16_f32 v214, v172, v173
    v_mfma_f32_16x16x32_bf16 v[144:147], a[140:143], v[108:111], v[144:147]
    v_exp_f32 v174, v174
    v_mfma_f32_16x16x32_bf16 v[148:151], a[156:159], v[108:111], v[148:151]
    ds_read_b64_tr_b16 a[188:189], v13 offset:49152
    ds_read_b64_tr_b16 a[190:191], v13 offset:50176
    v_mfma_f32_16x16x32_bf16 v[152:155], a[140:143], v[124:127], v[152:155]
    v_exp_f32 v175, v175
    v_mfma_f32_16x16x32_bf16 v[156:159], a[156:159], v[124:127], v[156:159]
    v_cvt_pk_bf16_f32 v215, v174, v175
    v_mfma_f32_16x16x32_bf16 a[0:3], a[160:163], v[192:195], a[0:3]
    v_exp_f32 v176, v176
    v_mfma_f32_16x16x32_bf16 a[16:19], a[164:167], v[192:195], a[16:19]
    v_mfma_f32_16x16x32_bf16 a[32:35], a[168:171], v[192:195], a[32:35]
    v_exp_f32 v177, v177
    v_mfma_f32_16x16x32_bf16 a[48:51], a[172:175], v[192:195], a[48:51]
    v_cvt_pk_bf16_f32 v216, v176, v177
    v_mfma_f32_16x16x32_bf16 a[64:67], a[176:179], v[192:195], a[64:67]
    v_exp_f32 v178, v178
    s_add_u32 m0, s51, 16384
    s_waitcnt lgkmcnt(0)
    v_mfma_f32_16x16x32_bf16 a[80:83], a[180:183], v[192:195], a[80:83]
    buffer_load_dwordx4 v24, s[8:11], s47 offen offset:0 lds
    v_mfma_f32_16x16x32_bf16 a[96:99], a[184:187], v[192:195], a[96:99]
    v_exp_f32 v179, v179
    v_mfma_f32_16x16x32_bf16 a[112:115], a[188:191], v[192:195], a[112:115]
    v_cvt_pk_bf16_f32 v217, v178, v179
    v_mfma_f32_16x16x32_bf16 a[192:195], a[208:211], v[192:195], a[192:195]
    ds_read_b128 a[128:131], v2 offset:40960
    ds_read_b128 a[144:147], v2 offset:41984
    v_mfma_f32_16x16x32_bf16 a[4:7], a[160:163], v[196:199], a[4:7]
    v_exp_f32 v180, v180
    v_mfma_f32_16x16x32_bf16 a[20:23], a[164:167], v[196:199], a[20:23]
    buffer_load_dwordx4 v24, s[8:11], s47 offen offset:1024 lds
    v_mfma_f32_16x16x32_bf16 a[36:39], a[168:171], v[196:199], a[36:39]
    v_exp_f32 v181, v181
    v_mfma_f32_16x16x32_bf16 a[52:55], a[172:175], v[196:199], a[52:55]
    v_cvt_pk_bf16_f32 v218, v180, v181
    v_mfma_f32_16x16x32_bf16 a[68:71], a[176:179], v[196:199], a[68:71]
    v_exp_f32 v182, v182
    v_mfma_f32_16x16x32_bf16 a[84:87], a[180:183], v[196:199], a[84:87]
    buffer_load_dwordx4 v25, s[8:11], s47 offen offset:2048 lds
    v_mfma_f32_16x16x32_bf16 a[100:103], a[184:187], v[196:199], a[100:103]
    v_exp_f32 v183, v183
    v_mfma_f32_16x16x32_bf16 a[116:119], a[188:191], v[196:199], a[116:119]
    v_cvt_pk_bf16_f32 v219, v182, v183
    v_mfma_f32_16x16x32_bf16 a[196:199], a[208:211], v[196:199], a[196:199]
    ds_read_b128 a[132:135], v3 offset:40960
    ds_read_b128 a[148:151], v3 offset:41984
    v_mfma_f32_16x16x32_bf16 a[8:11], a[160:163], v[200:203], a[8:11]
    v_exp_f32 v184, v184
    v_mfma_f32_16x16x32_bf16 a[24:27], a[164:167], v[200:203], a[24:27]
    buffer_load_dwordx4 v25, s[8:11], s47 offen offset:3072 lds
    s_add_u32 s47, s47, 16384
    v_mfma_f32_16x16x32_bf16 a[40:43], a[168:171], v[200:203], a[40:43]
    v_exp_f32 v185, v185
    v_mfma_f32_16x16x32_bf16 a[56:59], a[172:175], v[200:203], a[56:59]
    v_cvt_pk_bf16_f32 v220, v184, v185
    buffer_load_dword v57, v59, s[12:15], s57 offen
    v_mfma_f32_16x16x32_bf16 a[72:75], a[176:179], v[200:203], a[72:75]
    v_exp_f32 v186, v186
    v_mfma_f32_16x16x32_bf16 a[88:91], a[180:183], v[200:203], a[88:91]
    v_mfma_f32_16x16x32_bf16 a[104:107], a[184:187], v[200:203], a[104:107]
    v_exp_f32 v187, v187
    v_mfma_f32_16x16x32_bf16 a[120:123], a[188:191], v[200:203], a[120:123]
    v_cvt_pk_bf16_f32 v221, v186, v187
    v_mfma_f32_16x16x32_bf16 a[200:203], a[208:211], v[200:203], a[200:203]
    ds_read_b128 a[136:139], v4 offset:40960
    ds_read_b128 a[152:155], v4 offset:41984
    v_mfma_f32_16x16x32_bf16 a[12:15], a[160:163], v[204:207], a[12:15]
    v_exp_f32 v188, v188
    v_mfma_f32_16x16x32_bf16 a[28:31], a[164:167], v[204:207], a[28:31]
    v_mfma_f32_16x16x32_bf16 a[44:47], a[168:171], v[204:207], a[44:47]
    v_exp_f32 v189, v189
    v_mfma_f32_16x16x32_bf16 a[60:63], a[172:175], v[204:207], a[60:63]
    v_cvt_pk_bf16_f32 v222, v188, v189
    v_mfma_f32_16x16x32_bf16 a[76:79], a[176:179], v[204:207], a[76:79]
    v_exp_f32 v190, v190
    v_mfma_f32_16x16x32_bf16 a[92:95], a[180:183], v[204:207], a[92:95]
    v_mfma_f32_16x16x32_bf16 a[108:111], a[184:187], v[204:207], a[108:111]
    v_exp_f32 v191, v191
    v_mfma_f32_16x16x32_bf16 a[124:127], a[188:191], v[204:207], a[124:127]
    v_cvt_pk_bf16_f32 v223, v190, v191
    v_mfma_f32_16x16x32_bf16 a[204:207], a[208:211], v[204:207], a[204:207]
    ds_read_b128 a[140:143], v5 offset:40960
    ds_read_b128 a[156:159], v5 offset:41984
    s_waitcnt lgkmcnt(2)
    v_mfma_f32_16x16x32_bf16 v[160:163], a[128:131], v[64:67], v[224:227]
    s_waitcnt vmcnt(9)
    s_barrier
    v_exp_f32 v128, v128
    v_mfma_f32_16x16x32_bf16 v[164:167], a[144:147], v[64:67], v[224:227]
    ds_read_b64_tr_b16 a[160:161], v6 offset:57344
    ds_read_b64_tr_b16 a[162:163], v6 offset:58368
    v_mfma_f32_16x16x32_bf16 v[168:171], a[128:131], v[80:83], v[228:231]
    v_exp_f32 v129, v129
    v_mfma_f32_16x16x32_bf16 v[172:175], a[144:147], v[80:83], v[228:231]
    v_cvt_pk_bf16_f32 v192, v128, v129
    v_mfma_f32_16x16x32_bf16 v[176:179], a[128:131], v[96:99], v[232:235]
    v_exp_f32 v130, v130
    v_mfma_f32_16x16x32_bf16 v[180:183], a[144:147], v[96:99], v[232:235]
    ds_read_b64_tr_b16 a[164:165], v7 offset:57344
    ds_read_b64_tr_b16 a[166:167], v7 offset:58368
    v_mfma_f32_16x16x32_bf16 v[184:187], a[128:131], v[112:115], v[236:239]
    v_exp_f32 v131, v131
    v_mfma_f32_16x16x32_bf16 v[188:191], a[144:147], v[112:115], v[236:239]
    v_cvt_pk_bf16_f32 v193, v130, v131
    v_mfma_f32_16x16x32_bf16 v[160:163], a[132:135], v[68:71], v[160:163]
    v_exp_f32 v132, v132
    v_mfma_f32_16x16x32_bf16 v[164:167], a[148:151], v[68:71], v[164:167]
    ds_read_b64_tr_b16 a[168:169], v8 offset:57344
    ds_read_b64_tr_b16 a[170:171], v8 offset:58368
    v_mfma_f32_16x16x32_bf16 v[168:171], a[132:135], v[84:87], v[168:171]
    v_exp_f32 v133, v133
    v_mfma_f32_16x16x32_bf16 v[172:175], a[148:151], v[84:87], v[172:175]
    v_cvt_pk_bf16_f32 v194, v132, v133
    v_mfma_f32_16x16x32_bf16 v[176:179], a[132:135], v[100:103], v[176:179]
    v_exp_f32 v134, v134
    v_mfma_f32_16x16x32_bf16 v[180:183], a[148:151], v[100:103], v[180:183]
    ds_read_b64_tr_b16 a[172:173], v9 offset:57344
    ds_read_b64_tr_b16 a[174:175], v9 offset:58368
    v_mfma_f32_16x16x32_bf16 v[184:187], a[132:135], v[116:119], v[184:187]
    v_exp_f32 v135, v135
    v_mfma_f32_16x16x32_bf16 v[188:191], a[148:151], v[116:119], v[188:191]
    v_cvt_pk_bf16_f32 v195, v134, v135
    v_mfma_f32_16x16x32_bf16 v[160:163], a[136:139], v[72:75], v[160:163]
    v_exp_f32 v136, v136
    v_mfma_f32_16x16x32_bf16 v[164:167], a[152:155], v[72:75], v[164:167]
    ds_read_b64_tr_b16 a[176:177], v10 offset:57344
    ds_read_b64_tr_b16 a[178:179], v10 offset:58368
    v_mfma_f32_16x16x32_bf16 v[168:171], a[136:139], v[88:91], v[168:171]
    v_exp_f32 v137, v137
    v_mfma_f32_16x16x32_bf16 v[172:175], a[152:155], v[88:91], v[172:175]
    v_cvt_pk_bf16_f32 v196, v136, v137
    v_mfma_f32_16x16x32_bf16 v[176:179], a[136:139], v[104:107], v[176:179]
    v_exp_f32 v138, v138
    v_mfma_f32_16x16x32_bf16 v[180:183], a[152:155], v[104:107], v[180:183]
    ds_read_b64_tr_b16 a[180:181], v11 offset:57344
    ds_read_b64_tr_b16 a[182:183], v11 offset:58368
    v_mfma_f32_16x16x32_bf16 v[184:187], a[136:139], v[120:123], v[184:187]
    v_exp_f32 v139, v139
    v_mfma_f32_16x16x32_bf16 v[188:191], a[152:155], v[120:123], v[188:191]
    v_cvt_pk_bf16_f32 v197, v138, v139
    s_waitcnt lgkmcnt(2)
    v_mfma_f32_16x16x32_bf16 v[160:163], a[140:143], v[76:79], v[160:163]
    v_exp_f32 v140, v140
    v_mfma_f32_16x16x32_bf16 v[164:167], a[156:159], v[76:79], v[164:167]
    ds_read_b64_tr_b16 a[184:185], v12 offset:57344
    ds_read_b64_tr_b16 a[186:187], v12 offset:58368
    v_mfma_f32_16x16x32_bf16 v[168:171], a[140:143], v[92:95], v[168:171]
    v_exp_f32 v141, v141
    v_mfma_f32_16x16x32_bf16 v[172:175], a[156:159], v[92:95], v[172:175]
    v_cvt_pk_bf16_f32 v198, v140, v141
    v_mfma_f32_16x16x32_bf16 v[176:179], a[140:143], v[108:111], v[176:179]
    v_exp_f32 v142, v142
    v_mfma_f32_16x16x32_bf16 v[180:183], a[156:159], v[108:111], v[180:183]
    ds_read_b64_tr_b16 a[188:189], v13 offset:57344
    ds_read_b64_tr_b16 a[190:191], v13 offset:58368
    v_mfma_f32_16x16x32_bf16 v[184:187], a[140:143], v[124:127], v[184:187]
    v_exp_f32 v143, v143
    v_mfma_f32_16x16x32_bf16 v[188:191], a[156:159], v[124:127], v[188:191]
    v_cvt_pk_bf16_f32 v199, v142, v143
    v_mfma_f32_16x16x32_bf16 a[0:3], a[160:163], v[208:211], a[0:3]
    v_exp_f32 v144, v144
    v_mfma_f32_16x16x32_bf16 a[16:19], a[164:167], v[208:211], a[16:19]
    v_mfma_f32_16x16x32_bf16 a[32:35], a[168:171], v[208:211], a[32:35]
    v_exp_f32 v145, v145
    v_mfma_f32_16x16x32_bf16 a[48:51], a[172:175], v[208:211], a[48:51]
    v_cvt_pk_bf16_f32 v200, v144, v145
    v_mfma_f32_16x16x32_bf16 a[64:67], a[176:179], v[208:211], a[64:67]
    v_exp_f32 v146, v146
    s_add_u32 m0, s43, 16384
    s_waitcnt lgkmcnt(0)
    v_mfma_f32_16x16x32_bf16 a[80:83], a[180:183], v[208:211], a[80:83]
    buffer_load_dwordx4 v22, s[4:7], s46 offen offset:0 lds
    v_mfma_f32_16x16x32_bf16 a[96:99], a[184:187], v[208:211], a[96:99]
    v_exp_f32 v147, v147
    v_mfma_f32_16x16x32_bf16 a[112:115], a[188:191], v[208:211], a[112:115]
    v_cvt_pk_bf16_f32 v201, v146, v147
    v_mfma_f32_16x16x32_bf16 a[192:195], a[208:211], v[208:211], a[192:195]
    ds_read_b128 a[128:131], v2 offset:49152
    ds_read_b128 a[144:147], v2 offset:50176
    v_mfma_f32_16x16x32_bf16 a[4:7], a[160:163], v[212:215], a[4:7]
    v_exp_f32 v148, v148
    v_mfma_f32_16x16x32_bf16 a[20:23], a[164:167], v[212:215], a[20:23]
    buffer_load_dwordx4 v22, s[4:7], s46 offen offset:1024 lds
    v_mfma_f32_16x16x32_bf16 a[36:39], a[168:171], v[212:215], a[36:39]
    v_exp_f32 v149, v149
    v_mfma_f32_16x16x32_bf16 a[52:55], a[172:175], v[212:215], a[52:55]
    v_cvt_pk_bf16_f32 v202, v148, v149
    v_mfma_f32_16x16x32_bf16 a[68:71], a[176:179], v[212:215], a[68:71]
    v_exp_f32 v150, v150
    v_mfma_f32_16x16x32_bf16 a[84:87], a[180:183], v[212:215], a[84:87]
    buffer_load_dwordx4 v23, s[4:7], s46 offen offset:2048 lds
    v_mfma_f32_16x16x32_bf16 a[100:103], a[184:187], v[212:215], a[100:103]
    v_exp_f32 v151, v151
    v_mfma_f32_16x16x32_bf16 a[116:119], a[188:191], v[212:215], a[116:119]
    v_cvt_pk_bf16_f32 v203, v150, v151
    v_mfma_f32_16x16x32_bf16 a[196:199], a[208:211], v[212:215], a[196:199]
    ds_read_b128 a[132:135], v3 offset:49152
    ds_read_b128 a[148:151], v3 offset:50176
    v_mfma_f32_16x16x32_bf16 a[8:11], a[160:163], v[216:219], a[8:11]
    v_exp_f32 v152, v152
    v_mfma_f32_16x16x32_bf16 a[24:27], a[164:167], v[216:219], a[24:27]
    buffer_load_dwordx4 v23, s[4:7], s46 offen offset:3072 lds
    s_add_u32 s46, s46, 16384
    v_mfma_f32_16x16x32_bf16 a[40:43], a[168:171], v[216:219], a[40:43]
    v_exp_f32 v153, v153
    v_mfma_f32_16x16x32_bf16 a[56:59], a[172:175], v[216:219], a[56:59]
    v_cvt_pk_bf16_f32 v204, v152, v153
    v_mfma_f32_16x16x32_bf16 a[72:75], a[176:179], v[216:219], a[72:75]
    v_exp_f32 v154, v154
    v_mfma_f32_16x16x32_bf16 a[88:91], a[180:183], v[216:219], a[88:91]
    v_mfma_f32_16x16x32_bf16 a[104:107], a[184:187], v[216:219], a[104:107]
    v_exp_f32 v155, v155
    v_mfma_f32_16x16x32_bf16 a[120:123], a[188:191], v[216:219], a[120:123]
    v_cvt_pk_bf16_f32 v205, v154, v155
    v_mfma_f32_16x16x32_bf16 a[200:203], a[208:211], v[216:219], a[200:203]
    ds_read_b128 a[136:139], v4 offset:49152
    ds_read_b128 a[152:155], v4 offset:50176
    v_mfma_f32_16x16x32_bf16 a[12:15], a[160:163], v[220:223], a[12:15]
    v_exp_f32 v156, v156
    v_mfma_f32_16x16x32_bf16 a[28:31], a[164:167], v[220:223], a[28:31]
    v_mfma_f32_16x16x32_bf16 a[44:47], a[168:171], v[220:223], a[44:47]
    v_exp_f32 v157, v157
    v_mfma_f32_16x16x32_bf16 a[60:63], a[172:175], v[220:223], a[60:63]
    v_cvt_pk_bf16_f32 v206, v156, v157
    v_mfma_f32_16x16x32_bf16 a[76:79], a[176:179], v[220:223], a[76:79]
    v_exp_f32 v158, v158
    v_mfma_f32_16x16x32_bf16 a[92:95], a[180:183], v[220:223], a[92:95]
    v_mfma_f32_16x16x32_bf16 a[108:111], a[184:187], v[220:223], a[108:111]
    v_exp_f32 v159, v159
    v_mfma_f32_16x16x32_bf16 a[124:127], a[188:191], v[220:223], a[124:127]
    v_cvt_pk_bf16_f32 v207, v158, v159
    v_mfma_f32_16x16x32_bf16 a[204:207], a[208:211], v[220:223], a[204:207]
    ds_read_b128 a[140:143], v5 offset:49152
    ds_read_b128 a[156:159], v5 offset:50176
    s_waitcnt lgkmcnt(2)
    v_mfma_f32_16x16x32_bf16 v[128:131], a[128:131], v[64:67], v[224:227]
    v_exp_f32 v160, v160
    v_mfma_f32_16x16x32_bf16 v[132:135], a[144:147], v[64:67], v[224:227]
    ds_read_b64_tr_b16 a[160:161], v6 offset:0
    ds_read_b64_tr_b16 a[162:163], v6 offset:1024
    v_mfma_f32_16x16x32_bf16 v[136:139], a[128:131], v[80:83], v[228:231]
    v_exp_f32 v161, v161
    v_mfma_f32_16x16x32_bf16 v[140:143], a[144:147], v[80:83], v[228:231]
    v_cvt_pk_bf16_f32 v208, v160, v161
    v_mfma_f32_16x16x32_bf16 v[144:147], a[128:131], v[96:99], v[232:235]
    v_exp_f32 v162, v162
    v_mfma_f32_16x16x32_bf16 v[148:151], a[144:147], v[96:99], v[232:235]
    ds_read_b64_tr_b16 a[164:165], v7 offset:0
    ds_read_b64_tr_b16 a[166:167], v7 offset:1024
    v_mfma_f32_16x16x32_bf16 v[152:155], a[128:131], v[112:115], v[236:239]
    v_exp_f32 v163, v163
    v_mfma_f32_16x16x32_bf16 v[156:159], a[144:147], v[112:115], v[236:239]
    v_cvt_pk_bf16_f32 v209, v162, v163
    v_mfma_f32_16x16x32_bf16 v[128:131], a[132:135], v[68:71], v[128:131]
    v_exp_f32 v164, v164
    v_mfma_f32_16x16x32_bf16 v[132:135], a[148:151], v[68:71], v[132:135]
    ds_read_b64_tr_b16 a[168:169], v8 offset:0
    ds_read_b64_tr_b16 a[170:171], v8 offset:1024
    v_mfma_f32_16x16x32_bf16 v[136:139], a[132:135], v[84:87], v[136:139]
    v_exp_f32 v165, v165
    v_mfma_f32_16x16x32_bf16 v[140:143], a[148:151], v[84:87], v[140:143]
    v_cvt_pk_bf16_f32 v210, v164, v165
    v_mfma_f32_16x16x32_bf16 v[144:147], a[132:135], v[100:103], v[144:147]
    v_exp_f32 v166, v166
    v_mfma_f32_16x16x32_bf16 v[148:151], a[148:151], v[100:103], v[148:151]
    ds_read_b64_tr_b16 a[172:173], v9 offset:0
    ds_read_b64_tr_b16 a[174:175], v9 offset:1024
    v_mfma_f32_16x16x32_bf16 v[152:155], a[132:135], v[116:119], v[152:155]
    v_exp_f32 v167, v167
    v_mfma_f32_16x16x32_bf16 v[156:159], a[148:151], v[116:119], v[156:159]
    v_cvt_pk_bf16_f32 v211, v166, v167
    v_mfma_f32_16x16x32_bf16 v[128:131], a[136:139], v[72:75], v[128:131]
    v_exp_f32 v168, v168
    v_mfma_f32_16x16x32_bf16 v[132:135], a[152:155], v[72:75], v[132:135]
    ds_read_b64_tr_b16 a[176:177], v10 offset:0
    ds_read_b64_tr_b16 a[178:179], v10 offset:1024
    v_mfma_f32_16x16x32_bf16 v[136:139], a[136:139], v[88:91], v[136:139]
    v_exp_f32 v169, v169
    v_mfma_f32_16x16x32_bf16 v[140:143], a[152:155], v[88:91], v[140:143]
    v_cvt_pk_bf16_f32 v212, v168, v169
    v_mfma_f32_16x16x32_bf16 v[144:147], a[136:139], v[104:107], v[144:147]
    v_exp_f32 v170, v170
    v_mfma_f32_16x16x32_bf16 v[148:151], a[152:155], v[104:107], v[148:151]
    ds_read_b64_tr_b16 a[180:181], v11 offset:0
    ds_read_b64_tr_b16 a[182:183], v11 offset:1024
    v_mfma_f32_16x16x32_bf16 v[152:155], a[136:139], v[120:123], v[152:155]
    v_exp_f32 v171, v171
    v_mfma_f32_16x16x32_bf16 v[156:159], a[152:155], v[120:123], v[156:159]
    v_cvt_pk_bf16_f32 v213, v170, v171
    s_waitcnt lgkmcnt(2)
    v_mfma_f32_16x16x32_bf16 v[128:131], a[140:143], v[76:79], v[128:131]
    v_exp_f32 v172, v172
    v_mfma_f32_16x16x32_bf16 v[132:135], a[156:159], v[76:79], v[132:135]
    ds_read_b64_tr_b16 a[184:185], v12 offset:0
    ds_read_b64_tr_b16 a[186:187], v12 offset:1024
    v_mfma_f32_16x16x32_bf16 v[136:139], a[140:143], v[92:95], v[136:139]
    v_exp_f32 v173, v173
    v_mfma_f32_16x16x32_bf16 v[140:143], a[156:159], v[92:95], v[140:143]
    v_cvt_pk_bf16_f32 v214, v172, v173
    v_mfma_f32_16x16x32_bf16 v[144:147], a[140:143], v[108:111], v[144:147]
    v_exp_f32 v174, v174
    v_mfma_f32_16x16x32_bf16 v[148:151], a[156:159], v[108:111], v[148:151]
    ds_read_b64_tr_b16 a[188:189], v13 offset:0
    ds_read_b64_tr_b16 a[190:191], v13 offset:1024
    v_mfma_f32_16x16x32_bf16 v[152:155], a[140:143], v[124:127], v[152:155]
    v_exp_f32 v175, v175
    v_mfma_f32_16x16x32_bf16 v[156:159], a[156:159], v[124:127], v[156:159]
    v_cvt_pk_bf16_f32 v215, v174, v175
    v_mfma_f32_16x16x32_bf16 a[0:3], a[160:163], v[192:195], a[0:3]
    v_exp_f32 v176, v176
    v_mfma_f32_16x16x32_bf16 a[16:19], a[164:167], v[192:195], a[16:19]
    v_mfma_f32_16x16x32_bf16 a[32:35], a[168:171], v[192:195], a[32:35]
    v_exp_f32 v177, v177
    v_mfma_f32_16x16x32_bf16 a[48:51], a[172:175], v[192:195], a[48:51]
    v_cvt_pk_bf16_f32 v216, v176, v177
    v_mfma_f32_16x16x32_bf16 a[64:67], a[176:179], v[192:195], a[64:67]
    v_exp_f32 v178, v178
    s_add_u32 m0, s51, 32768
    s_waitcnt lgkmcnt(0)
    v_mfma_f32_16x16x32_bf16 a[80:83], a[180:183], v[192:195], a[80:83]
    buffer_load_dwordx4 v24, s[8:11], s47 offen offset:0 lds
    v_mfma_f32_16x16x32_bf16 a[96:99], a[184:187], v[192:195], a[96:99]
    v_exp_f32 v179, v179
    v_mfma_f32_16x16x32_bf16 a[112:115], a[188:191], v[192:195], a[112:115]
    v_cvt_pk_bf16_f32 v217, v178, v179
    v_mfma_f32_16x16x32_bf16 a[192:195], a[208:211], v[192:195], a[192:195]
    ds_read_b128 a[128:131], v2 offset:57344
    ds_read_b128 a[144:147], v2 offset:58368
    v_mfma_f32_16x16x32_bf16 a[4:7], a[160:163], v[196:199], a[4:7]
    v_exp_f32 v180, v180
    v_mfma_f32_16x16x32_bf16 a[20:23], a[164:167], v[196:199], a[20:23]
    buffer_load_dwordx4 v24, s[8:11], s47 offen offset:1024 lds
    v_mfma_f32_16x16x32_bf16 a[36:39], a[168:171], v[196:199], a[36:39]
    v_exp_f32 v181, v181
    v_mfma_f32_16x16x32_bf16 a[52:55], a[172:175], v[196:199], a[52:55]
    v_cvt_pk_bf16_f32 v218, v180, v181
    v_mfma_f32_16x16x32_bf16 a[68:71], a[176:179], v[196:199], a[68:71]
    v_exp_f32 v182, v182
    v_mfma_f32_16x16x32_bf16 a[84:87], a[180:183], v[196:199], a[84:87]
    buffer_load_dwordx4 v25, s[8:11], s47 offen offset:2048 lds
    v_mfma_f32_16x16x32_bf16 a[100:103], a[184:187], v[196:199], a[100:103]
    v_exp_f32 v183, v183
    v_mfma_f32_16x16x32_bf16 a[116:119], a[188:191], v[196:199], a[116:119]
    v_cvt_pk_bf16_f32 v219, v182, v183
    v_mfma_f32_16x16x32_bf16 a[196:199], a[208:211], v[196:199], a[196:199]
    ds_read_b128 a[132:135], v3 offset:57344
    ds_read_b128 a[148:151], v3 offset:58368
    v_mfma_f32_16x16x32_bf16 a[8:11], a[160:163], v[200:203], a[8:11]
    v_exp_f32 v184, v184
    v_mfma_f32_16x16x32_bf16 a[24:27], a[164:167], v[200:203], a[24:27]
    buffer_load_dwordx4 v25, s[8:11], s47 offen offset:3072 lds
    s_add_u32 s47, s47, 16384
    v_mfma_f32_16x16x32_bf16 a[40:43], a[168:171], v[200:203], a[40:43]
    v_exp_f32 v185, v185
    v_mfma_f32_16x16x32_bf16 a[56:59], a[172:175], v[200:203], a[56:59]
    v_cvt_pk_bf16_f32 v220, v184, v185
    buffer_load_dword v58, v59, s[16:19], s58 offen
    v_mfma_f32_16x16x32_bf16 a[72:75], a[176:179], v[200:203], a[72:75]
    v_exp_f32 v186, v186
    v_mfma_f32_16x16x32_bf16 a[88:91], a[180:183], v[200:203], a[88:91]
    v_mfma_f32_16x16x32_bf16 a[104:107], a[184:187], v[200:203], a[104:107]
    v_exp_f32 v187, v187
    v_mfma_f32_16x16x32_bf16 a[120:123], a[188:191], v[200:203], a[120:123]
    v_cvt_pk_bf16_f32 v221, v186, v187
    v_mfma_f32_16x16x32_bf16 a[200:203], a[208:211], v[200:203], a[200:203]
    ds_read_b128 a[136:139], v4 offset:57344
    ds_read_b128 a[152:155], v4 offset:58368
    v_mfma_f32_16x16x32_bf16 a[12:15], a[160:163], v[204:207], a[12:15]
    v_exp_f32 v188, v188
    v_mfma_f32_16x16x32_bf16 a[28:31], a[164:167], v[204:207], a[28:31]
    v_mfma_f32_16x16x32_bf16 a[44:47], a[168:171], v[204:207], a[44:47]
    v_exp_f32 v189, v189
    v_mfma_f32_16x16x32_bf16 a[60:63], a[172:175], v[204:207], a[60:63]
    v_cvt_pk_bf16_f32 v222, v188, v189
    v_mfma_f32_16x16x32_bf16 a[76:79], a[176:179], v[204:207], a[76:79]
    v_exp_f32 v190, v190
    v_mfma_f32_16x16x32_bf16 a[92:95], a[180:183], v[204:207], a[92:95]
    v_mfma_f32_16x16x32_bf16 a[108:111], a[184:187], v[204:207], a[108:111]
    v_exp_f32 v191, v191
    v_mfma_f32_16x16x32_bf16 a[124:127], a[188:191], v[204:207], a[124:127]
    v_cvt_pk_bf16_f32 v223, v190, v191
    v_mfma_f32_16x16x32_bf16 a[204:207], a[208:211], v[204:207], a[204:207]
    ds_read_b128 a[140:143], v5 offset:57344
    ds_read_b128 a[156:159], v5 offset:58368
    s_waitcnt lgkmcnt(2)
    v_mfma_f32_16x16x32_bf16 v[160:163], a[128:131], v[64:67], v[224:227]
    s_waitcnt vmcnt(9)
    s_barrier
    v_exp_f32 v128, v128
    v_mfma_f32_16x16x32_bf16 v[164:167], a[144:147], v[64:67], v[224:227]
    ds_read_b64_tr_b16 a[160:161], v6 offset:8192
    ds_read_b64_tr_b16 a[162:163], v6 offset:9216
    v_mfma_f32_16x16x32_bf16 v[168:171], a[128:131], v[80:83], v[228:231]
    v_exp_f32 v129, v129
    v_mfma_f32_16x16x32_bf16 v[172:175], a[144:147], v[80:83], v[228:231]
    v_cvt_pk_bf16_f32 v192, v128, v129
    v_mfma_f32_16x16x32_bf16 v[176:179], a[128:131], v[96:99], v[232:235]
    v_exp_f32 v130, v130
    v_mfma_f32_16x16x32_bf16 v[180:183], a[144:147], v[96:99], v[232:235]
    ds_read_b64_tr_b16 a[164:165], v7 offset:8192
    ds_read_b64_tr_b16 a[166:167], v7 offset:9216
    v_mfma_f32_16x16x32_bf16 v[184:187], a[128:131], v[112:115], v[236:239]
    v_exp_f32 v131, v131
    v_mfma_f32_16x16x32_bf16 v[188:191], a[144:147], v[112:115], v[236:239]
    v_cvt_pk_bf16_f32 v193, v130, v131
    v_mfma_f32_16x16x32_bf16 v[160:163], a[132:135], v[68:71], v[160:163]
    v_exp_f32 v132, v132
    v_mfma_f32_16x16x32_bf16 v[164:167], a[148:151], v[68:71], v[164:167]
    ds_read_b64_tr_b16 a[168:169], v8 offset:8192
    ds_read_b64_tr_b16 a[170:171], v8 offset:9216
    v_mfma_f32_16x16x32_bf16 v[168:171], a[132:135], v[84:87], v[168:171]
    v_exp_f32 v133, v133
    v_mfma_f32_16x16x32_bf16 v[172:175], a[148:151], v[84:87], v[172:175]
    v_cvt_pk_bf16_f32 v194, v132, v133
    v_mfma_f32_16x16x32_bf16 v[176:179], a[132:135], v[100:103], v[176:179]
    v_exp_f32 v134, v134
    v_mfma_f32_16x16x32_bf16 v[180:183], a[148:151], v[100:103], v[180:183]
    ds_read_b64_tr_b16 a[172:173], v9 offset:8192
    ds_read_b64_tr_b16 a[174:175], v9 offset:9216
    v_mfma_f32_16x16x32_bf16 v[184:187], a[132:135], v[116:119], v[184:187]
    v_exp_f32 v135, v135
    v_mfma_f32_16x16x32_bf16 v[188:191], a[148:151], v[116:119], v[188:191]
    v_cvt_pk_bf16_f32 v195, v134, v135
    v_mfma_f32_16x16x32_bf16 v[160:163], a[136:139], v[72:75], v[160:163]
    v_exp_f32 v136, v136
    v_mfma_f32_16x16x32_bf16 v[164:167], a[152:155], v[72:75], v[164:167]
    ds_read_b64_tr_b16 a[176:177], v10 offset:8192
    ds_read_b64_tr_b16 a[178:179], v10 offset:9216
    v_mfma_f32_16x16x32_bf16 v[168:171], a[136:139], v[88:91], v[168:171]
    v_exp_f32 v137, v137
    v_mfma_f32_16x16x32_bf16 v[172:175], a[152:155], v[88:91], v[172:175]
    v_cvt_pk_bf16_f32 v196, v136, v137
    v_mfma_f32_16x16x32_bf16 v[176:179], a[136:139], v[104:107], v[176:179]
    v_exp_f32 v138, v138
    v_mfma_f32_16x16x32_bf16 v[180:183], a[152:155], v[104:107], v[180:183]
    ds_read_b64_tr_b16 a[180:181], v11 offset:8192
    ds_read_b64_tr_b16 a[182:183], v11 offset:9216
    v_mfma_f32_16x16x32_bf16 v[184:187], a[136:139], v[120:123], v[184:187]
    v_exp_f32 v139, v139
    v_mfma_f32_16x16x32_bf16 v[188:191], a[152:155], v[120:123], v[188:191]
    v_cvt_pk_bf16_f32 v197, v138, v139
    s_waitcnt lgkmcnt(2)
    v_mfma_f32_16x16x32_bf16 v[160:163], a[140:143], v[76:79], v[160:163]
    v_exp_f32 v140, v140
    v_mfma_f32_16x16x32_bf16 v[164:167], a[156:159], v[76:79], v[164:167]
    ds_read_b64_tr_b16 a[184:185], v12 offset:8192
    ds_read_b64_tr_b16 a[186:187], v12 offset:9216
    v_mfma_f32_16x16x32_bf16 v[168:171], a[140:143], v[92:95], v[168:171]
    v_exp_f32 v141, v141
    v_mfma_f32_16x16x32_bf16 v[172:175], a[156:159], v[92:95], v[172:175]
    v_cvt_pk_bf16_f32 v198, v140, v141
    v_mfma_f32_16x16x32_bf16 v[176:179], a[140:143], v[108:111], v[176:179]
    v_exp_f32 v142, v142
    v_mfma_f32_16x16x32_bf16 v[180:183], a[156:159], v[108:111], v[180:183]
    ds_read_b64_tr_b16 a[188:189], v13 offset:8192
    ds_read_b64_tr_b16 a[190:191], v13 offset:9216
    v_mfma_f32_16x16x32_bf16 v[184:187], a[140:143], v[124:127], v[184:187]
    v_exp_f32 v143, v143
    v_mfma_f32_16x16x32_bf16 v[188:191], a[156:159], v[124:127], v[188:191]
    v_cvt_pk_bf16_f32 v199, v142, v143
    v_mfma_f32_16x16x32_bf16 a[0:3], a[160:163], v[208:211], a[0:3]
    v_exp_f32 v144, v144
    v_mfma_f32_16x16x32_bf16 a[16:19], a[164:167], v[208:211], a[16:19]
    v_mfma_f32_16x16x32_bf16 a[32:35], a[168:171], v[208:211], a[32:35]
    v_exp_f32 v145, v145
    v_mfma_f32_16x16x32_bf16 a[48:51], a[172:175], v[208:211], a[48:51]
    v_cvt_pk_bf16_f32 v200, v144, v145
    v_mfma_f32_16x16x32_bf16 a[64:67], a[176:179], v[208:211], a[64:67]
    v_exp_f32 v146, v146
    s_add_u32 m0, s43, 32768
    s_waitcnt lgkmcnt(0)
    v_mfma_f32_16x16x32_bf16 a[80:83], a[180:183], v[208:211], a[80:83]
    buffer_load_dwordx4 v22, s[4:7], s46 offen offset:0 lds
    v_mfma_f32_16x16x32_bf16 a[96:99], a[184:187], v[208:211], a[96:99]
    v_exp_f32 v147, v147
    v_mfma_f32_16x16x32_bf16 a[112:115], a[188:191], v[208:211], a[112:115]
    v_cvt_pk_bf16_f32 v201, v146, v147
    v_mfma_f32_16x16x32_bf16 a[192:195], a[208:211], v[208:211], a[192:195]
    ds_read_b128 a[128:131], v2 offset:0
    ds_read_b128 a[144:147], v2 offset:1024
    v_mfma_f32_16x16x32_bf16 a[4:7], a[160:163], v[212:215], a[4:7]
    v_exp_f32 v148, v148
    v_mfma_f32_16x16x32_bf16 a[20:23], a[164:167], v[212:215], a[20:23]
    buffer_load_dwordx4 v22, s[4:7], s46 offen offset:1024 lds
    v_mfma_f32_16x16x32_bf16 a[36:39], a[168:171], v[212:215], a[36:39]
    v_exp_f32 v149, v149
    v_mfma_f32_16x16x32_bf16 a[52:55], a[172:175], v[212:215], a[52:55]
    v_cvt_pk_bf16_f32 v202, v148, v149
    v_mfma_f32_16x16x32_bf16 a[68:71], a[176:179], v[212:215], a[68:71]
    v_exp_f32 v150, v150
    v_mfma_f32_16x16x32_bf16 a[84:87], a[180:183], v[212:215], a[84:87]
    buffer_load_dwordx4 v23, s[4:7], s46 offen offset:2048 lds
    v_mfma_f32_16x16x32_bf16 a[100:103], a[184:187], v[212:215], a[100:103]
    v_exp_f32 v151, v151
    v_mfma_f32_16x16x32_bf16 a[116:119], a[188:191], v[212:215], a[116:119]
    v_cvt_pk_bf16_f32 v203, v150, v151
    v_mfma_f32_16x16x32_bf16 a[196:199], a[208:211], v[212:215], a[196:199]
    ds_read_b128 a[132:135], v3 offset:0
    ds_read_b128 a[148:151], v3 offset:1024
    v_mfma_f32_16x16x32_bf16 a[8:11], a[160:163], v[216:219], a[8:11]
    v_exp_f32 v152, v152
    v_mfma_f32_16x16x32_bf16 a[24:27], a[164:167], v[216:219], a[24:27]
    buffer_load_dwordx4 v23, s[4:7], s46 offen offset:3072 lds
    s_add_u32 s46, s46, 16384
    v_mfma_f32_16x16x32_bf16 a[40:43], a[168:171], v[216:219], a[40:43]
    v_exp_f32 v153, v153
    v_mfma_f32_16x16x32_bf16 a[56:59], a[172:175], v[216:219], a[56:59]
    v_cvt_pk_bf16_f32 v204, v152, v153
    v_mfma_f32_16x16x32_bf16 a[72:75], a[176:179], v[216:219], a[72:75]
    v_exp_f32 v154, v154
    v_mfma_f32_16x16x32_bf16 a[88:91], a[180:183], v[216:219], a[88:91]
    v_mfma_f32_16x16x32_bf16 a[104:107], a[184:187], v[216:219], a[104:107]
    v_exp_f32 v155, v155
    v_mfma_f32_16x16x32_bf16 a[120:123], a[188:191], v[216:219], a[120:123]
    v_cvt_pk_bf16_f32 v205, v154, v155
    v_mfma_f32_16x16x32_bf16 a[200:203], a[208:211], v[216:219], a[200:203]
    ds_read_b128 a[136:139], v4 offset:0
    ds_read_b128 a[152:155], v4 offset:1024
    v_mfma_f32_16x16x32_bf16 a[12:15], a[160:163], v[220:223], a[12:15]
    v_exp_f32 v156, v156
    v_mfma_f32_16x16x32_bf16 a[28:31], a[164:167], v[220:223], a[28:31]
    v_mfma_f32_16x16x32_bf16 a[44:47], a[168:171], v[220:223], a[44:47]
    v_exp_f32 v157, v157
    v_mfma_f32_16x16x32_bf16 a[60:63], a[172:175], v[220:223], a[60:63]
    v_cvt_pk_bf16_f32 v206, v156, v157
    v_mfma_f32_16x16x32_bf16 a[76:79], a[176:179], v[220:223], a[76:79]
    v_exp_f32 v158, v158
    v_mfma_f32_16x16x32_bf16 a[92:95], a[180:183], v[220:223], a[92:95]
    v_mfma_f32_16x16x32_bf16 a[108:111], a[184:187], v[220:223], a[108:111]
    v_exp_f32 v159, v159
    v_mfma_f32_16x16x32_bf16 a[124:127], a[188:191], v[220:223], a[124:127]
    v_cvt_pk_bf16_f32 v207, v158, v159
    v_mfma_f32_16x16x32_bf16 a[204:207], a[208:211], v[220:223], a[204:207]
    ds_read_b128 a[140:143], v5 offset:0
    ds_read_b128 a[156:159], v5 offset:1024
    s_waitcnt lgkmcnt(2)
    v_mfma_f32_16x16x32_bf16 v[128:131], a[128:131], v[64:67], v[224:227]
    v_exp_f32 v160, v160
    v_mfma_f32_16x16x32_bf16 v[132:135], a[144:147], v[64:67], v[224:227]
    ds_read_b64_tr_b16 a[160:161], v6 offset:16384
    ds_read_b64_tr_b16 a[162:163], v6 offset:17408
    v_mfma_f32_16x16x32_bf16 v[136:139], a[128:131], v[80:83], v[228:231]
    v_exp_f32 v161, v161
    v_mfma_f32_16x16x32_bf16 v[140:143], a[144:147], v[80:83], v[228:231]
    v_cvt_pk_bf16_f32 v208, v160, v161
    v_mfma_f32_16x16x32_bf16 v[144:147], a[128:131], v[96:99], v[232:235]
    v_exp_f32 v162, v162
    v_mfma_f32_16x16x32_bf16 v[148:151], a[144:147], v[96:99], v[232:235]
    ds_read_b64_tr_b16 a[164:165], v7 offset:16384
    ds_read_b64_tr_b16 a[166:167], v7 offset:17408
    v_mfma_f32_16x16x32_bf16 v[152:155], a[128:131], v[112:115], v[236:239]
    v_exp_f32 v163, v163
    v_mfma_f32_16x16x32_bf16 v[156:159], a[144:147], v[112:115], v[236:239]
    v_cvt_pk_bf16_f32 v209, v162, v163
    v_mfma_f32_16x16x32_bf16 v[128:131], a[132:135], v[68:71], v[128:131]
    v_exp_f32 v164, v164
    v_mfma_f32_16x16x32_bf16 v[132:135], a[148:151], v[68:71], v[132:135]
    ds_read_b64_tr_b16 a[168:169], v8 offset:16384
    ds_read_b64_tr_b16 a[170:171], v8 offset:17408
    v_mfma_f32_16x16x32_bf16 v[136:139], a[132:135], v[84:87], v[136:139]
    v_exp_f32 v165, v165
    v_mfma_f32_16x16x32_bf16 v[140:143], a[148:151], v[84:87], v[140:143]
    v_cvt_pk_bf16_f32 v210, v164, v165
    v_mfma_f32_16x16x32_bf16 v[144:147], a[132:135], v[100:103], v[144:147]
    v_exp_f32 v166, v166
    v_mfma_f32_16x16x32_bf16 v[148:151], a[148:151], v[100:103], v[148:151]
    ds_read_b64_tr_b16 a[172:173], v9 offset:16384
    ds_read_b64_tr_b16 a[174:175], v9 offset:17408
    v_mfma_f32_16x16x32_bf16 v[152:155], a[132:135], v[116:119], v[152:155]
    v_exp_f32 v167, v167
    v_mfma_f32_16x16x32_bf16 v[156:159], a[148:151], v[116:119], v[156:159]
    v_cvt_pk_bf16_f32 v211, v166, v167
    v_mfma_f32_16x16x32_bf16 v[128:131], a[136:139], v[72:75], v[128:131]
    v_exp_f32 v168, v168
    v_mfma_f32_16x16x32_bf16 v[132:135], a[152:155], v[72:75], v[132:135]
    ds_read_b64_tr_b16 a[176:177], v10 offset:16384
    ds_read_b64_tr_b16 a[178:179], v10 offset:17408
    v_mfma_f32_16x16x32_bf16 v[136:139], a[136:139], v[88:91], v[136:139]
    v_exp_f32 v169, v169
    v_mfma_f32_16x16x32_bf16 v[140:143], a[152:155], v[88:91], v[140:143]
    v_cvt_pk_bf16_f32 v212, v168, v169
    v_mfma_f32_16x16x32_bf16 v[144:147], a[136:139], v[104:107], v[144:147]
    v_exp_f32 v170, v170
    v_mfma_f32_16x16x32_bf16 v[148:151], a[152:155], v[104:107], v[148:151]
    ds_read_b64_tr_b16 a[180:181], v11 offset:16384
    ds_read_b64_tr_b16 a[182:183], v11 offset:17408
    v_mfma_f32_16x16x32_bf16 v[152:155], a[136:139], v[120:123], v[152:155]
    v_exp_f32 v171, v171
    v_mfma_f32_16x16x32_bf16 v[156:159], a[152:155], v[120:123], v[156:159]
    v_cvt_pk_bf16_f32 v213, v170, v171
    s_waitcnt lgkmcnt(2)
    v_mfma_f32_16x16x32_bf16 v[128:131], a[140:143], v[76:79], v[128:131]
    v_exp_f32 v172, v172
    v_mfma_f32_16x16x32_bf16 v[132:135], a[156:159], v[76:79], v[132:135]
    ds_read_b64_tr_b16 a[184:185], v12 offset:16384
    ds_read_b64_tr_b16 a[186:187], v12 offset:17408
    v_mfma_f32_16x16x32_bf16 v[136:139], a[140:143], v[92:95], v[136:139]
    v_exp_f32 v173, v173
    v_mfma_f32_16x16x32_bf16 v[140:143], a[156:159], v[92:95], v[140:143]
    v_cvt_pk_bf16_f32 v214, v172, v173
    v_mfma_f32_16x16x32_bf16 v[144:147], a[140:143], v[108:111], v[144:147]
    v_exp_f32 v174, v174
    v_mfma_f32_16x16x32_bf16 v[148:151], a[156:159], v[108:111], v[148:151]
    ds_read_b64_tr_b16 a[188:189], v13 offset:16384
    ds_read_b64_tr_b16 a[190:191], v13 offset:17408
    v_mfma_f32_16x16x32_bf16 v[152:155], a[140:143], v[124:127], v[152:155]
    v_exp_f32 v175, v175
    v_mfma_f32_16x16x32_bf16 v[156:159], a[156:159], v[124:127], v[156:159]
    v_cvt_pk_bf16_f32 v215, v174, v175
    v_mfma_f32_16x16x32_bf16 a[0:3], a[160:163], v[192:195], a[0:3]
    v_exp_f32 v176, v176
    v_mfma_f32_16x16x32_bf16 a[16:19], a[164:167], v[192:195], a[16:19]
    v_mfma_f32_16x16x32_bf16 a[32:35], a[168:171], v[192:195], a[32:35]
    v_exp_f32 v177, v177
    v_mfma_f32_16x16x32_bf16 a[48:51], a[172:175], v[192:195], a[48:51]
    v_cvt_pk_bf16_f32 v216, v176, v177
    v_mfma_f32_16x16x32_bf16 a[64:67], a[176:179], v[192:195], a[64:67]
    v_exp_f32 v178, v178
    s_add_u32 m0, s51, 49152
    s_waitcnt lgkmcnt(0)
    v_mfma_f32_16x16x32_bf16 a[80:83], a[180:183], v[192:195], a[80:83]
    buffer_load_dwordx4 v24, s[8:11], s47 offen offset:0 lds
    v_mfma_f32_16x16x32_bf16 a[96:99], a[184:187], v[192:195], a[96:99]
    v_exp_f32 v179, v179
    v_mfma_f32_16x16x32_bf16 a[112:115], a[188:191], v[192:195], a[112:115]
    v_cvt_pk_bf16_f32 v217, v178, v179
    v_mfma_f32_16x16x32_bf16 a[192:195], a[208:211], v[192:195], a[192:195]
    ds_read_b128 a[128:131], v2 offset:8192
    ds_read_b128 a[144:147], v2 offset:9216
    v_mfma_f32_16x16x32_bf16 a[4:7], a[160:163], v[196:199], a[4:7]
    v_exp_f32 v180, v180
    v_mfma_f32_16x16x32_bf16 a[20:23], a[164:167], v[196:199], a[20:23]
    buffer_load_dwordx4 v24, s[8:11], s47 offen offset:1024 lds
    v_mfma_f32_16x16x32_bf16 a[36:39], a[168:171], v[196:199], a[36:39]
    v_exp_f32 v181, v181
    v_mfma_f32_16x16x32_bf16 a[52:55], a[172:175], v[196:199], a[52:55]
    v_cvt_pk_bf16_f32 v218, v180, v181
    v_mfma_f32_16x16x32_bf16 a[68:71], a[176:179], v[196:199], a[68:71]
    v_exp_f32 v182, v182
    v_mfma_f32_16x16x32_bf16 a[84:87], a[180:183], v[196:199], a[84:87]
    buffer_load_dwordx4 v25, s[8:11], s47 offen offset:2048 lds
    v_mfma_f32_16x16x32_bf16 a[100:103], a[184:187], v[196:199], a[100:103]
    v_exp_f32 v183, v183
    v_mfma_f32_16x16x32_bf16 a[116:119], a[188:191], v[196:199], a[116:119]
    v_cvt_pk_bf16_f32 v219, v182, v183
    v_mfma_f32_16x16x32_bf16 a[196:199], a[208:211], v[196:199], a[196:199]
    ds_read_b128 a[132:135], v3 offset:8192
    ds_read_b128 a[148:151], v3 offset:9216
    v_mfma_f32_16x16x32_bf16 a[8:11], a[160:163], v[200:203], a[8:11]
    v_exp_f32 v184, v184
    v_mfma_f32_16x16x32_bf16 a[24:27], a[164:167], v[200:203], a[24:27]
    buffer_load_dwordx4 v25, s[8:11], s47 offen offset:3072 lds
    s_add_u32 s47, s47, 16384
    v_mfma_f32_16x16x32_bf16 a[40:43], a[168:171], v[200:203], a[40:43]
    v_exp_f32 v185, v185
    v_mfma_f32_16x16x32_bf16 a[56:59], a[172:175], v[200:203], a[56:59]
    v_cvt_pk_bf16_f32 v220, v184, v185
    v_mfma_f32_16x16x32_bf16 a[72:75], a[176:179], v[200:203], a[72:75]
    v_exp_f32 v186, v186
    v_mfma_f32_16x16x32_bf16 a[88:91], a[180:183], v[200:203], a[88:91]
    v_mfma_f32_16x16x32_bf16 a[104:107], a[184:187], v[200:203], a[104:107]
    v_exp_f32 v187, v187
    v_mfma_f32_16x16x32_bf16 a[120:123], a[188:191], v[200:203], a[120:123]
    v_cvt_pk_bf16_f32 v221, v186, v187
    v_mfma_f32_16x16x32_bf16 a[200:203], a[208:211], v[200:203], a[200:203]
    ds_read_b128 a[136:139], v4 offset:8192
    ds_read_b128 a[152:155], v4 offset:9216
    v_mfma_f32_16x16x32_bf16 a[12:15], a[160:163], v[204:207], a[12:15]
    v_exp_f32 v188, v188
    v_mfma_f32_16x16x32_bf16 a[28:31], a[164:167], v[204:207], a[28:31]
    v_mfma_f32_16x16x32_bf16 a[44:47], a[168:171], v[204:207], a[44:47]
    v_exp_f32 v189, v189
    v_mfma_f32_16x16x32_bf16 a[60:63], a[172:175], v[204:207], a[60:63]
    v_cvt_pk_bf16_f32 v222, v188, v189
    v_mfma_f32_16x16x32_bf16 a[76:79], a[176:179], v[204:207], a[76:79]
    v_exp_f32 v190, v190
    v_mfma_f32_16x16x32_bf16 a[92:95], a[180:183], v[204:207], a[92:95]
    v_mfma_f32_16x16x32_bf16 a[108:111], a[184:187], v[204:207], a[108:111]
    v_exp_f32 v191, v191
    v_mfma_f32_16x16x32_bf16 a[124:127], a[188:191], v[204:207], a[124:127]
    v_cvt_pk_bf16_f32 v223, v190, v191
    v_mfma_f32_16x16x32_bf16 a[204:207], a[208:211], v[204:207], a[204:207]
    ds_read_b128 a[140:143], v5 offset:8192
    ds_read_b128 a[156:159], v5 offset:9216
    s_mov_b32 s48, 6
attn_kernel_loop:
    s_waitcnt lgkmcnt(2)
    v_mfma_f32_16x16x32_bf16 v[160:163], a[128:131], v[64:67], v[224:227]
    s_waitcnt vmcnt(8)
    s_barrier
    v_exp_f32 v128, v128
    v_mfma_f32_16x16x32_bf16 v[164:167], a[144:147], v[64:67], v[224:227]
    ds_read_b64_tr_b16 a[160:161], v6 offset:24576
    ds_read_b64_tr_b16 a[162:163], v6 offset:25600
    v_mfma_f32_16x16x32_bf16 v[168:171], a[128:131], v[80:83], v[228:231]
    v_exp_f32 v129, v129
    v_mfma_f32_16x16x32_bf16 v[172:175], a[144:147], v[80:83], v[228:231]
    v_cvt_pk_bf16_f32 v192, v128, v129
    v_mfma_f32_16x16x32_bf16 v[176:179], a[128:131], v[96:99], v[232:235]
    v_exp_f32 v130, v130
    v_mfma_f32_16x16x32_bf16 v[180:183], a[144:147], v[96:99], v[232:235]
    ds_read_b64_tr_b16 a[164:165], v7 offset:24576
    ds_read_b64_tr_b16 a[166:167], v7 offset:25600
    v_mfma_f32_16x16x32_bf16 v[184:187], a[128:131], v[112:115], v[236:239]
    v_exp_f32 v131, v131
    v_mfma_f32_16x16x32_bf16 v[188:191], a[144:147], v[112:115], v[236:239]
    v_cvt_pk_bf16_f32 v193, v130, v131
    v_mfma_f32_16x16x32_bf16 v[160:163], a[132:135], v[68:71], v[160:163]
    v_exp_f32 v132, v132
    v_mfma_f32_16x16x32_bf16 v[164:167], a[148:151], v[68:71], v[164:167]
    ds_read_b64_tr_b16 a[168:169], v8 offset:24576
    ds_read_b64_tr_b16 a[170:171], v8 offset:25600
    v_mfma_f32_16x16x32_bf16 v[168:171], a[132:135], v[84:87], v[168:171]
    v_exp_f32 v133, v133
    v_mfma_f32_16x16x32_bf16 v[172:175], a[148:151], v[84:87], v[172:175]
    v_cvt_pk_bf16_f32 v194, v132, v133
    v_mfma_f32_16x16x32_bf16 v[176:179], a[132:135], v[100:103], v[176:179]
    v_exp_f32 v134, v134
    v_mfma_f32_16x16x32_bf16 v[180:183], a[148:151], v[100:103], v[180:183]
    ds_read_b64_tr_b16 a[172:173], v9 offset:24576
    ds_read_b64_tr_b16 a[174:175], v9 offset:25600
    v_mfma_f32_16x16x32_bf16 v[184:187], a[132:135], v[116:119], v[184:187]
    v_exp_f32 v135, v135
    v_mfma_f32_16x16x32_bf16 v[188:191], a[148:151], v[116:119], v[188:191]
    v_cvt_pk_bf16_f32 v195, v134, v135
    v_mfma_f32_16x16x32_bf16 v[160:163], a[136:139], v[72:75], v[160:163]
    v_exp_f32 v136, v136
    v_mfma_f32_16x16x32_bf16 v[164:167], a[152:155], v[72:75], v[164:167]
    ds_read_b64_tr_b16 a[176:177], v10 offset:24576
    ds_read_b64_tr_b16 a[178:179], v10 offset:25600
    v_mfma_f32_16x16x32_bf16 v[168:171], a[136:139], v[88:91], v[168:171]
    v_exp_f32 v137, v137
    v_mfma_f32_16x16x32_bf16 v[172:175], a[152:155], v[88:91], v[172:175]
    v_cvt_pk_bf16_f32 v196, v136, v137
    v_mfma_f32_16x16x32_bf16 v[176:179], a[136:139], v[104:107], v[176:179]
    v_exp_f32 v138, v138
    v_mfma_f32_16x16x32_bf16 v[180:183], a[152:155], v[104:107], v[180:183]
    ds_read_b64_tr_b16 a[180:181], v11 offset:24576
    ds_read_b64_tr_b16 a[182:183], v11 offset:25600
    v_mfma_f32_16x16x32_bf16 v[184:187], a[136:139], v[120:123], v[184:187]
    v_exp_f32 v139, v139
    v_mfma_f32_16x16x32_bf16 v[188:191], a[152:155], v[120:123], v[188:191]
    v_cvt_pk_bf16_f32 v197, v138, v139
    s_waitcnt lgkmcnt(2)
    v_mfma_f32_16x16x32_bf16 v[160:163], a[140:143], v[76:79], v[160:163]
    v_exp_f32 v140, v140
    v_mfma_f32_16x16x32_bf16 v[164:167], a[156:159], v[76:79], v[164:167]
    ds_read_b64_tr_b16 a[184:185], v12 offset:24576
    ds_read_b64_tr_b16 a[186:187], v12 offset:25600
    v_mfma_f32_16x16x32_bf16 v[168:171], a[140:143], v[92:95], v[168:171]
    v_exp_f32 v141, v141
    v_mfma_f32_16x16x32_bf16 v[172:175], a[156:159], v[92:95], v[172:175]
    v_cvt_pk_bf16_f32 v198, v140, v141
    v_mfma_f32_16x16x32_bf16 v[176:179], a[140:143], v[108:111], v[176:179]
    v_exp_f32 v142, v142
    v_mfma_f32_16x16x32_bf16 v[180:183], a[156:159], v[108:111], v[180:183]
    ds_read_b64_tr_b16 a[188:189], v13 offset:24576
    ds_read_b64_tr_b16 a[190:191], v13 offset:25600
    v_mfma_f32_16x16x32_bf16 v[184:187], a[140:143], v[124:127], v[184:187]
    v_exp_f32 v143, v143
    v_mfma_f32_16x16x32_bf16 v[188:191], a[156:159], v[124:127], v[188:191]
    v_cvt_pk_bf16_f32 v199, v142, v143
    v_mfma_f32_16x16x32_bf16 a[0:3], a[160:163], v[208:211], a[0:3]
    v_exp_f32 v144, v144
    v_mfma_f32_16x16x32_bf16 a[16:19], a[164:167], v[208:211], a[16:19]
    v_mfma_f32_16x16x32_bf16 a[32:35], a[168:171], v[208:211], a[32:35]
    v_exp_f32 v145, v145
    v_mfma_f32_16x16x32_bf16 a[48:51], a[172:175], v[208:211], a[48:51]
    v_cvt_pk_bf16_f32 v200, v144, v145
    v_mfma_f32_16x16x32_bf16 a[64:67], a[176:179], v[208:211], a[64:67]
    v_exp_f32 v146, v146
    s_add_u32 m0, s43, 49152
    s_waitcnt lgkmcnt(0)
    v_mfma_f32_16x16x32_bf16 a[80:83], a[180:183], v[208:211], a[80:83]
    buffer_load_dwordx4 v22, s[4:7], s46 offen offset:0 lds
    v_mfma_f32_16x16x32_bf16 a[96:99], a[184:187], v[208:211], a[96:99]
    v_exp_f32 v147, v147
    v_mfma_f32_16x16x32_bf16 a[112:115], a[188:191], v[208:211], a[112:115]
    v_cvt_pk_bf16_f32 v201, v146, v147
    v_mfma_f32_16x16x32_bf16 a[192:195], a[208:211], v[208:211], a[192:195]
    ds_read_b128 a[128:131], v2 offset:16384
    ds_read_b128 a[144:147], v2 offset:17408
    v_mfma_f32_16x16x32_bf16 a[4:7], a[160:163], v[212:215], a[4:7]
    v_exp_f32 v148, v148
    v_mfma_f32_16x16x32_bf16 a[20:23], a[164:167], v[212:215], a[20:23]
    buffer_load_dwordx4 v22, s[4:7], s46 offen offset:1024 lds
    v_mfma_f32_16x16x32_bf16 a[36:39], a[168:171], v[212:215], a[36:39]
    v_exp_f32 v149, v149
    v_mfma_f32_16x16x32_bf16 a[52:55], a[172:175], v[212:215], a[52:55]
    v_cvt_pk_bf16_f32 v202, v148, v149
    v_mfma_f32_16x16x32_bf16 a[68:71], a[176:179], v[212:215], a[68:71]
    v_exp_f32 v150, v150
    v_mfma_f32_16x16x32_bf16 a[84:87], a[180:183], v[212:215], a[84:87]
    buffer_load_dwordx4 v23, s[4:7], s46 offen offset:2048 lds
    v_mfma_f32_16x16x32_bf16 a[100:103], a[184:187], v[212:215], a[100:103]
    v_exp_f32 v151, v151
    v_mfma_f32_16x16x32_bf16 a[116:119], a[188:191], v[212:215], a[116:119]
    v_cvt_pk_bf16_f32 v203, v150, v151
    v_mfma_f32_16x16x32_bf16 a[196:199], a[208:211], v[212:215], a[196:199]
    ds_read_b128 a[132:135], v3 offset:16384
    ds_read_b128 a[148:151], v3 offset:17408
    v_mfma_f32_16x16x32_bf16 a[8:11], a[160:163], v[216:219], a[8:11]
    v_exp_f32 v152, v152
    v_mfma_f32_16x16x32_bf16 a[24:27], a[164:167], v[216:219], a[24:27]
    buffer_load_dwordx4 v23, s[4:7], s46 offen offset:3072 lds
    s_add_u32 s46, s46, 16384
    v_mfma_f32_16x16x32_bf16 a[40:43], a[168:171], v[216:219], a[40:43]
    v_exp_f32 v153, v153
    v_mfma_f32_16x16x32_bf16 a[56:59], a[172:175], v[216:219], a[56:59]
    v_cvt_pk_bf16_f32 v204, v152, v153
    v_mfma_f32_16x16x32_bf16 a[72:75], a[176:179], v[216:219], a[72:75]
    v_exp_f32 v154, v154
    v_mfma_f32_16x16x32_bf16 a[88:91], a[180:183], v[216:219], a[88:91]
    v_mfma_f32_16x16x32_bf16 a[104:107], a[184:187], v[216:219], a[104:107]
    v_exp_f32 v155, v155
    v_mfma_f32_16x16x32_bf16 a[120:123], a[188:191], v[216:219], a[120:123]
    v_cvt_pk_bf16_f32 v205, v154, v155
    v_mfma_f32_16x16x32_bf16 a[200:203], a[208:211], v[216:219], a[200:203]
    ds_read_b128 a[136:139], v4 offset:16384
    ds_read_b128 a[152:155], v4 offset:17408
    v_mfma_f32_16x16x32_bf16 a[12:15], a[160:163], v[220:223], a[12:15]
    v_exp_f32 v156, v156
    v_mfma_f32_16x16x32_bf16 a[28:31], a[164:167], v[220:223], a[28:31]
    v_mfma_f32_16x16x32_bf16 a[44:47], a[168:171], v[220:223], a[44:47]
    v_exp_f32 v157, v157
    v_mfma_f32_16x16x32_bf16 a[60:63], a[172:175], v[220:223], a[60:63]
    v_cvt_pk_bf16_f32 v206, v156, v157
    v_mfma_f32_16x16x32_bf16 a[76:79], a[176:179], v[220:223], a[76:79]
    v_exp_f32 v158, v158
    v_mfma_f32_16x16x32_bf16 a[92:95], a[180:183], v[220:223], a[92:95]
    v_mfma_f32_16x16x32_bf16 a[108:111], a[184:187], v[220:223], a[108:111]
    v_exp_f32 v159, v159
    v_mfma_f32_16x16x32_bf16 a[124:127], a[188:191], v[220:223], a[124:127]
    v_cvt_pk_bf16_f32 v207, v158, v159
    v_mfma_f32_16x16x32_bf16 a[204:207], a[208:211], v[220:223], a[204:207]
    ds_read_b128 a[140:143], v5 offset:16384
    ds_read_b128 a[156:159], v5 offset:17408
    s_waitcnt lgkmcnt(2)
    v_mfma_f32_16x16x32_bf16 v[128:131], a[128:131], v[64:67], v[224:227]
    v_exp_f32 v160, v160
    v_mfma_f32_16x16x32_bf16 v[132:135], a[144:147], v[64:67], v[224:227]
    ds_read_b64_tr_b16 a[160:161], v6 offset:32768
    ds_read_b64_tr_b16 a[162:163], v6 offset:33792
    v_mfma_f32_16x16x32_bf16 v[136:139], a[128:131], v[80:83], v[228:231]
    v_exp_f32 v161, v161
    v_mfma_f32_16x16x32_bf16 v[140:143], a[144:147], v[80:83], v[228:231]
    v_cvt_pk_bf16_f32 v208, v160, v161
    v_mfma_f32_16x16x32_bf16 v[144:147], a[128:131], v[96:99], v[232:235]
    v_exp_f32 v162, v162
    v_mfma_f32_16x16x32_bf16 v[148:151], a[144:147], v[96:99], v[232:235]
    ds_read_b64_tr_b16 a[164:165], v7 offset:32768
    ds_read_b64_tr_b16 a[166:167], v7 offset:33792
    v_mfma_f32_16x16x32_bf16 v[152:155], a[128:131], v[112:115], v[236:239]
    v_exp_f32 v163, v163
    v_mfma_f32_16x16x32_bf16 v[156:159], a[144:147], v[112:115], v[236:239]
    v_cvt_pk_bf16_f32 v209, v162, v163
    v_mfma_f32_16x16x32_bf16 v[128:131], a[132:135], v[68:71], v[128:131]
    v_exp_f32 v164, v164
    v_mfma_f32_16x16x32_bf16 v[132:135], a[148:151], v[68:71], v[132:135]
    ds_read_b64_tr_b16 a[168:169], v8 offset:32768
    ds_read_b64_tr_b16 a[170:171], v8 offset:33792
    v_mfma_f32_16x16x32_bf16 v[136:139], a[132:135], v[84:87], v[136:139]
    v_exp_f32 v165, v165
    v_mfma_f32_16x16x32_bf16 v[140:143], a[148:151], v[84:87], v[140:143]
    v_cvt_pk_bf16_f32 v210, v164, v165
    v_mfma_f32_16x16x32_bf16 v[144:147], a[132:135], v[100:103], v[144:147]
    v_exp_f32 v166, v166
    v_mfma_f32_16x16x32_bf16 v[148:151], a[148:151], v[100:103], v[148:151]
    ds_read_b64_tr_b16 a[172:173], v9 offset:32768
    ds_read_b64_tr_b16 a[174:175], v9 offset:33792
    v_mfma_f32_16x16x32_bf16 v[152:155], a[132:135], v[116:119], v[152:155]
    v_exp_f32 v167, v167
    v_mfma_f32_16x16x32_bf16 v[156:159], a[148:151], v[116:119], v[156:159]
    v_cvt_pk_bf16_f32 v211, v166, v167
    v_mfma_f32_16x16x32_bf16 v[128:131], a[136:139], v[72:75], v[128:131]
    v_exp_f32 v168, v168
    v_mfma_f32_16x16x32_bf16 v[132:135], a[152:155], v[72:75], v[132:135]
    ds_read_b64_tr_b16 a[176:177], v10 offset:32768
    ds_read_b64_tr_b16 a[178:179], v10 offset:33792
    v_mfma_f32_16x16x32_bf16 v[136:139], a[136:139], v[88:91], v[136:139]
    v_exp_f32 v169, v169
    v_mfma_f32_16x16x32_bf16 v[140:143], a[152:155], v[88:91], v[140:143]
    v_cvt_pk_bf16_f32 v212, v168, v169
    v_mfma_f32_16x16x32_bf16 v[144:147], a[136:139], v[104:107], v[144:147]
    v_exp_f32 v170, v170
    v_mfma_f32_16x16x32_bf16 v[148:151], a[152:155], v[104:107], v[148:151]
    ds_read_b64_tr_b16 a[180:181], v11 offset:32768
    ds_read_b64_tr_b16 a[182:183], v11 offset:33792
    v_mfma_f32_16x16x32_bf16 v[152:155], a[136:139], v[120:123], v[152:155]
    v_exp_f32 v171, v171
    v_mfma_f32_16x16x32_bf16 v[156:159], a[152:155], v[120:123], v[156:159]
    v_cvt_pk_bf16_f32 v213, v170, v171
    s_waitcnt lgkmcnt(2)
    v_mfma_f32_16x16x32_bf16 v[128:131], a[140:143], v[76:79], v[128:131]
    v_exp_f32 v172, v172
    v_mfma_f32_16x16x32_bf16 v[132:135], a[156:159], v[76:79], v[132:135]
    ds_read_b64_tr_b16 a[184:185], v12 offset:32768
    ds_read_b64_tr_b16 a[186:187], v12 offset:33792
    v_mfma_f32_16x16x32_bf16 v[136:139], a[140:143], v[92:95], v[136:139]
    v_exp_f32 v173, v173
    v_mfma_f32_16x16x32_bf16 v[140:143], a[156:159], v[92:95], v[140:143]
    v_cvt_pk_bf16_f32 v214, v172, v173
    v_mfma_f32_16x16x32_bf16 v[144:147], a[140:143], v[108:111], v[144:147]
    v_exp_f32 v174, v174
    v_mfma_f32_16x16x32_bf16 v[148:151], a[156:159], v[108:111], v[148:151]
    ds_read_b64_tr_b16 a[188:189], v13 offset:32768
    ds_read_b64_tr_b16 a[190:191], v13 offset:33792
    v_mfma_f32_16x16x32_bf16 v[152:155], a[140:143], v[124:127], v[152:155]
    v_exp_f32 v175, v175
    v_mfma_f32_16x16x32_bf16 v[156:159], a[156:159], v[124:127], v[156:159]
    v_cvt_pk_bf16_f32 v215, v174, v175
    v_mfma_f32_16x16x32_bf16 a[0:3], a[160:163], v[192:195], a[0:3]
    v_exp_f32 v176, v176
    v_mfma_f32_16x16x32_bf16 a[16:19], a[164:167], v[192:195], a[16:19]
    v_mfma_f32_16x16x32_bf16 a[32:35], a[168:171], v[192:195], a[32:35]
    v_exp_f32 v177, v177
    v_mfma_f32_16x16x32_bf16 a[48:51], a[172:175], v[192:195], a[48:51]
    v_cvt_pk_bf16_f32 v216, v176, v177
    v_mfma_f32_16x16x32_bf16 a[64:67], a[176:179], v[192:195], a[64:67]
    v_exp_f32 v178, v178
    s_add_u32 m0, s51, 0
    s_waitcnt lgkmcnt(0)
    v_mfma_f32_16x16x32_bf16 a[80:83], a[180:183], v[192:195], a[80:83]
    buffer_load_dwordx4 v24, s[8:11], s47 offen offset:0 lds
    v_mfma_f32_16x16x32_bf16 a[96:99], a[184:187], v[192:195], a[96:99]
    v_exp_f32 v179, v179
    v_mfma_f32_16x16x32_bf16 a[112:115], a[188:191], v[192:195], a[112:115]
    v_cvt_pk_bf16_f32 v217, v178, v179
    v_mfma_f32_16x16x32_bf16 a[192:195], a[208:211], v[192:195], a[192:195]
    ds_read_b128 a[128:131], v2 offset:24576
    ds_read_b128 a[144:147], v2 offset:25600
    v_mfma_f32_16x16x32_bf16 a[4:7], a[160:163], v[196:199], a[4:7]
    v_exp_f32 v180, v180
    v_mfma_f32_16x16x32_bf16 a[20:23], a[164:167], v[196:199], a[20:23]
    buffer_load_dwordx4 v24, s[8:11], s47 offen offset:1024 lds
    v_mfma_f32_16x16x32_bf16 a[36:39], a[168:171], v[196:199], a[36:39]
    v_exp_f32 v181, v181
    v_mfma_f32_16x16x32_bf16 a[52:55], a[172:175], v[196:199], a[52:55]
    v_cvt_pk_bf16_f32 v218, v180, v181
    v_mfma_f32_16x16x32_bf16 a[68:71], a[176:179], v[196:199], a[68:71]
    v_exp_f32 v182, v182
    v_mfma_f32_16x16x32_bf16 a[84:87], a[180:183], v[196:199], a[84:87]
    buffer_load_dwordx4 v25, s[8:11], s47 offen offset:2048 lds
    v_mfma_f32_16x16x32_bf16 a[100:103], a[184:187], v[196:199], a[100:103]
    v_exp_f32 v183, v183
    v_mfma_f32_16x16x32_bf16 a[116:119], a[188:191], v[196:199], a[116:119]
    v_cvt_pk_bf16_f32 v219, v182, v183
    v_mfma_f32_16x16x32_bf16 a[196:199], a[208:211], v[196:199], a[196:199]
    ds_read_b128 a[132:135], v3 offset:24576
    ds_read_b128 a[148:151], v3 offset:25600
    v_mfma_f32_16x16x32_bf16 a[8:11], a[160:163], v[200:203], a[8:11]
    v_exp_f32 v184, v184
    v_mfma_f32_16x16x32_bf16 a[24:27], a[164:167], v[200:203], a[24:27]
    buffer_load_dwordx4 v25, s[8:11], s47 offen offset:3072 lds
    s_add_u32 s47, s47, 16384
    v_mfma_f32_16x16x32_bf16 a[40:43], a[168:171], v[200:203], a[40:43]
    v_exp_f32 v185, v185
    v_mfma_f32_16x16x32_bf16 a[56:59], a[172:175], v[200:203], a[56:59]
    v_cvt_pk_bf16_f32 v220, v184, v185
    v_mfma_f32_16x16x32_bf16 a[72:75], a[176:179], v[200:203], a[72:75]
    v_exp_f32 v186, v186
    v_mfma_f32_16x16x32_bf16 a[88:91], a[180:183], v[200:203], a[88:91]
    v_mfma_f32_16x16x32_bf16 a[104:107], a[184:187], v[200:203], a[104:107]
    v_exp_f32 v187, v187
    v_mfma_f32_16x16x32_bf16 a[120:123], a[188:191], v[200:203], a[120:123]
    v_cvt_pk_bf16_f32 v221, v186, v187
    v_mfma_f32_16x16x32_bf16 a[200:203], a[208:211], v[200:203], a[200:203]
    ds_read_b128 a[136:139], v4 offset:24576
    ds_read_b128 a[152:155], v4 offset:25600
    v_mfma_f32_16x16x32_bf16 a[12:15], a[160:163], v[204:207], a[12:15]
    v_exp_f32 v188, v188
    v_mfma_f32_16x16x32_bf16 a[28:31], a[164:167], v[204:207], a[28:31]
    v_mfma_f32_16x16x32_bf16 a[44:47], a[168:171], v[204:207], a[44:47]
    v_exp_f32 v189, v189
    v_mfma_f32_16x16x32_bf16 a[60:63], a[172:175], v[204:207], a[60:63]
    v_cvt_pk_bf16_f32 v222, v188, v189
    v_mfma_f32_16x16x32_bf16 a[76:79], a[176:179], v[204:207], a[76:79]
    v_exp_f32 v190, v190
    v_mfma_f32_16x16x32_bf16 a[92:95], a[180:183], v[204:207], a[92:95]
    v_mfma_f32_16x16x32_bf16 a[108:111], a[184:187], v[204:207], a[108:111]
    v_exp_f32 v191, v191
    v_mfma_f32_16x16x32_bf16 a[124:127], a[188:191], v[204:207], a[124:127]
    v_cvt_pk_bf16_f32 v223, v190, v191
    v_mfma_f32_16x16x32_bf16 a[204:207], a[208:211], v[204:207], a[204:207]
    ds_read_b128 a[140:143], v5 offset:24576
    ds_read_b128 a[156:159], v5 offset:25600
    s_waitcnt lgkmcnt(2)
    v_mfma_f32_16x16x32_bf16 v[160:163], a[128:131], v[64:67], v[224:227]
    s_waitcnt vmcnt(8)
    s_barrier
    v_exp_f32 v128, v128
    v_mfma_f32_16x16x32_bf16 v[164:167], a[144:147], v[64:67], v[224:227]
    ds_read_b64_tr_b16 a[160:161], v6 offset:40960
    ds_read_b64_tr_b16 a[162:163], v6 offset:41984
    v_mfma_f32_16x16x32_bf16 v[168:171], a[128:131], v[80:83], v[228:231]
    v_exp_f32 v129, v129
    v_mfma_f32_16x16x32_bf16 v[172:175], a[144:147], v[80:83], v[228:231]
    v_cvt_pk_bf16_f32 v192, v128, v129
    v_mfma_f32_16x16x32_bf16 v[176:179], a[128:131], v[96:99], v[232:235]
    v_exp_f32 v130, v130
    v_mfma_f32_16x16x32_bf16 v[180:183], a[144:147], v[96:99], v[232:235]
    ds_read_b64_tr_b16 a[164:165], v7 offset:40960
    ds_read_b64_tr_b16 a[166:167], v7 offset:41984
    v_mfma_f32_16x16x32_bf16 v[184:187], a[128:131], v[112:115], v[236:239]
    v_exp_f32 v131, v131
    v_mfma_f32_16x16x32_bf16 v[188:191], a[144:147], v[112:115], v[236:239]
    v_cvt_pk_bf16_f32 v193, v130, v131
    v_mfma_f32_16x16x32_bf16 v[160:163], a[132:135], v[68:71], v[160:163]
    v_exp_f32 v132, v132
    v_mfma_f32_16x16x32_bf16 v[164:167], a[148:151], v[68:71], v[164:167]
    ds_read_b64_tr_b16 a[168:169], v8 offset:40960
    ds_read_b64_tr_b16 a[170:171], v8 offset:41984
    v_mfma_f32_16x16x32_bf16 v[168:171], a[132:135], v[84:87], v[168:171]
    v_exp_f32 v133, v133
    v_mfma_f32_16x16x32_bf16 v[172:175], a[148:151], v[84:87], v[172:175]
    v_cvt_pk_bf16_f32 v194, v132, v133
    v_mfma_f32_16x16x32_bf16 v[176:179], a[132:135], v[100:103], v[176:179]
    v_exp_f32 v134, v134
    v_mfma_f32_16x16x32_bf16 v[180:183], a[148:151], v[100:103], v[180:183]
    ds_read_b64_tr_b16 a[172:173], v9 offset:40960
    ds_read_b64_tr_b16 a[174:175], v9 offset:41984
    v_mfma_f32_16x16x32_bf16 v[184:187], a[132:135], v[116:119], v[184:187]
    v_exp_f32 v135, v135
    v_mfma_f32_16x16x32_bf16 v[188:191], a[148:151], v[116:119], v[188:191]
    v_cvt_pk_bf16_f32 v195, v134, v135
    v_mfma_f32_16x16x32_bf16 v[160:163], a[136:139], v[72:75], v[160:163]
    v_exp_f32 v136, v136
    v_mfma_f32_16x16x32_bf16 v[164:167], a[152:155], v[72:75], v[164:167]
    ds_read_b64_tr_b16 a[176:177], v10 offset:40960
    ds_read_b64_tr_b16 a[178:179], v10 offset:41984
    v_mfma_f32_16x16x32_bf16 v[168:171], a[136:139], v[88:91], v[168:171]
    v_exp_f32 v137, v137
    v_mfma_f32_16x16x32_bf16 v[172:175], a[152:155], v[88:91], v[172:175]
    v_cvt_pk_bf16_f32 v196, v136, v137
    v_mfma_f32_16x16x32_bf16 v[176:179], a[136:139], v[104:107], v[176:179]
    v_exp_f32 v138, v138
    v_mfma_f32_16x16x32_bf16 v[180:183], a[152:155], v[104:107], v[180:183]
    ds_read_b64_tr_b16 a[180:181], v11 offset:40960
    ds_read_b64_tr_b16 a[182:183], v11 offset:41984
    v_mfma_f32_16x16x32_bf16 v[184:187], a[136:139], v[120:123], v[184:187]
    v_exp_f32 v139, v139
    v_mfma_f32_16x16x32_bf16 v[188:191], a[152:155], v[120:123], v[188:191]
    v_cvt_pk_bf16_f32 v197, v138, v139
    s_waitcnt lgkmcnt(2)
    v_mfma_f32_16x16x32_bf16 v[160:163], a[140:143], v[76:79], v[160:163]
    v_exp_f32 v140, v140
    v_mfma_f32_16x16x32_bf16 v[164:167], a[156:159], v[76:79], v[164:167]
    ds_read_b64_tr_b16 a[184:185], v12 offset:40960
    ds_read_b64_tr_b16 a[186:187], v12 offset:41984
    v_mfma_f32_16x16x32_bf16 v[168:171], a[140:143], v[92:95], v[168:171]
    v_exp_f32 v141, v141
    v_mfma_f32_16x16x32_bf16 v[172:175], a[156:159], v[92:95], v[172:175]
    v_cvt_pk_bf16_f32 v198, v140, v141
    v_mfma_f32_16x16x32_bf16 v[176:179], a[140:143], v[108:111], v[176:179]
    v_exp_f32 v142, v142
    v_mfma_f32_16x16x32_bf16 v[180:183], a[156:159], v[108:111], v[180:183]
    ds_read_b64_tr_b16 a[188:189], v13 offset:40960
    ds_read_b64_tr_b16 a[190:191], v13 offset:41984
    v_mfma_f32_16x16x32_bf16 v[184:187], a[140:143], v[124:127], v[184:187]
    v_exp_f32 v143, v143
    v_mfma_f32_16x16x32_bf16 v[188:191], a[156:159], v[124:127], v[188:191]
    v_cvt_pk_bf16_f32 v199, v142, v143
    v_mfma_f32_16x16x32_bf16 a[0:3], a[160:163], v[208:211], a[0:3]
    v_exp_f32 v144, v144
    v_mfma_f32_16x16x32_bf16 a[16:19], a[164:167], v[208:211], a[16:19]
    v_mfma_f32_16x16x32_bf16 a[32:35], a[168:171], v[208:211], a[32:35]
    v_exp_f32 v145, v145
    v_mfma_f32_16x16x32_bf16 a[48:51], a[172:175], v[208:211], a[48:51]
    v_cvt_pk_bf16_f32 v200, v144, v145
    v_mfma_f32_16x16x32_bf16 a[64:67], a[176:179], v[208:211], a[64:67]
    v_exp_f32 v146, v146
    s_add_u32 m0, s43, 0
    s_waitcnt lgkmcnt(0)
    v_mfma_f32_16x16x32_bf16 a[80:83], a[180:183], v[208:211], a[80:83]
    buffer_load_dwordx4 v22, s[4:7], s46 offen offset:0 lds
    v_mfma_f32_16x16x32_bf16 a[96:99], a[184:187], v[208:211], a[96:99]
    v_exp_f32 v147, v147
    v_mfma_f32_16x16x32_bf16 a[112:115], a[188:191], v[208:211], a[112:115]
    v_cvt_pk_bf16_f32 v201, v146, v147
    v_mfma_f32_16x16x32_bf16 a[192:195], a[208:211], v[208:211], a[192:195]
    ds_read_b128 a[128:131], v2 offset:32768
    ds_read_b128 a[144:147], v2 offset:33792
    v_mfma_f32_16x16x32_bf16 a[4:7], a[160:163], v[212:215], a[4:7]
    v_exp_f32 v148, v148
    v_mfma_f32_16x16x32_bf16 a[20:23], a[164:167], v[212:215], a[20:23]
    buffer_load_dwordx4 v22, s[4:7], s46 offen offset:1024 lds
    v_mfma_f32_16x16x32_bf16 a[36:39], a[168:171], v[212:215], a[36:39]
    v_exp_f32 v149, v149
    v_mfma_f32_16x16x32_bf16 a[52:55], a[172:175], v[212:215], a[52:55]
    v_cvt_pk_bf16_f32 v202, v148, v149
    v_mfma_f32_16x16x32_bf16 a[68:71], a[176:179], v[212:215], a[68:71]
    v_exp_f32 v150, v150
    v_mfma_f32_16x16x32_bf16 a[84:87], a[180:183], v[212:215], a[84:87]
    buffer_load_dwordx4 v23, s[4:7], s46 offen offset:2048 lds
    v_mfma_f32_16x16x32_bf16 a[100:103], a[184:187], v[212:215], a[100:103]
    v_exp_f32 v151, v151
    v_mfma_f32_16x16x32_bf16 a[116:119], a[188:191], v[212:215], a[116:119]
    v_cvt_pk_bf16_f32 v203, v150, v151
    v_mfma_f32_16x16x32_bf16 a[196:199], a[208:211], v[212:215], a[196:199]
    ds_read_b128 a[132:135], v3 offset:32768
    ds_read_b128 a[148:151], v3 offset:33792
    v_mfma_f32_16x16x32_bf16 a[8:11], a[160:163], v[216:219], a[8:11]
    v_exp_f32 v152, v152
    v_mfma_f32_16x16x32_bf16 a[24:27], a[164:167], v[216:219], a[24:27]
    buffer_load_dwordx4 v23, s[4:7], s46 offen offset:3072 lds
    s_add_u32 s46, s46, 16384
    v_mfma_f32_16x16x32_bf16 a[40:43], a[168:171], v[216:219], a[40:43]
    v_exp_f32 v153, v153
    v_mfma_f32_16x16x32_bf16 a[56:59], a[172:175], v[216:219], a[56:59]
    v_cvt_pk_bf16_f32 v204, v152, v153
    v_mfma_f32_16x16x32_bf16 a[72:75], a[176:179], v[216:219], a[72:75]
    v_exp_f32 v154, v154
    v_mfma_f32_16x16x32_bf16 a[88:91], a[180:183], v[216:219], a[88:91]
    v_mfma_f32_16x16x32_bf16 a[104:107], a[184:187], v[216:219], a[104:107]
    v_exp_f32 v155, v155
    v_mfma_f32_16x16x32_bf16 a[120:123], a[188:191], v[216:219], a[120:123]
    v_cvt_pk_bf16_f32 v205, v154, v155
    v_mfma_f32_16x16x32_bf16 a[200:203], a[208:211], v[216:219], a[200:203]
    ds_read_b128 a[136:139], v4 offset:32768
    ds_read_b128 a[152:155], v4 offset:33792
    v_mfma_f32_16x16x32_bf16 a[12:15], a[160:163], v[220:223], a[12:15]
    v_exp_f32 v156, v156
    v_mfma_f32_16x16x32_bf16 a[28:31], a[164:167], v[220:223], a[28:31]
    v_mfma_f32_16x16x32_bf16 a[44:47], a[168:171], v[220:223], a[44:47]
    v_exp_f32 v157, v157
    v_mfma_f32_16x16x32_bf16 a[60:63], a[172:175], v[220:223], a[60:63]
    v_cvt_pk_bf16_f32 v206, v156, v157
    v_mfma_f32_16x16x32_bf16 a[76:79], a[176:179], v[220:223], a[76:79]
    v_exp_f32 v158, v158
    v_mfma_f32_16x16x32_bf16 a[92:95], a[180:183], v[220:223], a[92:95]
    v_mfma_f32_16x16x32_bf16 a[108:111], a[184:187], v[220:223], a[108:111]
    v_exp_f32 v159, v159
    v_mfma_f32_16x16x32_bf16 a[124:127], a[188:191], v[220:223], a[124:127]
    v_cvt_pk_bf16_f32 v207, v158, v159
    v_mfma_f32_16x16x32_bf16 a[204:207], a[208:211], v[220:223], a[204:207]
    ds_read_b128 a[140:143], v5 offset:32768
    ds_read_b128 a[156:159], v5 offset:33792
    s_waitcnt lgkmcnt(2)
    v_mfma_f32_16x16x32_bf16 v[128:131], a[128:131], v[64:67], v[224:227]
    v_exp_f32 v160, v160
    v_mfma_f32_16x16x32_bf16 v[132:135], a[144:147], v[64:67], v[224:227]
    ds_read_b64_tr_b16 a[160:161], v6 offset:49152
    ds_read_b64_tr_b16 a[162:163], v6 offset:50176
    v_mfma_f32_16x16x32_bf16 v[136:139], a[128:131], v[80:83], v[228:231]
    v_exp_f32 v161, v161
    v_mfma_f32_16x16x32_bf16 v[140:143], a[144:147], v[80:83], v[228:231]
    v_cvt_pk_bf16_f32 v208, v160, v161
    v_mfma_f32_16x16x32_bf16 v[144:147], a[128:131], v[96:99], v[232:235]
    v_exp_f32 v162, v162
    v_mfma_f32_16x16x32_bf16 v[148:151], a[144:147], v[96:99], v[232:235]
    ds_read_b64_tr_b16 a[164:165], v7 offset:49152
    ds_read_b64_tr_b16 a[166:167], v7 offset:50176
    v_mfma_f32_16x16x32_bf16 v[152:155], a[128:131], v[112:115], v[236:239]
    v_exp_f32 v163, v163
    v_mfma_f32_16x16x32_bf16 v[156:159], a[144:147], v[112:115], v[236:239]
    v_cvt_pk_bf16_f32 v209, v162, v163
    v_mfma_f32_16x16x32_bf16 v[128:131], a[132:135], v[68:71], v[128:131]
    v_exp_f32 v164, v164
    v_mfma_f32_16x16x32_bf16 v[132:135], a[148:151], v[68:71], v[132:135]
    ds_read_b64_tr_b16 a[168:169], v8 offset:49152
    ds_read_b64_tr_b16 a[170:171], v8 offset:50176
    v_mfma_f32_16x16x32_bf16 v[136:139], a[132:135], v[84:87], v[136:139]
    v_exp_f32 v165, v165
    v_mfma_f32_16x16x32_bf16 v[140:143], a[148:151], v[84:87], v[140:143]
    v_cvt_pk_bf16_f32 v210, v164, v165
    v_mfma_f32_16x16x32_bf16 v[144:147], a[132:135], v[100:103], v[144:147]
    v_exp_f32 v166, v166
    v_mfma_f32_16x16x32_bf16 v[148:151], a[148:151], v[100:103], v[148:151]
    ds_read_b64_tr_b16 a[172:173], v9 offset:49152
    ds_read_b64_tr_b16 a[174:175], v9 offset:50176
    v_mfma_f32_16x16x32_bf16 v[152:155], a[132:135], v[116:119], v[152:155]
    v_exp_f32 v167, v167
    v_mfma_f32_16x16x32_bf16 v[156:159], a[148:151], v[116:119], v[156:159]
    v_cvt_pk_bf16_f32 v211, v166, v167
    v_mfma_f32_16x16x32_bf16 v[128:131], a[136:139], v[72:75], v[128:131]
    v_exp_f32 v168, v168
    v_mfma_f32_16x16x32_bf16 v[132:135], a[152:155], v[72:75], v[132:135]
    ds_read_b64_tr_b16 a[176:177], v10 offset:49152
    ds_read_b64_tr_b16 a[178:179], v10 offset:50176
    v_mfma_f32_16x16x32_bf16 v[136:139], a[136:139], v[88:91], v[136:139]
    v_exp_f32 v169, v169
    v_mfma_f32_16x16x32_bf16 v[140:143], a[152:155], v[88:91], v[140:143]
    v_cvt_pk_bf16_f32 v212, v168, v169
    v_mfma_f32_16x16x32_bf16 v[144:147], a[136:139], v[104:107], v[144:147]
    v_exp_f32 v170, v170
    v_mfma_f32_16x16x32_bf16 v[148:151], a[152:155], v[104:107], v[148:151]
    ds_read_b64_tr_b16 a[180:181], v11 offset:49152
    ds_read_b64_tr_b16 a[182:183], v11 offset:50176
    v_mfma_f32_16x16x32_bf16 v[152:155], a[136:139], v[120:123], v[152:155]
    v_exp_f32 v171, v171
    v_mfma_f32_16x16x32_bf16 v[156:159], a[152:155], v[120:123], v[156:159]
    v_cvt_pk_bf16_f32 v213, v170, v171
    s_waitcnt lgkmcnt(2)
    v_mfma_f32_16x16x32_bf16 v[128:131], a[140:143], v[76:79], v[128:131]
    v_exp_f32 v172, v172
    v_mfma_f32_16x16x32_bf16 v[132:135], a[156:159], v[76:79], v[132:135]
    ds_read_b64_tr_b16 a[184:185], v12 offset:49152
    ds_read_b64_tr_b16 a[186:187], v12 offset:50176
    v_mfma_f32_16x16x32_bf16 v[136:139], a[140:143], v[92:95], v[136:139]
    v_exp_f32 v173, v173
    v_mfma_f32_16x16x32_bf16 v[140:143], a[156:159], v[92:95], v[140:143]
    v_cvt_pk_bf16_f32 v214, v172, v173
    v_mfma_f32_16x16x32_bf16 v[144:147], a[140:143], v[108:111], v[144:147]
    v_exp_f32 v174, v174
    v_mfma_f32_16x16x32_bf16 v[148:151], a[156:159], v[108:111], v[148:151]
    ds_read_b64_tr_b16 a[188:189], v13 offset:49152
    ds_read_b64_tr_b16 a[190:191], v13 offset:50176
    v_mfma_f32_16x16x32_bf16 v[152:155], a[140:143], v[124:127], v[152:155]
    v_exp_f32 v175, v175
    v_mfma_f32_16x16x32_bf16 v[156:159], a[156:159], v[124:127], v[156:159]
    v_cvt_pk_bf16_f32 v215, v174, v175
    v_mfma_f32_16x16x32_bf16 a[0:3], a[160:163], v[192:195], a[0:3]
    v_exp_f32 v176, v176
    v_mfma_f32_16x16x32_bf16 a[16:19], a[164:167], v[192:195], a[16:19]
    v_mfma_f32_16x16x32_bf16 a[32:35], a[168:171], v[192:195], a[32:35]
    v_exp_f32 v177, v177
    v_mfma_f32_16x16x32_bf16 a[48:51], a[172:175], v[192:195], a[48:51]
    v_cvt_pk_bf16_f32 v216, v176, v177
    v_mfma_f32_16x16x32_bf16 a[64:67], a[176:179], v[192:195], a[64:67]
    v_exp_f32 v178, v178
    s_add_u32 m0, s51, 16384
    s_waitcnt lgkmcnt(0)
    v_mfma_f32_16x16x32_bf16 a[80:83], a[180:183], v[192:195], a[80:83]
    buffer_load_dwordx4 v24, s[8:11], s47 offen offset:0 lds
    v_mfma_f32_16x16x32_bf16 a[96:99], a[184:187], v[192:195], a[96:99]
    v_exp_f32 v179, v179
    v_mfma_f32_16x16x32_bf16 a[112:115], a[188:191], v[192:195], a[112:115]
    v_cvt_pk_bf16_f32 v217, v178, v179
    v_mfma_f32_16x16x32_bf16 a[192:195], a[208:211], v[192:195], a[192:195]
    ds_read_b128 a[128:131], v2 offset:40960
    ds_read_b128 a[144:147], v2 offset:41984
    v_mfma_f32_16x16x32_bf16 a[4:7], a[160:163], v[196:199], a[4:7]
    v_exp_f32 v180, v180
    v_mfma_f32_16x16x32_bf16 a[20:23], a[164:167], v[196:199], a[20:23]
    buffer_load_dwordx4 v24, s[8:11], s47 offen offset:1024 lds
    v_mfma_f32_16x16x32_bf16 a[36:39], a[168:171], v[196:199], a[36:39]
    v_exp_f32 v181, v181
    v_mfma_f32_16x16x32_bf16 a[52:55], a[172:175], v[196:199], a[52:55]
    v_cvt_pk_bf16_f32 v218, v180, v181
    v_mfma_f32_16x16x32_bf16 a[68:71], a[176:179], v[196:199], a[68:71]
    v_exp_f32 v182, v182
    v_mfma_f32_16x16x32_bf16 a[84:87], a[180:183], v[196:199], a[84:87]
    buffer_load_dwordx4 v25, s[8:11], s47 offen offset:2048 lds
    v_mfma_f32_16x16x32_bf16 a[100:103], a[184:187], v[196:199], a[100:103]
    v_exp_f32 v183, v183
    v_mfma_f32_16x16x32_bf16 a[116:119], a[188:191], v[196:199], a[116:119]
    v_cvt_pk_bf16_f32 v219, v182, v183
    v_mfma_f32_16x16x32_bf16 a[196:199], a[208:211], v[196:199], a[196:199]
    ds_read_b128 a[132:135], v3 offset:40960
    ds_read_b128 a[148:151], v3 offset:41984
    v_mfma_f32_16x16x32_bf16 a[8:11], a[160:163], v[200:203], a[8:11]
    v_exp_f32 v184, v184
    v_mfma_f32_16x16x32_bf16 a[24:27], a[164:167], v[200:203], a[24:27]
    buffer_load_dwordx4 v25, s[8:11], s47 offen offset:3072 lds
    s_add_u32 s47, s47, 16384
    v_mfma_f32_16x16x32_bf16 a[40:43], a[168:171], v[200:203], a[40:43]
    v_exp_f32 v185, v185
    v_mfma_f32_16x16x32_bf16 a[56:59], a[172:175], v[200:203], a[56:59]
    v_cvt_pk_bf16_f32 v220, v184, v185
    v_mfma_f32_16x16x32_bf16 a[72:75], a[176:179], v[200:203], a[72:75]
    v_exp_f32 v186, v186
    v_mfma_f32_16x16x32_bf16 a[88:91], a[180:183], v[200:203], a[88:91]
    v_mfma_f32_16x16x32_bf16 a[104:107], a[184:187], v[200:203], a[104:107]
    v_exp_f32 v187, v187
    v_mfma_f32_16x16x32_bf16 a[120:123], a[188:191], v[200:203], a[120:123]
    v_cvt_pk_bf16_f32 v221, v186, v187
    v_mfma_f32_16x16x32_bf16 a[200:203], a[208:211], v[200:203], a[200:203]
    ds_read_b128 a[136:139], v4 offset:40960
    ds_read_b128 a[152:155], v4 offset:41984
    v_mfma_f32_16x16x32_bf16 a[12:15], a[160:163], v[204:207], a[12:15]
    v_exp_f32 v188, v188
    v_mfma_f32_16x16x32_bf16 a[28:31], a[164:167], v[204:207], a[28:31]
    v_mfma_f32_16x16x32_bf16 a[44:47], a[168:171], v[204:207], a[44:47]
    v_exp_f32 v189, v189
    v_mfma_f32_16x16x32_bf16 a[60:63], a[172:175], v[204:207], a[60:63]
    v_cvt_pk_bf16_f32 v222, v188, v189
    v_mfma_f32_16x16x32_bf16 a[76:79], a[176:179], v[204:207], a[76:79]
    v_exp_f32 v190, v190
    v_mfma_f32_16x16x32_bf16 a[92:95], a[180:183], v[204:207], a[92:95]
    v_mfma_f32_16x16x32_bf16 a[108:111], a[184:187], v[204:207], a[108:111]
    v_exp_f32 v191, v191
    v_mfma_f32_16x16x32_bf16 a[124:127], a[188:191], v[204:207], a[124:127]
    v_cvt_pk_bf16_f32 v223, v190, v191
    v_mfma_f32_16x16x32_bf16 a[204:207], a[208:211], v[204:207], a[204:207]
    ds_read_b128 a[140:143], v5 offset:40960
    ds_read_b128 a[156:159], v5 offset:41984
    s_waitcnt lgkmcnt(2)
    v_mfma_f32_16x16x32_bf16 v[160:163], a[128:131], v[64:67], v[224:227]
    s_waitcnt vmcnt(8)
    s_barrier
    v_exp_f32 v128, v128
    v_mfma_f32_16x16x32_bf16 v[164:167], a[144:147], v[64:67], v[224:227]
    ds_read_b64_tr_b16 a[160:161], v6 offset:57344
    ds_read_b64_tr_b16 a[162:163], v6 offset:58368
    v_mfma_f32_16x16x32_bf16 v[168:171], a[128:131], v[80:83], v[228:231]
    v_exp_f32 v129, v129
    v_mfma_f32_16x16x32_bf16 v[172:175], a[144:147], v[80:83], v[228:231]
    v_cvt_pk_bf16_f32 v192, v128, v129
    v_mfma_f32_16x16x32_bf16 v[176:179], a[128:131], v[96:99], v[232:235]
    v_exp_f32 v130, v130
    v_mfma_f32_16x16x32_bf16 v[180:183], a[144:147], v[96:99], v[232:235]
    ds_read_b64_tr_b16 a[164:165], v7 offset:57344
    ds_read_b64_tr_b16 a[166:167], v7 offset:58368
    v_mfma_f32_16x16x32_bf16 v[184:187], a[128:131], v[112:115], v[236:239]
    v_exp_f32 v131, v131
    v_mfma_f32_16x16x32_bf16 v[188:191], a[144:147], v[112:115], v[236:239]
    v_cvt_pk_bf16_f32 v193, v130, v131
    v_mfma_f32_16x16x32_bf16 v[160:163], a[132:135], v[68:71], v[160:163]
    v_exp_f32 v132, v132
    v_mfma_f32_16x16x32_bf16 v[164:167], a[148:151], v[68:71], v[164:167]
    ds_read_b64_tr_b16 a[168:169], v8 offset:57344
    ds_read_b64_tr_b16 a[170:171], v8 offset:58368
    v_mfma_f32_16x16x32_bf16 v[168:171], a[132:135], v[84:87], v[168:171]
    v_exp_f32 v133, v133
    v_mfma_f32_16x16x32_bf16 v[172:175], a[148:151], v[84:87], v[172:175]
    v_cvt_pk_bf16_f32 v194, v132, v133
    v_mfma_f32_16x16x32_bf16 v[176:179], a[132:135], v[100:103], v[176:179]
    v_exp_f32 v134, v134
    v_mfma_f32_16x16x32_bf16 v[180:183], a[148:151], v[100:103], v[180:183]
    ds_read_b64_tr_b16 a[172:173], v9 offset:57344
    ds_read_b64_tr_b16 a[174:175], v9 offset:58368
    v_mfma_f32_16x16x32_bf16 v[184:187], a[132:135], v[116:119], v[184:187]
    v_exp_f32 v135, v135
    v_mfma_f32_16x16x32_bf16 v[188:191], a[148:151], v[116:119], v[188:191]
    v_cvt_pk_bf16_f32 v195, v134, v135
    v_mfma_f32_16x16x32_bf16 v[160:163], a[136:139], v[72:75], v[160:163]
    v_exp_f32 v136, v136
    v_mfma_f32_16x16x32_bf16 v[164:167], a[152:155], v[72:75], v[164:167]
    ds_read_b64_tr_b16 a[176:177], v10 offset:57344
    ds_read_b64_tr_b16 a[178:179], v10 offset:58368
    v_mfma_f32_16x16x32_bf16 v[168:171], a[136:139], v[88:91], v[168:171]
    v_exp_f32 v137, v137
    v_mfma_f32_16x16x32_bf16 v[172:175], a[152:155], v[88:91], v[172:175]
    v_cvt_pk_bf16_f32 v196, v136, v137
    v_mfma_f32_16x16x32_bf16 v[176:179], a[136:139], v[104:107], v[176:179]
    v_exp_f32 v138, v138
    v_mfma_f32_16x16x32_bf16 v[180:183], a[152:155], v[104:107], v[180:183]
    ds_read_b64_tr_b16 a[180:181], v11 offset:57344
    ds_read_b64_tr_b16 a[182:183], v11 offset:58368
    v_mfma_f32_16x16x32_bf16 v[184:187], a[136:139], v[120:123], v[184:187]
    v_exp_f32 v139, v139
    v_mfma_f32_16x16x32_bf16 v[188:191], a[152:155], v[120:123], v[188:191]
    v_cvt_pk_bf16_f32 v197, v138, v139
    s_waitcnt lgkmcnt(2)
    v_mfma_f32_16x16x32_bf16 v[160:163], a[140:143], v[76:79], v[160:163]
    v_exp_f32 v140, v140
    v_mfma_f32_16x16x32_bf16 v[164:167], a[156:159], v[76:79], v[164:167]
    ds_read_b64_tr_b16 a[184:185], v12 offset:57344
    ds_read_b64_tr_b16 a[186:187], v12 offset:58368
    v_mfma_f32_16x16x32_bf16 v[168:171], a[140:143], v[92:95], v[168:171]
    v_exp_f32 v141, v141
    v_mfma_f32_16x16x32_bf16 v[172:175], a[156:159], v[92:95], v[172:175]
    v_cvt_pk_bf16_f32 v198, v140, v141
    v_mfma_f32_16x16x32_bf16 v[176:179], a[140:143], v[108:111], v[176:179]
    v_exp_f32 v142, v142
    v_mfma_f32_16x16x32_bf16 v[180:183], a[156:159], v[108:111], v[180:183]
    ds_read_b64_tr_b16 a[188:189], v13 offset:57344
    ds_read_b64_tr_b16 a[190:191], v13 offset:58368
    v_mfma_f32_16x16x32_bf16 v[184:187], a[140:143], v[124:127], v[184:187]
    v_exp_f32 v143, v143
    v_mfma_f32_16x16x32_bf16 v[188:191], a[156:159], v[124:127], v[188:191]
    v_cvt_pk_bf16_f32 v199, v142, v143
    v_mfma_f32_16x16x32_bf16 a[0:3], a[160:163], v[208:211], a[0:3]
    v_exp_f32 v144, v144
    v_mfma_f32_16x16x32_bf16 a[16:19], a[164:167], v[208:211], a[16:19]
    v_mfma_f32_16x16x32_bf16 a[32:35], a[168:171], v[208:211], a[32:35]
    v_exp_f32 v145, v145
    v_mfma_f32_16x16x32_bf16 a[48:51], a[172:175], v[208:211], a[48:51]
    v_cvt_pk_bf16_f32 v200, v144, v145
    v_mfma_f32_16x16x32_bf16 a[64:67], a[176:179], v[208:211], a[64:67]
    v_exp_f32 v146, v146
    s_add_u32 m0, s43, 16384
    s_waitcnt lgkmcnt(0)
    v_mfma_f32_16x16x32_bf16 a[80:83], a[180:183], v[208:211], a[80:83]
    buffer_load_dwordx4 v22, s[4:7], s46 offen offset:0 lds
    v_mfma_f32_16x16x32_bf16 a[96:99], a[184:187], v[208:211], a[96:99]
    v_exp_f32 v147, v147
    v_mfma_f32_16x16x32_bf16 a[112:115], a[188:191], v[208:211], a[112:115]
    v_cvt_pk_bf16_f32 v201, v146, v147
    v_mfma_f32_16x16x32_bf16 a[192:195], a[208:211], v[208:211], a[192:195]
    ds_read_b128 a[128:131], v2 offset:49152
    ds_read_b128 a[144:147], v2 offset:50176
    v_mfma_f32_16x16x32_bf16 a[4:7], a[160:163], v[212:215], a[4:7]
    v_exp_f32 v148, v148
    v_mfma_f32_16x16x32_bf16 a[20:23], a[164:167], v[212:215], a[20:23]
    buffer_load_dwordx4 v22, s[4:7], s46 offen offset:1024 lds
    v_mfma_f32_16x16x32_bf16 a[36:39], a[168:171], v[212:215], a[36:39]
    v_exp_f32 v149, v149
    v_mfma_f32_16x16x32_bf16 a[52:55], a[172:175], v[212:215], a[52:55]
    v_cvt_pk_bf16_f32 v202, v148, v149
    v_mfma_f32_16x16x32_bf16 a[68:71], a[176:179], v[212:215], a[68:71]
    v_exp_f32 v150, v150
    v_mfma_f32_16x16x32_bf16 a[84:87], a[180:183], v[212:215], a[84:87]
    buffer_load_dwordx4 v23, s[4:7], s46 offen offset:2048 lds
    v_mfma_f32_16x16x32_bf16 a[100:103], a[184:187], v[212:215], a[100:103]
    v_exp_f32 v151, v151
    v_mfma_f32_16x16x32_bf16 a[116:119], a[188:191], v[212:215], a[116:119]
    v_cvt_pk_bf16_f32 v203, v150, v151
    v_mfma_f32_16x16x32_bf16 a[196:199], a[208:211], v[212:215], a[196:199]
    ds_read_b128 a[132:135], v3 offset:49152
    ds_read_b128 a[148:151], v3 offset:50176
    v_mfma_f32_16x16x32_bf16 a[8:11], a[160:163], v[216:219], a[8:11]
    v_exp_f32 v152, v152
    v_mfma_f32_16x16x32_bf16 a[24:27], a[164:167], v[216:219], a[24:27]
    buffer_load_dwordx4 v23, s[4:7], s46 offen offset:3072 lds
    s_add_u32 s46, s46, 16384
    v_mfma_f32_16x16x32_bf16 a[40:43], a[168:171], v[216:219], a[40:43]
    v_exp_f32 v153, v153
    v_mfma_f32_16x16x32_bf16 a[56:59], a[172:175], v[216:219], a[56:59]
    v_cvt_pk_bf16_f32 v204, v152, v153
    v_mfma_f32_16x16x32_bf16 a[72:75], a[176:179], v[216:219], a[72:75]
    v_exp_f32 v154, v154
    v_mfma_f32_16x16x32_bf16 a[88:91], a[180:183], v[216:219], a[88:91]
    v_mfma_f32_16x16x32_bf16 a[104:107], a[184:187], v[216:219], a[104:107]
    v_exp_f32 v155, v155
    v_mfma_f32_16x16x32_bf16 a[120:123], a[188:191], v[216:219], a[120:123]
    v_cvt_pk_bf16_f32 v205, v154, v155
    v_mfma_f32_16x16x32_bf16 a[200:203], a[208:211], v[216:219], a[200:203]
    ds_read_b128 a[136:139], v4 offset:49152
    ds_read_b128 a[152:155], v4 offset:50176
    v_mfma_f32_16x16x32_bf16 a[12:15], a[160:163], v[220:223], a[12:15]
    v_exp_f32 v156, v156
    v_mfma_f32_16x16x32_bf16 a[28:31], a[164:167], v[220:223], a[28:31]
    v_mfma_f32_16x16x32_bf16 a[44:47], a[168:171], v[220:223], a[44:47]
    v_exp_f32 v157, v157
    v_mfma_f32_16x16x32_bf16 a[60:63], a[172:175], v[220:223], a[60:63]
    v_cvt_pk_bf16_f32 v206, v156, v157
    v_mfma_f32_16x16x32_bf16 a[76:79], a[176:179], v[220:223], a[76:79]
    v_exp_f32 v158, v158
    v_mfma_f32_16x16x32_bf16 a[92:95], a[180:183], v[220:223], a[92:95]
    v_mfma_f32_16x16x32_bf16 a[108:111], a[184:187], v[220:223], a[108:111]
    v_exp_f32 v159, v159
    v_mfma_f32_16x16x32_bf16 a[124:127], a[188:191], v[220:223], a[124:127]
    v_cvt_pk_bf16_f32 v207, v158, v159
    v_mfma_f32_16x16x32_bf16 a[204:207], a[208:211], v[220:223], a[204:207]
    ds_read_b128 a[140:143], v5 offset:49152
    ds_read_b128 a[156:159], v5 offset:50176
    s_waitcnt lgkmcnt(2)
    v_mfma_f32_16x16x32_bf16 v[128:131], a[128:131], v[64:67], v[224:227]
    v_exp_f32 v160, v160
    v_mfma_f32_16x16x32_bf16 v[132:135], a[144:147], v[64:67], v[224:227]
    ds_read_b64_tr_b16 a[160:161], v6 offset:0
    ds_read_b64_tr_b16 a[162:163], v6 offset:1024
    v_mfma_f32_16x16x32_bf16 v[136:139], a[128:131], v[80:83], v[228:231]
    v_exp_f32 v161, v161
    v_mfma_f32_16x16x32_bf16 v[140:143], a[144:147], v[80:83], v[228:231]
    v_cvt_pk_bf16_f32 v208, v160, v161
    v_mfma_f32_16x16x32_bf16 v[144:147], a[128:131], v[96:99], v[232:235]
    v_exp_f32 v162, v162
    v_mfma_f32_16x16x32_bf16 v[148:151], a[144:147], v[96:99], v[232:235]
    ds_read_b64_tr_b16 a[164:165], v7 offset:0
    ds_read_b64_tr_b16 a[166:167], v7 offset:1024
    v_mfma_f32_16x16x32_bf16 v[152:155], a[128:131], v[112:115], v[236:239]
    v_exp_f32 v163, v163
    v_mfma_f32_16x16x32_bf16 v[156:159], a[144:147], v[112:115], v[236:239]
    v_cvt_pk_bf16_f32 v209, v162, v163
    v_mfma_f32_16x16x32_bf16 v[128:131], a[132:135], v[68:71], v[128:131]
    v_exp_f32 v164, v164
    v_mfma_f32_16x16x32_bf16 v[132:135], a[148:151], v[68:71], v[132:135]
    ds_read_b64_tr_b16 a[168:169], v8 offset:0
    ds_read_b64_tr_b16 a[170:171], v8 offset:1024
    v_mfma_f32_16x16x32_bf16 v[136:139], a[132:135], v[84:87], v[136:139]
    v_exp_f32 v165, v165
    v_mfma_f32_16x16x32_bf16 v[140:143], a[148:151], v[84:87], v[140:143]
    v_cvt_pk_bf16_f32 v210, v164, v165
    v_mfma_f32_16x16x32_bf16 v[144:147], a[132:135], v[100:103], v[144:147]
    v_exp_f32 v166, v166
    v_mfma_f32_16x16x32_bf16 v[148:151], a[148:151], v[100:103], v[148:151]
    ds_read_b64_tr_b16 a[172:173], v9 offset:0
    ds_read_b64_tr_b16 a[174:175], v9 offset:1024
    v_mfma_f32_16x16x32_bf16 v[152:155], a[132:135], v[116:119], v[152:155]
    v_exp_f32 v167, v167
    v_mfma_f32_16x16x32_bf16 v[156:159], a[148:151], v[116:119], v[156:159]
    v_cvt_pk_bf16_f32 v211, v166, v167
    v_mfma_f32_16x16x32_bf16 v[128:131], a[136:139], v[72:75], v[128:131]
    v_exp_f32 v168, v168
    v_mfma_f32_16x16x32_bf16 v[132:135], a[152:155], v[72:75], v[132:135]
    ds_read_b64_tr_b16 a[176:177], v10 offset:0
    ds_read_b64_tr_b16 a[178:179], v10 offset:1024
    v_mfma_f32_16x16x32_bf16 v[136:139], a[136:139], v[88:91], v[136:139]
    v_exp_f32 v169, v169
    v_mfma_f32_16x16x32_bf16 v[140:143], a[152:155], v[88:91], v[140:143]
    v_cvt_pk_bf16_f32 v212, v168, v169
    v_mfma_f32_16x16x32_bf16 v[144:147], a[136:139], v[104:107], v[144:147]
    v_exp_f32 v170, v170
    v_mfma_f32_16x16x32_bf16 v[148:151], a[152:155], v[104:107], v[148:151]
    ds_read_b64_tr_b16 a[180:181], v11 offset:0
    ds_read_b64_tr_b16 a[182:183], v11 offset:1024
    v_mfma_f32_16x16x32_bf16 v[152:155], a[136:139], v[120:123], v[152:155]
    v_exp_f32 v171, v171
    v_mfma_f32_16x16x32_bf16 v[156:159], a[152:155], v[120:123], v[156:159]
    v_cvt_pk_bf16_f32 v213, v170, v171
    s_waitcnt lgkmcnt(2)
    v_mfma_f32_16x16x32_bf16 v[128:131], a[140:143], v[76:79], v[128:131]
    v_exp_f32 v172, v172
    v_mfma_f32_16x16x32_bf16 v[132:135], a[156:159], v[76:79], v[132:135]
    ds_read_b64_tr_b16 a[184:185], v12 offset:0
    ds_read_b64_tr_b16 a[186:187], v12 offset:1024
    v_mfma_f32_16x16x32_bf16 v[136:139], a[140:143], v[92:95], v[136:139]
    v_exp_f32 v173, v173
    v_mfma_f32_16x16x32_bf16 v[140:143], a[156:159], v[92:95], v[140:143]
    v_cvt_pk_bf16_f32 v214, v172, v173
    v_mfma_f32_16x16x32_bf16 v[144:147], a[140:143], v[108:111], v[144:147]
    v_exp_f32 v174, v174
    v_mfma_f32_16x16x32_bf16 v[148:151], a[156:159], v[108:111], v[148:151]
    ds_read_b64_tr_b16 a[188:189], v13 offset:0
    ds_read_b64_tr_b16 a[190:191], v13 offset:1024
    v_mfma_f32_16x16x32_bf16 v[152:155], a[140:143], v[124:127], v[152:155]
    v_exp_f32 v175, v175
    v_mfma_f32_16x16x32_bf16 v[156:159], a[156:159], v[124:127], v[156:159]
    v_cvt_pk_bf16_f32 v215, v174, v175
    v_mfma_f32_16x16x32_bf16 a[0:3], a[160:163], v[192:195], a[0:3]
    v_exp_f32 v176, v176
    v_mfma_f32_16x16x32_bf16 a[16:19], a[164:167], v[192:195], a[16:19]
    v_mfma_f32_16x16x32_bf16 a[32:35], a[168:171], v[192:195], a[32:35]
    v_exp_f32 v177, v177
    v_mfma_f32_16x16x32_bf16 a[48:51], a[172:175], v[192:195], a[48:51]
    v_cvt_pk_bf16_f32 v216, v176, v177
    v_mfma_f32_16x16x32_bf16 a[64:67], a[176:179], v[192:195], a[64:67]
    v_exp_f32 v178, v178
    s_add_u32 m0, s51, 32768
    s_waitcnt lgkmcnt(0)
    v_mfma_f32_16x16x32_bf16 a[80:83], a[180:183], v[192:195], a[80:83]
    buffer_load_dwordx4 v24, s[8:11], s47 offen offset:0 lds
    v_mfma_f32_16x16x32_bf16 a[96:99], a[184:187], v[192:195], a[96:99]
    v_exp_f32 v179, v179
    v_mfma_f32_16x16x32_bf16 a[112:115], a[188:191], v[192:195], a[112:115]
    v_cvt_pk_bf16_f32 v217, v178, v179
    v_mfma_f32_16x16x32_bf16 a[192:195], a[208:211], v[192:195], a[192:195]
    ds_read_b128 a[128:131], v2 offset:57344
    ds_read_b128 a[144:147], v2 offset:58368
    v_mfma_f32_16x16x32_bf16 a[4:7], a[160:163], v[196:199], a[4:7]
    v_exp_f32 v180, v180
    v_mfma_f32_16x16x32_bf16 a[20:23], a[164:167], v[196:199], a[20:23]
    buffer_load_dwordx4 v24, s[8:11], s47 offen offset:1024 lds
    v_mfma_f32_16x16x32_bf16 a[36:39], a[168:171], v[196:199], a[36:39]
    v_exp_f32 v181, v181
    v_mfma_f32_16x16x32_bf16 a[52:55], a[172:175], v[196:199], a[52:55]
    v_cvt_pk_bf16_f32 v218, v180, v181
    v_mfma_f32_16x16x32_bf16 a[68:71], a[176:179], v[196:199], a[68:71]
    v_exp_f32 v182, v182
    v_mfma_f32_16x16x32_bf16 a[84:87], a[180:183], v[196:199], a[84:87]
    buffer_load_dwordx4 v25, s[8:11], s47 offen offset:2048 lds
    v_mfma_f32_16x16x32_bf16 a[100:103], a[184:187], v[196:199], a[100:103]
    v_exp_f32 v183, v183
    v_mfma_f32_16x16x32_bf16 a[116:119], a[188:191], v[196:199], a[116:119]
    v_cvt_pk_bf16_f32 v219, v182, v183
    v_mfma_f32_16x16x32_bf16 a[196:199], a[208:211], v[196:199], a[196:199]
    ds_read_b128 a[132:135], v3 offset:57344
    ds_read_b128 a[148:151], v3 offset:58368
    v_mfma_f32_16x16x32_bf16 a[8:11], a[160:163], v[200:203], a[8:11]
    v_exp_f32 v184, v184
    v_mfma_f32_16x16x32_bf16 a[24:27], a[164:167], v[200:203], a[24:27]
    buffer_load_dwordx4 v25, s[8:11], s47 offen offset:3072 lds
    s_add_u32 s47, s47, 16384
    v_mfma_f32_16x16x32_bf16 a[40:43], a[168:171], v[200:203], a[40:43]
    v_exp_f32 v185, v185
    v_mfma_f32_16x16x32_bf16 a[56:59], a[172:175], v[200:203], a[56:59]
    v_cvt_pk_bf16_f32 v220, v184, v185
    v_mfma_f32_16x16x32_bf16 a[72:75], a[176:179], v[200:203], a[72:75]
    v_exp_f32 v186, v186
    v_mfma_f32_16x16x32_bf16 a[88:91], a[180:183], v[200:203], a[88:91]
    v_mfma_f32_16x16x32_bf16 a[104:107], a[184:187], v[200:203], a[104:107]
    v_exp_f32 v187, v187
    v_mfma_f32_16x16x32_bf16 a[120:123], a[188:191], v[200:203], a[120:123]
    v_cvt_pk_bf16_f32 v221, v186, v187
    v_mfma_f32_16x16x32_bf16 a[200:203], a[208:211], v[200:203], a[200:203]
    ds_read_b128 a[136:139], v4 offset:57344
    ds_read_b128 a[152:155], v4 offset:58368
    v_mfma_f32_16x16x32_bf16 a[12:15], a[160:163], v[204:207], a[12:15]
    v_exp_f32 v188, v188
    v_mfma_f32_16x16x32_bf16 a[28:31], a[164:167], v[204:207], a[28:31]
    v_mfma_f32_16x16x32_bf16 a[44:47], a[168:171], v[204:207], a[44:47]
    v_exp_f32 v189, v189
    v_mfma_f32_16x16x32_bf16 a[60:63], a[172:175], v[204:207], a[60:63]
    v_cvt_pk_bf16_f32 v222, v188, v189
    v_mfma_f32_16x16x32_bf16 a[76:79], a[176:179], v[204:207], a[76:79]
    v_exp_f32 v190, v190
    v_mfma_f32_16x16x32_bf16 a[92:95], a[180:183], v[204:207], a[92:95]
    v_mfma_f32_16x16x32_bf16 a[108:111], a[184:187], v[204:207], a[108:111]
    v_exp_f32 v191, v191
    v_mfma_f32_16x16x32_bf16 a[124:127], a[188:191], v[204:207], a[124:127]
    v_cvt_pk_bf16_f32 v223, v190, v191
    v_mfma_f32_16x16x32_bf16 a[204:207], a[208:211], v[204:207], a[204:207]
    ds_read_b128 a[140:143], v5 offset:57344
    ds_read_b128 a[156:159], v5 offset:58368
    s_waitcnt lgkmcnt(2)
    v_mfma_f32_16x16x32_bf16 v[160:163], a[128:131], v[64:67], v[224:227]
    s_waitcnt vmcnt(8)
    s_barrier
    v_exp_f32 v128, v128
    v_mfma_f32_16x16x32_bf16 v[164:167], a[144:147], v[64:67], v[224:227]
    ds_read_b64_tr_b16 a[160:161], v6 offset:8192
    ds_read_b64_tr_b16 a[162:163], v6 offset:9216
    v_mfma_f32_16x16x32_bf16 v[168:171], a[128:131], v[80:83], v[228:231]
    v_exp_f32 v129, v129
    v_mfma_f32_16x16x32_bf16 v[172:175], a[144:147], v[80:83], v[228:231]
    v_cvt_pk_bf16_f32 v192, v128, v129
    v_mfma_f32_16x16x32_bf16 v[176:179], a[128:131], v[96:99], v[232:235]
    v_exp_f32 v130, v130
    v_mfma_f32_16x16x32_bf16 v[180:183], a[144:147], v[96:99], v[232:235]
    ds_read_b64_tr_b16 a[164:165], v7 offset:8192
    ds_read_b64_tr_b16 a[166:167], v7 offset:9216
    v_mfma_f32_16x16x32_bf16 v[184:187], a[128:131], v[112:115], v[236:239]
    v_exp_f32 v131, v131
    v_mfma_f32_16x16x32_bf16 v[188:191], a[144:147], v[112:115], v[236:239]
    v_cvt_pk_bf16_f32 v193, v130, v131
    v_mfma_f32_16x16x32_bf16 v[160:163], a[132:135], v[68:71], v[160:163]
    v_exp_f32 v132, v132
    v_mfma_f32_16x16x32_bf16 v[164:167], a[148:151], v[68:71], v[164:167]
    ds_read_b64_tr_b16 a[168:169], v8 offset:8192
    ds_read_b64_tr_b16 a[170:171], v8 offset:9216
    v_mfma_f32_16x16x32_bf16 v[168:171], a[132:135], v[84:87], v[168:171]
    v_exp_f32 v133, v133
    v_mfma_f32_16x16x32_bf16 v[172:175], a[148:151], v[84:87], v[172:175]
    v_cvt_pk_bf16_f32 v194, v132, v133
    v_mfma_f32_16x16x32_bf16 v[176:179], a[132:135], v[100:103], v[176:179]
    v_exp_f32 v134, v134
    v_mfma_f32_16x16x32_bf16 v[180:183], a[148:151], v[100:103], v[180:183]
    ds_read_b64_tr_b16 a[172:173], v9 offset:8192
    ds_read_b64_tr_b16 a[174:175], v9 offset:9216
    v_mfma_f32_16x16x32_bf16 v[184:187], a[132:135], v[116:119], v[184:187]
    v_exp_f32 v135, v135
    v_mfma_f32_16x16x32_bf16 v[188:191], a[148:151], v[116:119], v[188:191]
    v_cvt_pk_bf16_f32 v195, v134, v135
    v_mfma_f32_16x16x32_bf16 v[160:163], a[136:139], v[72:75], v[160:163]
    v_exp_f32 v136, v136
    v_mfma_f32_16x16x32_bf16 v[164:167], a[152:155], v[72:75], v[164:167]
    ds_read_b64_tr_b16 a[176:177], v10 offset:8192
    ds_read_b64_tr_b16 a[178:179], v10 offset:9216
    v_mfma_f32_16x16x32_bf16 v[168:171], a[136:139], v[88:91], v[168:171]
    v_exp_f32 v137, v137
    v_mfma_f32_16x16x32_bf16 v[172:175], a[152:155], v[88:91], v[172:175]
    v_cvt_pk_bf16_f32 v196, v136, v137
    v_mfma_f32_16x16x32_bf16 v[176:179], a[136:139], v[104:107], v[176:179]
    v_exp_f32 v138, v138
    v_mfma_f32_16x16x32_bf16 v[180:183], a[152:155], v[104:107], v[180:183]
    ds_read_b64_tr_b16 a[180:181], v11 offset:8192
    ds_read_b64_tr_b16 a[182:183], v11 offset:9216
    v_mfma_f32_16x16x32_bf16 v[184:187], a[136:139], v[120:123], v[184:187]
    v_exp_f32 v139, v139
    v_mfma_f32_16x16x32_bf16 v[188:191], a[152:155], v[120:123], v[188:191]
    v_cvt_pk_bf16_f32 v197, v138, v139
    s_waitcnt lgkmcnt(2)
    v_mfma_f32_16x16x32_bf16 v[160:163], a[140:143], v[76:79], v[160:163]
    v_exp_f32 v140, v140
    v_mfma_f32_16x16x32_bf16 v[164:167], a[156:159], v[76:79], v[164:167]
    ds_read_b64_tr_b16 a[184:185], v12 offset:8192
    ds_read_b64_tr_b16 a[186:187], v12 offset:9216
    v_mfma_f32_16x16x32_bf16 v[168:171], a[140:143], v[92:95], v[168:171]
    v_exp_f32 v141, v141
    v_mfma_f32_16x16x32_bf16 v[172:175], a[156:159], v[92:95], v[172:175]
    v_cvt_pk_bf16_f32 v198, v140, v141
    v_mfma_f32_16x16x32_bf16 v[176:179], a[140:143], v[108:111], v[176:179]
    v_exp_f32 v142, v142
    v_mfma_f32_16x16x32_bf16 v[180:183], a[156:159], v[108:111], v[180:183]
    ds_read_b64_tr_b16 a[188:189], v13 offset:8192
    ds_read_b64_tr_b16 a[190:191], v13 offset:9216
    v_mfma_f32_16x16x32_bf16 v[184:187], a[140:143], v[124:127], v[184:187]
    v_exp_f32 v143, v143
    v_mfma_f32_16x16x32_bf16 v[188:191], a[156:159], v[124:127], v[188:191]
    v_cvt_pk_bf16_f32 v199, v142, v143
    v_mfma_f32_16x16x32_bf16 a[0:3], a[160:163], v[208:211], a[0:3]
    v_exp_f32 v144, v144
    v_mfma_f32_16x16x32_bf16 a[16:19], a[164:167], v[208:211], a[16:19]
    v_mfma_f32_16x16x32_bf16 a[32:35], a[168:171], v[208:211], a[32:35]
    v_exp_f32 v145, v145
    v_mfma_f32_16x16x32_bf16 a[48:51], a[172:175], v[208:211], a[48:51]
    v_cvt_pk_bf16_f32 v200, v144, v145
    v_mfma_f32_16x16x32_bf16 a[64:67], a[176:179], v[208:211], a[64:67]
    v_exp_f32 v146, v146
    s_add_u32 m0, s43, 32768
    s_waitcnt lgkmcnt(0)
    v_mfma_f32_16x16x32_bf16 a[80:83], a[180:183], v[208:211], a[80:83]
    buffer_load_dwordx4 v22, s[4:7], s46 offen offset:0 lds
    v_mfma_f32_16x16x32_bf16 a[96:99], a[184:187], v[208:211], a[96:99]
    v_exp_f32 v147, v147
    v_mfma_f32_16x16x32_bf16 a[112:115], a[188:191], v[208:211], a[112:115]
    v_cvt_pk_bf16_f32 v201, v146, v147
    v_mfma_f32_16x16x32_bf16 a[192:195], a[208:211], v[208:211], a[192:195]
    ds_read_b128 a[128:131], v2 offset:0
    ds_read_b128 a[144:147], v2 offset:1024
    v_mfma_f32_16x16x32_bf16 a[4:7], a[160:163], v[212:215], a[4:7]
    v_exp_f32 v148, v148
    v_mfma_f32_16x16x32_bf16 a[20:23], a[164:167], v[212:215], a[20:23]
    buffer_load_dwordx4 v22, s[4:7], s46 offen offset:1024 lds
    v_mfma_f32_16x16x32_bf16 a[36:39], a[168:171], v[212:215], a[36:39]
    v_exp_f32 v149, v149
    v_mfma_f32_16x16x32_bf16 a[52:55], a[172:175], v[212:215], a[52:55]
    v_cvt_pk_bf16_f32 v202, v148, v149
    v_mfma_f32_16x16x32_bf16 a[68:71], a[176:179], v[212:215], a[68:71]
    v_exp_f32 v150, v150
    v_mfma_f32_16x16x32_bf16 a[84:87], a[180:183], v[212:215], a[84:87]
    buffer_load_dwordx4 v23, s[4:7], s46 offen offset:2048 lds
    v_mfma_f32_16x16x32_bf16 a[100:103], a[184:187], v[212:215], a[100:103]
    v_exp_f32 v151, v151
    v_mfma_f32_16x16x32_bf16 a[116:119], a[188:191], v[212:215], a[116:119]
    v_cvt_pk_bf16_f32 v203, v150, v151
    v_mfma_f32_16x16x32_bf16 a[196:199], a[208:211], v[212:215], a[196:199]
    ds_read_b128 a[132:135], v3 offset:0
    ds_read_b128 a[148:151], v3 offset:1024
    v_mfma_f32_16x16x32_bf16 a[8:11], a[160:163], v[216:219], a[8:11]
    v_exp_f32 v152, v152
    v_mfma_f32_16x16x32_bf16 a[24:27], a[164:167], v[216:219], a[24:27]
    buffer_load_dwordx4 v23, s[4:7], s46 offen offset:3072 lds
    s_add_u32 s46, s46, 16384
    v_mfma_f32_16x16x32_bf16 a[40:43], a[168:171], v[216:219], a[40:43]
    v_exp_f32 v153, v153
    v_mfma_f32_16x16x32_bf16 a[56:59], a[172:175], v[216:219], a[56:59]
    v_cvt_pk_bf16_f32 v204, v152, v153
    v_mfma_f32_16x16x32_bf16 a[72:75], a[176:179], v[216:219], a[72:75]
    v_exp_f32 v154, v154
    v_mfma_f32_16x16x32_bf16 a[88:91], a[180:183], v[216:219], a[88:91]
    v_mfma_f32_16x16x32_bf16 a[104:107], a[184:187], v[216:219], a[104:107]
    v_exp_f32 v155, v155
    v_mfma_f32_16x16x32_bf16 a[120:123], a[188:191], v[216:219], a[120:123]
    v_cvt_pk_bf16_f32 v205, v154, v155
    v_mfma_f32_16x16x32_bf16 a[200:203], a[208:211], v[216:219], a[200:203]
    ds_read_b128 a[136:139], v4 offset:0
    ds_read_b128 a[152:155], v4 offset:1024
    v_mfma_f32_16x16x32_bf16 a[12:15], a[160:163], v[220:223], a[12:15]
    v_exp_f32 v156, v156
    v_mfma_f32_16x16x32_bf16 a[28:31], a[164:167], v[220:223], a[28:31]
    v_mfma_f32_16x16x32_bf16 a[44:47], a[168:171], v[220:223], a[44:47]
    v_exp_f32 v157, v157
    v_mfma_f32_16x16x32_bf16 a[60:63], a[172:175], v[220:223], a[60:63]
    v_cvt_pk_bf16_f32 v206, v156, v157
    v_mfma_f32_16x16x32_bf16 a[76:79], a[176:179], v[220:223], a[76:79]
    v_exp_f32 v158, v158
    v_mfma_f32_16x16x32_bf16 a[92:95], a[180:183], v[220:223], a[92:95]
    v_mfma_f32_16x16x32_bf16 a[108:111], a[184:187], v[220:223], a[108:111]
    v_exp_f32 v159, v159
    v_mfma_f32_16x16x32_bf16 a[124:127], a[188:191], v[220:223], a[124:127]
    v_cvt_pk_bf16_f32 v207, v158, v159
    v_mfma_f32_16x16x32_bf16 a[204:207], a[208:211], v[220:223], a[204:207]
    ds_read_b128 a[140:143], v5 offset:0
    ds_read_b128 a[156:159], v5 offset:1024
    s_waitcnt lgkmcnt(2)
    v_mfma_f32_16x16x32_bf16 v[128:131], a[128:131], v[64:67], v[224:227]
    v_exp_f32 v160, v160
    v_mfma_f32_16x16x32_bf16 v[132:135], a[144:147], v[64:67], v[224:227]
    ds_read_b64_tr_b16 a[160:161], v6 offset:16384
    ds_read_b64_tr_b16 a[162:163], v6 offset:17408
    v_mfma_f32_16x16x32_bf16 v[136:139], a[128:131], v[80:83], v[228:231]
    v_exp_f32 v161, v161
    v_mfma_f32_16x16x32_bf16 v[140:143], a[144:147], v[80:83], v[228:231]
    v_cvt_pk_bf16_f32 v208, v160, v161
    v_mfma_f32_16x16x32_bf16 v[144:147], a[128:131], v[96:99], v[232:235]
    v_exp_f32 v162, v162
    v_mfma_f32_16x16x32_bf16 v[148:151], a[144:147], v[96:99], v[232:235]
    ds_read_b64_tr_b16 a[164:165], v7 offset:16384
    ds_read_b64_tr_b16 a[166:167], v7 offset:17408
    v_mfma_f32_16x16x32_bf16 v[152:155], a[128:131], v[112:115], v[236:239]
    v_exp_f32 v163, v163
    v_mfma_f32_16x16x32_bf16 v[156:159], a[144:147], v[112:115], v[236:239]
    v_cvt_pk_bf16_f32 v209, v162, v163
    v_mfma_f32_16x16x32_bf16 v[128:131], a[132:135], v[68:71], v[128:131]
    v_exp_f32 v164, v164
    v_mfma_f32_16x16x32_bf16 v[132:135], a[148:151], v[68:71], v[132:135]
    ds_read_b64_tr_b16 a[168:169], v8 offset:16384
    ds_read_b64_tr_b16 a[170:171], v8 offset:17408
    v_mfma_f32_16x16x32_bf16 v[136:139], a[132:135], v[84:87], v[136:139]
    v_exp_f32 v165, v165
    v_mfma_f32_16x16x32_bf16 v[140:143], a[148:151], v[84:87], v[140:143]
    v_cvt_pk_bf16_f32 v210, v164, v165
    v_mfma_f32_16x16x32_bf16 v[144:147], a[132:135], v[100:103], v[144:147]
    v_exp_f32 v166, v166
    v_mfma_f32_16x16x32_bf16 v[148:151], a[148:151], v[100:103], v[148:151]
    ds_read_b64_tr_b16 a[172:173], v9 offset:16384
    ds_read_b64_tr_b16 a[174:175], v9 offset:17408
    v_mfma_f32_16x16x32_bf16 v[152:155], a[132:135], v[116:119], v[152:155]
    v_exp_f32 v167, v167
    v_mfma_f32_16x16x32_bf16 v[156:159], a[148:151], v[116:119], v[156:159]
    v_cvt_pk_bf16_f32 v211, v166, v167
    v_mfma_f32_16x16x32_bf16 v[128:131], a[136:139], v[72:75], v[128:131]
    v_exp_f32 v168, v168
    v_mfma_f32_16x16x32_bf16 v[132:135], a[152:155], v[72:75], v[132:135]
    ds_read_b64_tr_b16 a[176:177], v10 offset:16384
    ds_read_b64_tr_b16 a[178:179], v10 offset:17408
    v_mfma_f32_16x16x32_bf16 v[136:139], a[136:139], v[88:91], v[136:139]
    v_exp_f32 v169, v169
    v_mfma_f32_16x16x32_bf16 v[140:143], a[152:155], v[88:91], v[140:143]
    v_cvt_pk_bf16_f32 v212, v168, v169
    v_mfma_f32_16x16x32_bf16 v[144:147], a[136:139], v[104:107], v[144:147]
    v_exp_f32 v170, v170
    v_mfma_f32_16x16x32_bf16 v[148:151], a[152:155], v[104:107], v[148:151]
    ds_read_b64_tr_b16 a[180:181], v11 offset:16384
    ds_read_b64_tr_b16 a[182:183], v11 offset:17408
    v_mfma_f32_16x16x32_bf16 v[152:155], a[136:139], v[120:123], v[152:155]
    v_exp_f32 v171, v171
    v_mfma_f32_16x16x32_bf16 v[156:159], a[152:155], v[120:123], v[156:159]
    v_cvt_pk_bf16_f32 v213, v170, v171
    s_waitcnt lgkmcnt(2)
    v_mfma_f32_16x16x32_bf16 v[128:131], a[140:143], v[76:79], v[128:131]
    v_exp_f32 v172, v172
    v_mfma_f32_16x16x32_bf16 v[132:135], a[156:159], v[76:79], v[132:135]
    ds_read_b64_tr_b16 a[184:185], v12 offset:16384
    ds_read_b64_tr_b16 a[186:187], v12 offset:17408
    v_mfma_f32_16x16x32_bf16 v[136:139], a[140:143], v[92:95], v[136:139]
    v_exp_f32 v173, v173
    v_mfma_f32_16x16x32_bf16 v[140:143], a[156:159], v[92:95], v[140:143]
    v_cvt_pk_bf16_f32 v214, v172, v173
    v_mfma_f32_16x16x32_bf16 v[144:147], a[140:143], v[108:111], v[144:147]
    v_exp_f32 v174, v174
    v_mfma_f32_16x16x32_bf16 v[148:151], a[156:159], v[108:111], v[148:151]
    ds_read_b64_tr_b16 a[188:189], v13 offset:16384
    ds_read_b64_tr_b16 a[190:191], v13 offset:17408
    v_mfma_f32_16x16x32_bf16 v[152:155], a[140:143], v[124:127], v[152:155]
    v_exp_f32 v175, v175
    v_mfma_f32_16x16x32_bf16 v[156:159], a[156:159], v[124:127], v[156:159]
    v_cvt_pk_bf16_f32 v215, v174, v175
    v_mfma_f32_16x16x32_bf16 a[0:3], a[160:163], v[192:195], a[0:3]
    v_exp_f32 v176, v176
    v_mfma_f32_16x16x32_bf16 a[16:19], a[164:167], v[192:195], a[16:19]
    v_mfma_f32_16x16x32_bf16 a[32:35], a[168:171], v[192:195], a[32:35]
    v_exp_f32 v177, v177
    v_mfma_f32_16x16x32_bf16 a[48:51], a[172:175], v[192:195], a[48:51]
    v_cvt_pk_bf16_f32 v216, v176, v177
    v_mfma_f32_16x16x32_bf16 a[64:67], a[176:179], v[192:195], a[64:67]
    v_exp_f32 v178, v178
    s_add_u32 m0, s51, 49152
    s_waitcnt lgkmcnt(0)
    v_mfma_f32_16x16x32_bf16 a[80:83], a[180:183], v[192:195], a[80:83]
    buffer_load_dwordx4 v24, s[8:11], s47 offen offset:0 lds
    v_mfma_f32_16x16x32_bf16 a[96:99], a[184:187], v[192:195], a[96:99]
    v_exp_f32 v179, v179
    v_mfma_f32_16x16x32_bf16 a[112:115], a[188:191], v[192:195], a[112:115]
    v_cvt_pk_bf16_f32 v217, v178, v179
    v_mfma_f32_16x16x32_bf16 a[192:195], a[208:211], v[192:195], a[192:195]
    ds_read_b128 a[128:131], v2 offset:8192
    ds_read_b128 a[144:147], v2 offset:9216
    v_mfma_f32_16x16x32_bf16 a[4:7], a[160:163], v[196:199], a[4:7]
    v_exp_f32 v180, v180
    v_mfma_f32_16x16x32_bf16 a[20:23], a[164:167], v[196:199], a[20:23]
    buffer_load_dwordx4 v24, s[8:11], s47 offen offset:1024 lds
    v_mfma_f32_16x16x32_bf16 a[36:39], a[168:171], v[196:199], a[36:39]
    v_exp_f32 v181, v181
    v_mfma_f32_16x16x32_bf16 a[52:55], a[172:175], v[196:199], a[52:55]
    v_cvt_pk_bf16_f32 v218, v180, v181
    v_mfma_f32_16x16x32_bf16 a[68:71], a[176:179], v[196:199], a[68:71]
    v_exp_f32 v182, v182
    v_mfma_f32_16x16x32_bf16 a[84:87], a[180:183], v[196:199], a[84:87]
    buffer_load_dwordx4 v25, s[8:11], s47 offen offset:2048 lds
    v_mfma_f32_16x16x32_bf16 a[100:103], a[184:187], v[196:199], a[100:103]
    v_exp_f32 v183, v183
    v_mfma_f32_16x16x32_bf16 a[116:119], a[188:191], v[196:199], a[116:119]
    v_cvt_pk_bf16_f32 v219, v182, v183
    v_mfma_f32_16x16x32_bf16 a[196:199], a[208:211], v[196:199], a[196:199]
    ds_read_b128 a[132:135], v3 offset:8192
    ds_read_b128 a[148:151], v3 offset:9216
    v_mfma_f32_16x16x32_bf16 a[8:11], a[160:163], v[200:203], a[8:11]
    v_exp_f32 v184, v184
    v_mfma_f32_16x16x32_bf16 a[24:27], a[164:167], v[200:203], a[24:27]
    buffer_load_dwordx4 v25, s[8:11], s47 offen offset:3072 lds
    s_add_u32 s47, s47, 16384
    v_mfma_f32_16x16x32_bf16 a[40:43], a[168:171], v[200:203], a[40:43]
    v_exp_f32 v185, v185
    v_mfma_f32_16x16x32_bf16 a[56:59], a[172:175], v[200:203], a[56:59]
    v_cvt_pk_bf16_f32 v220, v184, v185
    v_mfma_f32_16x16x32_bf16 a[72:75], a[176:179], v[200:203], a[72:75]
    v_exp_f32 v186, v186
    v_mfma_f32_16x16x32_bf16 a[88:91], a[180:183], v[200:203], a[88:91]
    v_mfma_f32_16x16x32_bf16 a[104:107], a[184:187], v[200:203], a[104:107]
    v_exp_f32 v187, v187
    v_mfma_f32_16x16x32_bf16 a[120:123], a[188:191], v[200:203], a[120:123]
    v_cvt_pk_bf16_f32 v221, v186, v187
    v_mfma_f32_16x16x32_bf16 a[200:203], a[208:211], v[200:203], a[200:203]
    ds_read_b128 a[136:139], v4 offset:8192
    ds_read_b128 a[152:155], v4 offset:9216
    v_mfma_f32_16x16x32_bf16 a[12:15], a[160:163], v[204:207], a[12:15]
    v_exp_f32 v188, v188
    v_mfma_f32_16x16x32_bf16 a[28:31], a[164:167], v[204:207], a[28:31]
    v_mfma_f32_16x16x32_bf16 a[44:47], a[168:171], v[204:207], a[44:47]
    v_exp_f32 v189, v189
    v_mfma_f32_16x16x32_bf16 a[60:63], a[172:175], v[204:207], a[60:63]
    v_cvt_pk_bf16_f32 v222, v188, v189
    v_mfma_f32_16x16x32_bf16 a[76:79], a[176:179], v[204:207], a[76:79]
    v_exp_f32 v190, v190
    v_mfma_f32_16x16x32_bf16 a[92:95], a[180:183], v[204:207], a[92:95]
    v_mfma_f32_16x16x32_bf16 a[108:111], a[184:187], v[204:207], a[108:111]
    v_exp_f32 v191, v191
    v_mfma_f32_16x16x32_bf16 a[124:127], a[188:191], v[204:207], a[124:127]
    v_cvt_pk_bf16_f32 v223, v190, v191
    v_mfma_f32_16x16x32_bf16 a[204:207], a[208:211], v[204:207], a[204:207]
    ds_read_b128 a[140:143], v5 offset:8192
    ds_read_b128 a[156:159], v5 offset:9216
    s_sub_u32 s48, s48, 1
    s_cmp_lg_u32 s48, 0
    s_cbranch_scc1 attn_kernel_loop
    s_waitcnt lgkmcnt(2)
    v_mfma_f32_16x16x32_bf16 v[160:163], a[128:131], v[64:67], v[224:227]
    s_waitcnt vmcnt(8)
    s_barrier
    v_exp_f32 v128, v128
    v_mfma_f32_16x16x32_bf16 v[164:167], a[144:147], v[64:67], v[224:227]
    ds_read_b64_tr_b16 a[160:161], v6 offset:24576
    ds_read_b64_tr_b16 a[162:163], v6 offset:25600
    v_mfma_f32_16x16x32_bf16 v[168:171], a[128:131], v[80:83], v[228:231]
    v_exp_f32 v129, v129
    v_mfma_f32_16x16x32_bf16 v[172:175], a[144:147], v[80:83], v[228:231]
    v_cvt_pk_bf16_f32 v192, v128, v129
    v_mfma_f32_16x16x32_bf16 v[176:179], a[128:131], v[96:99], v[232:235]
    v_exp_f32 v130, v130
    v_mfma_f32_16x16x32_bf16 v[180:183], a[144:147], v[96:99], v[232:235]
    ds_read_b64_tr_b16 a[164:165], v7 offset:24576
    ds_read_b64_tr_b16 a[166:167], v7 offset:25600
    v_mfma_f32_16x16x32_bf16 v[184:187], a[128:131], v[112:115], v[236:239]
    v_exp_f32 v131, v131
    v_mfma_f32_16x16x32_bf16 v[188:191], a[144:147], v[112:115], v[236:239]
    v_cvt_pk_bf16_f32 v193, v130, v131
    v_mfma_f32_16x16x32_bf16 v[160:163], a[132:135], v[68:71], v[160:163]
    v_exp_f32 v132, v132
    v_mfma_f32_16x16x32_bf16 v[164:167], a[148:151], v[68:71], v[164:167]
    ds_read_b64_tr_b16 a[168:169], v8 offset:24576
    ds_read_b64_tr_b16 a[170:171], v8 offset:25600
    v_mfma_f32_16x16x32_bf16 v[168:171], a[132:135], v[84:87], v[168:171]
    v_exp_f32 v133, v133
    v_mfma_f32_16x16x32_bf16 v[172:175], a[148:151], v[84:87], v[172:175]
    v_cvt_pk_bf16_f32 v194, v132, v133
    v_mfma_f32_16x16x32_bf16 v[176:179], a[132:135], v[100:103], v[176:179]
    v_exp_f32 v134, v134
    v_mfma_f32_16x16x32_bf16 v[180:183], a[148:151], v[100:103], v[180:183]
    ds_read_b64_tr_b16 a[172:173], v9 offset:24576
    ds_read_b64_tr_b16 a[174:175], v9 offset:25600
    v_mfma_f32_16x16x32_bf16 v[184:187], a[132:135], v[116:119], v[184:187]
    v_exp_f32 v135, v135
    v_mfma_f32_16x16x32_bf16 v[188:191], a[148:151], v[116:119], v[188:191]
    v_cvt_pk_bf16_f32 v195, v134, v135
    v_mfma_f32_16x16x32_bf16 v[160:163], a[136:139], v[72:75], v[160:163]
    v_exp_f32 v136, v136
    v_mfma_f32_16x16x32_bf16 v[164:167], a[152:155], v[72:75], v[164:167]
    ds_read_b64_tr_b16 a[176:177], v10 offset:24576
    ds_read_b64_tr_b16 a[178:179], v10 offset:25600
    v_mfma_f32_16x16x32_bf16 v[168:171], a[136:139], v[88:91], v[168:171]
    v_exp_f32 v137, v137
    v_mfma_f32_16x16x32_bf16 v[172:175], a[152:155], v[88:91], v[172:175]
    v_cvt_pk_bf16_f32 v196, v136, v137
    v_mfma_f32_16x16x32_bf16 v[176:179], a[136:139], v[104:107], v[176:179]
    v_exp_f32 v138, v138
    v_mfma_f32_16x16x32_bf16 v[180:183], a[152:155], v[104:107], v[180:183]
    ds_read_b64_tr_b16 a[180:181], v11 offset:24576
    ds_read_b64_tr_b16 a[182:183], v11 offset:25600
    v_mfma_f32_16x16x32_bf16 v[184:187], a[136:139], v[120:123], v[184:187]
    v_exp_f32 v139, v139
    v_mfma_f32_16x16x32_bf16 v[188:191], a[152:155], v[120:123], v[188:191]
    v_cvt_pk_bf16_f32 v197, v138, v139
    s_waitcnt lgkmcnt(2)
    v_mfma_f32_16x16x32_bf16 v[160:163], a[140:143], v[76:79], v[160:163]
    v_exp_f32 v140, v140
    v_mfma_f32_16x16x32_bf16 v[164:167], a[156:159], v[76:79], v[164:167]
    ds_read_b64_tr_b16 a[184:185], v12 offset:24576
    ds_read_b64_tr_b16 a[186:187], v12 offset:25600
    v_mfma_f32_16x16x32_bf16 v[168:171], a[140:143], v[92:95], v[168:171]
    v_exp_f32 v141, v141
    v_mfma_f32_16x16x32_bf16 v[172:175], a[156:159], v[92:95], v[172:175]
    v_cvt_pk_bf16_f32 v198, v140, v141
    v_mfma_f32_16x16x32_bf16 v[176:179], a[140:143], v[108:111], v[176:179]
    v_exp_f32 v142, v142
    v_mfma_f32_16x16x32_bf16 v[180:183], a[156:159], v[108:111], v[180:183]
    ds_read_b64_tr_b16 a[188:189], v13 offset:24576
    ds_read_b64_tr_b16 a[190:191], v13 offset:25600
    v_mfma_f32_16x16x32_bf16 v[184:187], a[140:143], v[124:127], v[184:187]
    v_exp_f32 v143, v143
    v_mfma_f32_16x16x32_bf16 v[188:191], a[156:159], v[124:127], v[188:191]
    v_cvt_pk_bf16_f32 v199, v142, v143
    v_mfma_f32_16x16x32_bf16 a[0:3], a[160:163], v[208:211], a[0:3]
    v_exp_f32 v144, v144
    v_mfma_f32_16x16x32_bf16 a[16:19], a[164:167], v[208:211], a[16:19]
    v_mfma_f32_16x16x32_bf16 a[32:35], a[168:171], v[208:211], a[32:35]
    v_exp_f32 v145, v145
    v_mfma_f32_16x16x32_bf16 a[48:51], a[172:175], v[208:211], a[48:51]
    v_cvt_pk_bf16_f32 v200, v144, v145
    v_mfma_f32_16x16x32_bf16 a[64:67], a[176:179], v[208:211], a[64:67]
    v_exp_f32 v146, v146
    s_add_u32 m0, s43, 49152
    s_waitcnt lgkmcnt(0)
    v_mfma_f32_16x16x32_bf16 a[80:83], a[180:183], v[208:211], a[80:83]
    buffer_load_dwordx4 v22, s[4:7], s46 offen offset:0 lds
    v_mfma_f32_16x16x32_bf16 a[96:99], a[184:187], v[208:211], a[96:99]
    v_exp_f32 v147, v147
    v_mfma_f32_16x16x32_bf16 a[112:115], a[188:191], v[208:211], a[112:115]
    v_cvt_pk_bf16_f32 v201, v146, v147
    v_mfma_f32_16x16x32_bf16 a[192:195], a[208:211], v[208:211], a[192:195]
    ds_read_b128 a[128:131], v2 offset:16384
    ds_read_b128 a[144:147], v2 offset:17408
    v_mfma_f32_16x16x32_bf16 a[4:7], a[160:163], v[212:215], a[4:7]
    v_exp_f32 v148, v148
    v_mfma_f32_16x16x32_bf16 a[20:23], a[164:167], v[212:215], a[20:23]
    buffer_load_dwordx4 v22, s[4:7], s46 offen offset:1024 lds
    v_mfma_f32_16x16x32_bf16 a[36:39], a[168:171], v[212:215], a[36:39]
    v_exp_f32 v149, v149
    v_mfma_f32_16x16x32_bf16 a[52:55], a[172:175], v[212:215], a[52:55]
    v_cvt_pk_bf16_f32 v202, v148, v149
    v_mfma_f32_16x16x32_bf16 a[68:71], a[176:179], v[212:215], a[68:71]
    v_exp_f32 v150, v150
    v_mfma_f32_16x16x32_bf16 a[84:87], a[180:183], v[212:215], a[84:87]
    buffer_load_dwordx4 v23, s[4:7], s46 offen offset:2048 lds
    v_mfma_f32_16x16x32_bf16 a[100:103], a[184:187], v[212:215], a[100:103]
    v_exp_f32 v151, v151
    v_mfma_f32_16x16x32_bf16 a[116:119], a[188:191], v[212:215], a[116:119]
    v_cvt_pk_bf16_f32 v203, v150, v151
    v_mfma_f32_16x16x32_bf16 a[196:199], a[208:211], v[212:215], a[196:199]
    ds_read_b128 a[132:135], v3 offset:16384
    ds_read_b128 a[148:151], v3 offset:17408
    v_mfma_f32_16x16x32_bf16 a[8:11], a[160:163], v[216:219], a[8:11]
    v_exp_f32 v152, v152
    v_mfma_f32_16x16x32_bf16 a[24:27], a[164:167], v[216:219], a[24:27]
    buffer_load_dwordx4 v23, s[4:7], s46 offen offset:3072 lds
    s_add_u32 s46, s46, 16384
    v_mfma_f32_16x16x32_bf16 a[40:43], a[168:171], v[216:219], a[40:43]
    v_exp_f32 v153, v153
    v_mfma_f32_16x16x32_bf16 a[56:59], a[172:175], v[216:219], a[56:59]
    v_cvt_pk_bf16_f32 v204, v152, v153
    v_mfma_f32_16x16x32_bf16 a[72:75], a[176:179], v[216:219], a[72:75]
    v_exp_f32 v154, v154
    v_mfma_f32_16x16x32_bf16 a[88:91], a[180:183], v[216:219], a[88:91]
    v_mfma_f32_16x16x32_bf16 a[104:107], a[184:187], v[216:219], a[104:107]
    v_exp_f32 v155, v155
    v_mfma_f32_16x16x32_bf16 a[120:123], a[188:191], v[216:219], a[120:123]
    v_cvt_pk_bf16_f32 v205, v154, v155
    v_mfma_f32_16x16x32_bf16 a[200:203], a[208:211], v[216:219], a[200:203]
    ds_read_b128 a[136:139], v4 offset:16384
    ds_read_b128 a[152:155], v4 offset:17408
    v_mfma_f32_16x16x32_bf16 a[12:15], a[160:163], v[220:223], a[12:15]
    v_exp_f32 v156, v156
    v_mfma_f32_16x16x32_bf16 a[28:31], a[164:167], v[220:223], a[28:31]
    v_mfma_f32_16x16x32_bf16 a[44:47], a[168:171], v[220:223], a[44:47]
    v_exp_f32 v157, v157
    v_mfma_f32_16x16x32_bf16 a[60:63], a[172:175], v[220:223], a[60:63]
    v_cvt_pk_bf16_f32 v206, v156, v157
    v_mfma_f32_16x16x32_bf16 a[76:79], a[176:179], v[220:223], a[76:79]
    v_exp_f32 v158, v158
    v_mfma_f32_16x16x32_bf16 a[92:95], a[180:183], v[220:223], a[92:95]
    v_mfma_f32_16x16x32_bf16 a[108:111], a[184:187], v[220:223], a[108:111]
    v_exp_f32 v159, v159
    v_mfma_f32_16x16x32_bf16 a[124:127], a[188:191], v[220:223], a[124:127]
    v_cvt_pk_bf16_f32 v207, v158, v159
    v_mfma_f32_16x16x32_bf16 a[204:207], a[208:211], v[220:223], a[204:207]
    ds_read_b128 a[140:143], v5 offset:16384
    ds_read_b128 a[156:159], v5 offset:17408
    s_waitcnt lgkmcnt(2)
    v_mfma_f32_16x16x32_bf16 v[128:131], a[128:131], v[64:67], v[224:227]
    v_exp_f32 v160, v160
    v_mfma_f32_16x16x32_bf16 v[132:135], a[144:147], v[64:67], v[224:227]
    ds_read_b64_tr_b16 a[160:161], v6 offset:32768
    ds_read_b64_tr_b16 a[162:163], v6 offset:33792
    v_mfma_f32_16x16x32_bf16 v[136:139], a[128:131], v[80:83], v[228:231]
    v_exp_f32 v161, v161
    v_mfma_f32_16x16x32_bf16 v[140:143], a[144:147], v[80:83], v[228:231]
    v_cvt_pk_bf16_f32 v208, v160, v161
    v_mfma_f32_16x16x32_bf16 v[144:147], a[128:131], v[96:99], v[232:235]
    v_exp_f32 v162, v162
    v_mfma_f32_16x16x32_bf16 v[148:151], a[144:147], v[96:99], v[232:235]
    ds_read_b64_tr_b16 a[164:165], v7 offset:32768
    ds_read_b64_tr_b16 a[166:167], v7 offset:33792
    v_mfma_f32_16x16x32_bf16 v[152:155], a[128:131], v[112:115], v[236:239]
    v_exp_f32 v163, v163
    v_mfma_f32_16x16x32_bf16 v[156:159], a[144:147], v[112:115], v[236:239]
    v_cvt_pk_bf16_f32 v209, v162, v163
    v_mfma_f32_16x16x32_bf16 v[128:131], a[132:135], v[68:71], v[128:131]
    v_exp_f32 v164, v164
    v_mfma_f32_16x16x32_bf16 v[132:135], a[148:151], v[68:71], v[132:135]
    ds_read_b64_tr_b16 a[168:169], v8 offset:32768
    ds_read_b64_tr_b16 a[170:171], v8 offset:33792
    v_mfma_f32_16x16x32_bf16 v[136:139], a[132:135], v[84:87], v[136:139]
    v_exp_f32 v165, v165
    v_mfma_f32_16x16x32_bf16 v[140:143], a[148:151], v[84:87], v[140:143]
    v_cvt_pk_bf16_f32 v210, v164, v165
    v_mfma_f32_16x16x32_bf16 v[144:147], a[132:135], v[100:103], v[144:147]
    v_exp_f32 v166, v166
    v_mfma_f32_16x16x32_bf16 v[148:151], a[148:151], v[100:103], v[148:151]
    ds_read_b64_tr_b16 a[172:173], v9 offset:32768
    ds_read_b64_tr_b16 a[174:175], v9 offset:33792
    v_mfma_f32_16x16x32_bf16 v[152:155], a[132:135], v[116:119], v[152:155]
    v_exp_f32 v167, v167
    v_mfma_f32_16x16x32_bf16 v[156:159], a[148:151], v[116:119], v[156:159]
    v_cvt_pk_bf16_f32 v211, v166, v167
    v_mfma_f32_16x16x32_bf16 v[128:131], a[136:139], v[72:75], v[128:131]
    v_exp_f32 v168, v168
    v_mfma_f32_16x16x32_bf16 v[132:135], a[152:155], v[72:75], v[132:135]
    ds_read_b64_tr_b16 a[176:177], v10 offset:32768
    ds_read_b64_tr_b16 a[178:179], v10 offset:33792
    v_mfma_f32_16x16x32_bf16 v[136:139], a[136:139], v[88:91], v[136:139]
    v_exp_f32 v169, v169
    v_mfma_f32_16x16x32_bf16 v[140:143], a[152:155], v[88:91], v[140:143]
    v_cvt_pk_bf16_f32 v212, v168, v169
    v_mfma_f32_16x16x32_bf16 v[144:147], a[136:139], v[104:107], v[144:147]
    v_exp_f32 v170, v170
    v_mfma_f32_16x16x32_bf16 v[148:151], a[152:155], v[104:107], v[148:151]
    ds_read_b64_tr_b16 a[180:181], v11 offset:32768
    ds_read_b64_tr_b16 a[182:183], v11 offset:33792
    v_mfma_f32_16x16x32_bf16 v[152:155], a[136:139], v[120:123], v[152:155]
    v_exp_f32 v171, v171
    v_mfma_f32_16x16x32_bf16 v[156:159], a[152:155], v[120:123], v[156:159]
    v_cvt_pk_bf16_f32 v213, v170, v171
    s_waitcnt lgkmcnt(2)
    v_mfma_f32_16x16x32_bf16 v[128:131], a[140:143], v[76:79], v[128:131]
    v_exp_f32 v172, v172
    v_mfma_f32_16x16x32_bf16 v[132:135], a[156:159], v[76:79], v[132:135]
    ds_read_b64_tr_b16 a[184:185], v12 offset:32768
    ds_read_b64_tr_b16 a[186:187], v12 offset:33792
    v_mfma_f32_16x16x32_bf16 v[136:139], a[140:143], v[92:95], v[136:139]
    v_exp_f32 v173, v173
    v_mfma_f32_16x16x32_bf16 v[140:143], a[156:159], v[92:95], v[140:143]
    v_cvt_pk_bf16_f32 v214, v172, v173
    v_mfma_f32_16x16x32_bf16 v[144:147], a[140:143], v[108:111], v[144:147]
    v_exp_f32 v174, v174
    v_mfma_f32_16x16x32_bf16 v[148:151], a[156:159], v[108:111], v[148:151]
    ds_read_b64_tr_b16 a[188:189], v13 offset:32768
    ds_read_b64_tr_b16 a[190:191], v13 offset:33792
    v_mfma_f32_16x16x32_bf16 v[152:155], a[140:143], v[124:127], v[152:155]
    v_exp_f32 v175, v175
    v_mfma_f32_16x16x32_bf16 v[156:159], a[156:159], v[124:127], v[156:159]
    v_cvt_pk_bf16_f32 v215, v174, v175
    v_mfma_f32_16x16x32_bf16 a[0:3], a[160:163], v[192:195], a[0:3]
    v_exp_f32 v176, v176
    v_mfma_f32_16x16x32_bf16 a[16:19], a[164:167], v[192:195], a[16:19]
    v_mfma_f32_16x16x32_bf16 a[32:35], a[168:171], v[192:195], a[32:35]
    v_exp_f32 v177, v177
    v_mfma_f32_16x16x32_bf16 a[48:51], a[172:175], v[192:195], a[48:51]
    v_cvt_pk_bf16_f32 v216, v176, v177
    v_mfma_f32_16x16x32_bf16 a[64:67], a[176:179], v[192:195], a[64:67]
    v_exp_f32 v178, v178
    s_add_u32 m0, s51, 0
    s_waitcnt lgkmcnt(0)
    v_mfma_f32_16x16x32_bf16 a[80:83], a[180:183], v[192:195], a[80:83]
    buffer_load_dwordx4 v24, s[8:11], s47 offen offset:0 lds
    v_mfma_f32_16x16x32_bf16 a[96:99], a[184:187], v[192:195], a[96:99]
    v_exp_f32 v179, v179
    v_mfma_f32_16x16x32_bf16 a[112:115], a[188:191], v[192:195], a[112:115]
    v_cvt_pk_bf16_f32 v217, v178, v179
    v_mfma_f32_16x16x32_bf16 a[192:195], a[208:211], v[192:195], a[192:195]
    ds_read_b128 a[128:131], v2 offset:24576
    ds_read_b128 a[144:147], v2 offset:25600
    v_mfma_f32_16x16x32_bf16 a[4:7], a[160:163], v[196:199], a[4:7]
    v_exp_f32 v180, v180
    v_mfma_f32_16x16x32_bf16 a[20:23], a[164:167], v[196:199], a[20:23]
    buffer_load_dwordx4 v24, s[8:11], s47 offen offset:1024 lds
    v_mfma_f32_16x16x32_bf16 a[36:39], a[168:171], v[196:199], a[36:39]
    v_exp_f32 v181, v181
    v_mfma_f32_16x16x32_bf16 a[52:55], a[172:175], v[196:199], a[52:55]
    v_cvt_pk_bf16_f32 v218, v180, v181
    v_mfma_f32_16x16x32_bf16 a[68:71], a[176:179], v[196:199], a[68:71]
    v_exp_f32 v182, v182
    v_mfma_f32_16x16x32_bf16 a[84:87], a[180:183], v[196:199], a[84:87]
    buffer_load_dwordx4 v25, s[8:11], s47 offen offset:2048 lds
    v_mfma_f32_16x16x32_bf16 a[100:103], a[184:187], v[196:199], a[100:103]
    v_exp_f32 v183, v183
    v_mfma_f32_16x16x32_bf16 a[116:119], a[188:191], v[196:199], a[116:119]
    v_cvt_pk_bf16_f32 v219, v182, v183
    v_mfma_f32_16x16x32_bf16 a[196:199], a[208:211], v[196:199], a[196:199]
    ds_read_b128 a[132:135], v3 offset:24576
    ds_read_b128 a[148:151], v3 offset:25600
    v_mfma_f32_16x16x32_bf16 a[8:11], a[160:163], v[200:203], a[8:11]
    v_exp_f32 v184, v184
    v_mfma_f32_16x16x32_bf16 a[24:27], a[164:167], v[200:203], a[24:27]
    buffer_load_dwordx4 v25, s[8:11], s47 offen offset:3072 lds
    s_add_u32 s47, s47, 16384
    v_mfma_f32_16x16x32_bf16 a[40:43], a[168:171], v[200:203], a[40:43]
    v_exp_f32 v185, v185
    v_mfma_f32_16x16x32_bf16 a[56:59], a[172:175], v[200:203], a[56:59]
    v_cvt_pk_bf16_f32 v220, v184, v185
    v_mfma_f32_16x16x32_bf16 a[72:75], a[176:179], v[200:203], a[72:75]
    v_exp_f32 v186, v186
    v_mfma_f32_16x16x32_bf16 a[88:91], a[180:183], v[200:203], a[88:91]
    v_mfma_f32_16x16x32_bf16 a[104:107], a[184:187], v[200:203], a[104:107]
    v_exp_f32 v187, v187
    v_mfma_f32_16x16x32_bf16 a[120:123], a[188:191], v[200:203], a[120:123]
    v_cvt_pk_bf16_f32 v221, v186, v187
    v_mfma_f32_16x16x32_bf16 a[200:203], a[208:211], v[200:203], a[200:203]
    ds_read_b128 a[136:139], v4 offset:24576
    ds_read_b128 a[152:155], v4 offset:25600
    v_mfma_f32_16x16x32_bf16 a[12:15], a[160:163], v[204:207], a[12:15]
    v_exp_f32 v188, v188
    v_mfma_f32_16x16x32_bf16 a[28:31], a[164:167], v[204:207], a[28:31]
    v_mfma_f32_16x16x32_bf16 a[44:47], a[168:171], v[204:207], a[44:47]
    v_exp_f32 v189, v189
    v_mfma_f32_16x16x32_bf16 a[60:63], a[172:175], v[204:207], a[60:63]
    v_cvt_pk_bf16_f32 v222, v188, v189
    v_mfma_f32_16x16x32_bf16 a[76:79], a[176:179], v[204:207], a[76:79]
    v_exp_f32 v190, v190
    v_mfma_f32_16x16x32_bf16 a[92:95], a[180:183], v[204:207], a[92:95]
    v_mfma_f32_16x16x32_bf16 a[108:111], a[184:187], v[204:207], a[108:111]
    v_exp_f32 v191, v191
    v_mfma_f32_16x16x32_bf16 a[124:127], a[188:191], v[204:207], a[124:127]
    v_cvt_pk_bf16_f32 v223, v190, v191
    v_mfma_f32_16x16x32_bf16 a[204:207], a[208:211], v[204:207], a[204:207]
    ds_read_b128 a[140:143], v5 offset:24576
    ds_read_b128 a[156:159], v5 offset:25600
    s_waitcnt lgkmcnt(2)
    v_mfma_f32_16x16x32_bf16 v[160:163], a[128:131], v[64:67], v[224:227]
    s_waitcnt vmcnt(8)
    s_barrier
    v_exp_f32 v128, v128
    v_mfma_f32_16x16x32_bf16 v[164:167], a[144:147], v[64:67], v[224:227]
    ds_read_b64_tr_b16 a[160:161], v6 offset:40960
    ds_read_b64_tr_b16 a[162:163], v6 offset:41984
    v_mfma_f32_16x16x32_bf16 v[168:171], a[128:131], v[80:83], v[228:231]
    v_exp_f32 v129, v129
    v_mfma_f32_16x16x32_bf16 v[172:175], a[144:147], v[80:83], v[228:231]
    v_cvt_pk_bf16_f32 v192, v128, v129
    v_mfma_f32_16x16x32_bf16 v[176:179], a[128:131], v[96:99], v[232:235]
    v_exp_f32 v130, v130
    v_mfma_f32_16x16x32_bf16 v[180:183], a[144:147], v[96:99], v[232:235]
    ds_read_b64_tr_b16 a[164:165], v7 offset:40960
    ds_read_b64_tr_b16 a[166:167], v7 offset:41984
    v_mfma_f32_16x16x32_bf16 v[184:187], a[128:131], v[112:115], v[236:239]
    v_exp_f32 v131, v131
    v_mfma_f32_16x16x32_bf16 v[188:191], a[144:147], v[112:115], v[236:239]
    v_cvt_pk_bf16_f32 v193, v130, v131
    v_mfma_f32_16x16x32_bf16 v[160:163], a[132:135], v[68:71], v[160:163]
    v_exp_f32 v132, v132
    v_mfma_f32_16x16x32_bf16 v[164:167], a[148:151], v[68:71], v[164:167]
    ds_read_b64_tr_b16 a[168:169], v8 offset:40960
    ds_read_b64_tr_b16 a[170:171], v8 offset:41984
    v_mfma_f32_16x16x32_bf16 v[168:171], a[132:135], v[84:87], v[168:171]
    v_exp_f32 v133, v133
    v_mfma_f32_16x16x32_bf16 v[172:175], a[148:151], v[84:87], v[172:175]
    v_cvt_pk_bf16_f32 v194, v132, v133
    v_mfma_f32_16x16x32_bf16 v[176:179], a[132:135], v[100:103], v[176:179]
    v_exp_f32 v134, v134
    v_mfma_f32_16x16x32_bf16 v[180:183], a[148:151], v[100:103], v[180:183]
    ds_read_b64_tr_b16 a[172:173], v9 offset:40960
    ds_read_b64_tr_b16 a[174:175], v9 offset:41984
    v_mfma_f32_16x16x32_bf16 v[184:187], a[132:135], v[116:119], v[184:187]
    v_exp_f32 v135, v135
    v_mfma_f32_16x16x32_bf16 v[188:191], a[148:151], v[116:119], v[188:191]
    v_cvt_pk_bf16_f32 v195, v134, v135
    v_mfma_f32_16x16x32_bf16 v[160:163], a[136:139], v[72:75], v[160:163]
    v_exp_f32 v136, v136
    v_mfma_f32_16x16x32_bf16 v[164:167], a[152:155], v[72:75], v[164:167]
    ds_read_b64_tr_b16 a[176:177], v10 offset:40960
    ds_read_b64_tr_b16 a[178:179], v10 offset:41984
    v_mfma_f32_16x16x32_bf16 v[168:171], a[136:139], v[88:91], v[168:171]
    v_exp_f32 v137, v137
    v_mfma_f32_16x16x32_bf16 v[172:175], a[152:155], v[88:91], v[172:175]
    v_cvt_pk_bf16_f32 v196, v136, v137
    v_mfma_f32_16x16x32_bf16 v[176:179], a[136:139], v[104:107], v[176:179]
    v_exp_f32 v138, v138
    v_mfma_f32_16x16x32_bf16 v[180:183], a[152:155], v[104:107], v[180:183]
    ds_read_b64_tr_b16 a[180:181], v11 offset:40960
    ds_read_b64_tr_b16 a[182:183], v11 offset:41984
    v_mfma_f32_16x16x32_bf16 v[184:187], a[136:139], v[120:123], v[184:187]
    v_exp_f32 v139, v139
    v_mfma_f32_16x16x32_bf16 v[188:191], a[152:155], v[120:123], v[188:191]
    v_cvt_pk_bf16_f32 v197, v138, v139
    s_waitcnt lgkmcnt(2)
    v_mfma_f32_16x16x32_bf16 v[160:163], a[140:143], v[76:79], v[160:163]
    v_exp_f32 v140, v140
    v_mfma_f32_16x16x32_bf16 v[164:167], a[156:159], v[76:79], v[164:167]
    ds_read_b64_tr_b16 a[184:185], v12 offset:40960
    ds_read_b64_tr_b16 a[186:187], v12 offset:41984
    v_mfma_f32_16x16x32_bf16 v[168:171], a[140:143], v[92:95], v[168:171]
    v_exp_f32 v141, v141
    v_mfma_f32_16x16x32_bf16 v[172:175], a[156:159], v[92:95], v[172:175]
    v_cvt_pk_bf16_f32 v198, v140, v141
    v_mfma_f32_16x16x32_bf16 v[176:179], a[140:143], v[108:111], v[176:179]
    v_exp_f32 v142, v142
    v_mfma_f32_16x16x32_bf16 v[180:183], a[156:159], v[108:111], v[180:183]
    ds_read_b64_tr_b16 a[188:189], v13 offset:40960
    ds_read_b64_tr_b16 a[190:191], v13 offset:41984
    v_mfma_f32_16x16x32_bf16 v[184:187], a[140:143], v[124:127], v[184:187]
    v_exp_f32 v143, v143
    v_mfma_f32_16x16x32_bf16 v[188:191], a[156:159], v[124:127], v[188:191]
    v_cvt_pk_bf16_f32 v199, v142, v143
    v_mfma_f32_16x16x32_bf16 a[0:3], a[160:163], v[208:211], a[0:3]
    v_exp_f32 v144, v144
    v_mfma_f32_16x16x32_bf16 a[16:19], a[164:167], v[208:211], a[16:19]
    v_mfma_f32_16x16x32_bf16 a[32:35], a[168:171], v[208:211], a[32:35]
    v_exp_f32 v145, v145
    v_mfma_f32_16x16x32_bf16 a[48:51], a[172:175], v[208:211], a[48:51]
    v_cvt_pk_bf16_f32 v200, v144, v145
    v_mfma_f32_16x16x32_bf16 a[64:67], a[176:179], v[208:211], a[64:67]
    v_exp_f32 v146, v146
    s_waitcnt lgkmcnt(0)
    v_mfma_f32_16x16x32_bf16 a[80:83], a[180:183], v[208:211], a[80:83]
    v_mfma_f32_16x16x32_bf16 a[96:99], a[184:187], v[208:211], a[96:99]
    v_exp_f32 v147, v147
    v_mfma_f32_16x16x32_bf16 a[112:115], a[188:191], v[208:211], a[112:115]
    v_cvt_pk_bf16_f32 v201, v146, v147
    v_mfma_f32_16x16x32_bf16 a[192:195], a[208:211], v[208:211], a[192:195]
    ds_read_b128 a[128:131], v2 offset:32768
    ds_read_b128 a[144:147], v2 offset:33792
    v_mfma_f32_16x16x32_bf16 a[4:7], a[160:163], v[212:215], a[4:7]
    v_exp_f32 v148, v148
    v_mfma_f32_16x16x32_bf16 a[20:23], a[164:167], v[212:215], a[20:23]
    v_mfma_f32_16x16x32_bf16 a[36:39], a[168:171], v[212:215], a[36:39]
    v_exp_f32 v149, v149
    v_mfma_f32_16x16x32_bf16 a[52:55], a[172:175], v[212:215], a[52:55]
    v_cvt_pk_bf16_f32 v202, v148, v149
    v_mfma_f32_16x16x32_bf16 a[68:71], a[176:179], v[212:215], a[68:71]
    v_exp_f32 v150, v150
    v_mfma_f32_16x16x32_bf16 a[84:87], a[180:183], v[212:215], a[84:87]
    v_mfma_f32_16x16x32_bf16 a[100:103], a[184:187], v[212:215], a[100:103]
    v_exp_f32 v151, v151
    v_mfma_f32_16x16x32_bf16 a[116:119], a[188:191], v[212:215], a[116:119]
    v_cvt_pk_bf16_f32 v203, v150, v151
    v_mfma_f32_16x16x32_bf16 a[196:199], a[208:211], v[212:215], a[196:199]
    ds_read_b128 a[132:135], v3 offset:32768
    ds_read_b128 a[148:151], v3 offset:33792
    v_mfma_f32_16x16x32_bf16 a[8:11], a[160:163], v[216:219], a[8:11]
    v_exp_f32 v152, v152
    v_mfma_f32_16x16x32_bf16 a[24:27], a[164:167], v[216:219], a[24:27]
    v_mfma_f32_16x16x32_bf16 a[40:43], a[168:171], v[216:219], a[40:43]
    v_exp_f32 v153, v153
    v_mfma_f32_16x16x32_bf16 a[56:59], a[172:175], v[216:219], a[56:59]
    v_cvt_pk_bf16_f32 v204, v152, v153
    v_mfma_f32_16x16x32_bf16 a[72:75], a[176:179], v[216:219], a[72:75]
    v_exp_f32 v154, v154
    v_mfma_f32_16x16x32_bf16 a[88:91], a[180:183], v[216:219], a[88:91]
    v_mfma_f32_16x16x32_bf16 a[104:107], a[184:187], v[216:219], a[104:107]
    v_exp_f32 v155, v155
    v_mfma_f32_16x16x32_bf16 a[120:123], a[188:191], v[216:219], a[120:123]
    v_cvt_pk_bf16_f32 v205, v154, v155
    v_mfma_f32_16x16x32_bf16 a[200:203], a[208:211], v[216:219], a[200:203]
    ds_read_b128 a[136:139], v4 offset:32768
    ds_read_b128 a[152:155], v4 offset:33792
    v_mfma_f32_16x16x32_bf16 a[12:15], a[160:163], v[220:223], a[12:15]
    v_exp_f32 v156, v156
    v_mfma_f32_16x16x32_bf16 a[28:31], a[164:167], v[220:223], a[28:31]
    v_mfma_f32_16x16x32_bf16 a[44:47], a[168:171], v[220:223], a[44:47]
    v_exp_f32 v157, v157
    v_mfma_f32_16x16x32_bf16 a[60:63], a[172:175], v[220:223], a[60:63]
    v_cvt_pk_bf16_f32 v206, v156, v157
    v_mfma_f32_16x16x32_bf16 a[76:79], a[176:179], v[220:223], a[76:79]
    v_exp_f32 v158, v158
    v_mfma_f32_16x16x32_bf16 a[92:95], a[180:183], v[220:223], a[92:95]
    v_mfma_f32_16x16x32_bf16 a[108:111], a[184:187], v[220:223], a[108:111]
    v_exp_f32 v159, v159
    v_mfma_f32_16x16x32_bf16 a[124:127], a[188:191], v[220:223], a[124:127]
    v_cvt_pk_bf16_f32 v207, v158, v159
    v_mfma_f32_16x16x32_bf16 a[204:207], a[208:211], v[220:223], a[204:207]
    ds_read_b128 a[140:143], v5 offset:32768
    ds_read_b128 a[156:159], v5 offset:33792
    s_waitcnt lgkmcnt(2)
    v_mfma_f32_16x16x32_bf16 v[128:131], a[128:131], v[64:67], v[224:227]
    v_exp_f32 v160, v160
    v_mfma_f32_16x16x32_bf16 v[132:135], a[144:147], v[64:67], v[224:227]
    ds_read_b64_tr_b16 a[160:161], v6 offset:49152
    ds_read_b64_tr_b16 a[162:163], v6 offset:50176
    v_mfma_f32_16x16x32_bf16 v[136:139], a[128:131], v[80:83], v[228:231]
    v_exp_f32 v161, v161
    v_mfma_f32_16x16x32_bf16 v[140:143], a[144:147], v[80:83], v[228:231]
    v_cvt_pk_bf16_f32 v208, v160, v161
    v_mfma_f32_16x16x32_bf16 v[144:147], a[128:131], v[96:99], v[232:235]
    v_exp_f32 v162, v162
    v_mfma_f32_16x16x32_bf16 v[148:151], a[144:147], v[96:99], v[232:235]
    ds_read_b64_tr_b16 a[164:165], v7 offset:49152
    ds_read_b64_tr_b16 a[166:167], v7 offset:50176
    v_mfma_f32_16x16x32_bf16 v[152:155], a[128:131], v[112:115], v[236:239]
    v_exp_f32 v163, v163
    v_mfma_f32_16x16x32_bf16 v[156:159], a[144:147], v[112:115], v[236:239]
    v_cvt_pk_bf16_f32 v209, v162, v163
    v_mfma_f32_16x16x32_bf16 v[128:131], a[132:135], v[68:71], v[128:131]
    v_exp_f32 v164, v164
    v_mfma_f32_16x16x32_bf16 v[132:135], a[148:151], v[68:71], v[132:135]
    ds_read_b64_tr_b16 a[168:169], v8 offset:49152
    ds_read_b64_tr_b16 a[170:171], v8 offset:50176
    v_mfma_f32_16x16x32_bf16 v[136:139], a[132:135], v[84:87], v[136:139]
    v_exp_f32 v165, v165
    v_mfma_f32_16x16x32_bf16 v[140:143], a[148:151], v[84:87], v[140:143]
    v_cvt_pk_bf16_f32 v210, v164, v165
    v_mfma_f32_16x16x32_bf16 v[144:147], a[132:135], v[100:103], v[144:147]
    v_exp_f32 v166, v166
    v_mfma_f32_16x16x32_bf16 v[148:151], a[148:151], v[100:103], v[148:151]
    ds_read_b64_tr_b16 a[172:173], v9 offset:49152
    ds_read_b64_tr_b16 a[174:175], v9 offset:50176
    v_mfma_f32_16x16x32_bf16 v[152:155], a[132:135], v[116:119], v[152:155]
    v_exp_f32 v167, v167
    v_mfma_f32_16x16x32_bf16 v[156:159], a[148:151], v[116:119], v[156:159]
    v_cvt_pk_bf16_f32 v211, v166, v167
    v_mfma_f32_16x16x32_bf16 v[128:131], a[136:139], v[72:75], v[128:131]
    v_exp_f32 v168, v168
    v_mfma_f32_16x16x32_bf16 v[132:135], a[152:155], v[72:75], v[132:135]
    ds_read_b64_tr_b16 a[176:177], v10 offset:49152
    ds_read_b64_tr_b16 a[178:179], v10 offset:50176
    v_mfma_f32_16x16x32_bf16 v[136:139], a[136:139], v[88:91], v[136:139]
    v_exp_f32 v169, v169
    v_mfma_f32_16x16x32_bf16 v[140:143], a[152:155], v[88:91], v[140:143]
    v_cvt_pk_bf16_f32 v212, v168, v169
    v_mfma_f32_16x16x32_bf16 v[144:147], a[136:139], v[104:107], v[144:147]
    v_exp_f32 v170, v170
    v_mfma_f32_16x16x32_bf16 v[148:151], a[152:155], v[104:107], v[148:151]
    ds_read_b64_tr_b16 a[180:181], v11 offset:49152
    ds_read_b64_tr_b16 a[182:183], v11 offset:50176
    v_mfma_f32_16x16x32_bf16 v[152:155], a[136:139], v[120:123], v[152:155]
    v_exp_f32 v171, v171
    v_mfma_f32_16x16x32_bf16 v[156:159], a[152:155], v[120:123], v[156:159]
    v_cvt_pk_bf16_f32 v213, v170, v171
    s_waitcnt lgkmcnt(2)
    v_mfma_f32_16x16x32_bf16 v[128:131], a[140:143], v[76:79], v[128:131]
    v_exp_f32 v172, v172
    v_mfma_f32_16x16x32_bf16 v[132:135], a[156:159], v[76:79], v[132:135]
    ds_read_b64_tr_b16 a[184:185], v12 offset:49152
    ds_read_b64_tr_b16 a[186:187], v12 offset:50176
    v_mfma_f32_16x16x32_bf16 v[136:139], a[140:143], v[92:95], v[136:139]
    v_exp_f32 v173, v173
    v_mfma_f32_16x16x32_bf16 v[140:143], a[156:159], v[92:95], v[140:143]
    v_cvt_pk_bf16_f32 v214, v172, v173
    v_mfma_f32_16x16x32_bf16 v[144:147], a[140:143], v[108:111], v[144:147]
    v_exp_f32 v174, v174
    v_mfma_f32_16x16x32_bf16 v[148:151], a[156:159], v[108:111], v[148:151]
    ds_read_b64_tr_b16 a[188:189], v13 offset:49152
    ds_read_b64_tr_b16 a[190:191], v13 offset:50176
    v_mfma_f32_16x16x32_bf16 v[152:155], a[140:143], v[124:127], v[152:155]
    v_exp_f32 v175, v175
    v_mfma_f32_16x16x32_bf16 v[156:159], a[156:159], v[124:127], v[156:159]
    v_cvt_pk_bf16_f32 v215, v174, v175
    v_mfma_f32_16x16x32_bf16 a[0:3], a[160:163], v[192:195], a[0:3]
    v_exp_f32 v176, v176
    v_mfma_f32_16x16x32_bf16 a[16:19], a[164:167], v[192:195], a[16:19]
    v_mfma_f32_16x16x32_bf16 a[32:35], a[168:171], v[192:195], a[32:35]
    v_exp_f32 v177, v177
    v_mfma_f32_16x16x32_bf16 a[48:51], a[172:175], v[192:195], a[48:51]
    v_cvt_pk_bf16_f32 v216, v176, v177
    v_mfma_f32_16x16x32_bf16 a[64:67], a[176:179], v[192:195], a[64:67]
    v_exp_f32 v178, v178
    s_add_u32 m0, s51, 16384
    s_waitcnt lgkmcnt(0)
    v_mfma_f32_16x16x32_bf16 a[80:83], a[180:183], v[192:195], a[80:83]
    buffer_load_dwordx4 v24, s[8:11], s47 offen offset:0 lds
    v_mfma_f32_16x16x32_bf16 a[96:99], a[184:187], v[192:195], a[96:99]
    v_exp_f32 v179, v179
    v_mfma_f32_16x16x32_bf16 a[112:115], a[188:191], v[192:195], a[112:115]
    v_cvt_pk_bf16_f32 v217, v178, v179
    v_mfma_f32_16x16x32_bf16 a[192:195], a[208:211], v[192:195], a[192:195]
    ds_read_b128 a[128:131], v2 offset:40960
    ds_read_b128 a[144:147], v2 offset:41984
    v_mfma_f32_16x16x32_bf16 a[4:7], a[160:163], v[196:199], a[4:7]
    v_exp_f32 v180, v180
    v_mfma_f32_16x16x32_bf16 a[20:23], a[164:167], v[196:199], a[20:23]
    buffer_load_dwordx4 v24, s[8:11], s47 offen offset:1024 lds
    v_mfma_f32_16x16x32_bf16 a[36:39], a[168:171], v[196:199], a[36:39]
    v_exp_f32 v181, v181
    v_mfma_f32_16x16x32_bf16 a[52:55], a[172:175], v[196:199], a[52:55]
    v_cvt_pk_bf16_f32 v218, v180, v181
    v_mfma_f32_16x16x32_bf16 a[68:71], a[176:179], v[196:199], a[68:71]
    v_exp_f32 v182, v182
    v_mfma_f32_16x16x32_bf16 a[84:87], a[180:183], v[196:199], a[84:87]
    buffer_load_dwordx4 v25, s[8:11], s47 offen offset:2048 lds
    v_mfma_f32_16x16x32_bf16 a[100:103], a[184:187], v[196:199], a[100:103]
    v_exp_f32 v183, v183
    v_mfma_f32_16x16x32_bf16 a[116:119], a[188:191], v[196:199], a[116:119]
    v_cvt_pk_bf16_f32 v219, v182, v183
    v_mfma_f32_16x16x32_bf16 a[196:199], a[208:211], v[196:199], a[196:199]
    ds_read_b128 a[132:135], v3 offset:40960
    ds_read_b128 a[148:151], v3 offset:41984
    v_mfma_f32_16x16x32_bf16 a[8:11], a[160:163], v[200:203], a[8:11]
    v_exp_f32 v184, v184
    v_mfma_f32_16x16x32_bf16 a[24:27], a[164:167], v[200:203], a[24:27]
    buffer_load_dwordx4 v25, s[8:11], s47 offen offset:3072 lds
    s_add_u32 s47, s47, 16384
    v_mfma_f32_16x16x32_bf16 a[40:43], a[168:171], v[200:203], a[40:43]
    v_exp_f32 v185, v185
    v_mfma_f32_16x16x32_bf16 a[56:59], a[172:175], v[200:203], a[56:59]
    v_cvt_pk_bf16_f32 v220, v184, v185
    v_mfma_f32_16x16x32_bf16 a[72:75], a[176:179], v[200:203], a[72:75]
    v_exp_f32 v186, v186
    v_mfma_f32_16x16x32_bf16 a[88:91], a[180:183], v[200:203], a[88:91]
    v_mfma_f32_16x16x32_bf16 a[104:107], a[184:187], v[200:203], a[104:107]
    v_exp_f32 v187, v187
    v_mfma_f32_16x16x32_bf16 a[120:123], a[188:191], v[200:203], a[120:123]
    v_cvt_pk_bf16_f32 v221, v186, v187
    v_mfma_f32_16x16x32_bf16 a[200:203], a[208:211], v[200:203], a[200:203]
    ds_read_b128 a[136:139], v4 offset:40960
    ds_read_b128 a[152:155], v4 offset:41984
    v_mfma_f32_16x16x32_bf16 a[12:15], a[160:163], v[204:207], a[12:15]
    v_exp_f32 v188, v188
    v_mfma_f32_16x16x32_bf16 a[28:31], a[164:167], v[204:207], a[28:31]
    v_mfma_f32_16x16x32_bf16 a[44:47], a[168:171], v[204:207], a[44:47]
    v_exp_f32 v189, v189
    v_mfma_f32_16x16x32_bf16 a[60:63], a[172:175], v[204:207], a[60:63]
    v_cvt_pk_bf16_f32 v222, v188, v189
    v_mfma_f32_16x16x32_bf16 a[76:79], a[176:179], v[204:207], a[76:79]
    v_exp_f32 v190, v190
    v_mfma_f32_16x16x32_bf16 a[92:95], a[180:183], v[204:207], a[92:95]
    v_mfma_f32_16x16x32_bf16 a[108:111], a[184:187], v[204:207], a[108:111]
    v_exp_f32 v191, v191
    v_mfma_f32_16x16x32_bf16 a[124:127], a[188:191], v[204:207], a[124:127]
    v_cvt_pk_bf16_f32 v223, v190, v191
    v_mfma_f32_16x16x32_bf16 a[204:207], a[208:211], v[204:207], a[204:207]
    ds_read_b128 a[140:143], v5 offset:40960
    ds_read_b128 a[156:159], v5 offset:41984
    s_waitcnt lgkmcnt(2)
    v_mfma_f32_16x16x32_bf16 v[160:163], a[128:131], v[64:67], v[224:227]
    s_waitcnt vmcnt(4)
    s_barrier
    v_exp_f32 v128, v128
    v_mfma_f32_16x16x32_bf16 v[164:167], a[144:147], v[64:67], v[224:227]
    ds_read_b64_tr_b16 a[160:161], v6 offset:57344
    ds_read_b64_tr_b16 a[162:163], v6 offset:58368
    v_mfma_f32_16x16x32_bf16 v[168:171], a[128:131], v[80:83], v[228:231]
    v_exp_f32 v129, v129
    v_mfma_f32_16x16x32_bf16 v[172:175], a[144:147], v[80:83], v[228:231]
    v_cvt_pk_bf16_f32 v192, v128, v129
    v_mfma_f32_16x16x32_bf16 v[176:179], a[128:131], v[96:99], v[232:235]
    v_exp_f32 v130, v130
    v_mfma_f32_16x16x32_bf16 v[180:183], a[144:147], v[96:99], v[232:235]
    ds_read_b64_tr_b16 a[164:165], v7 offset:57344
    ds_read_b64_tr_b16 a[166:167], v7 offset:58368
    v_mfma_f32_16x16x32_bf16 v[184:187], a[128:131], v[112:115], v[236:239]
    v_exp_f32 v131, v131
    v_mfma_f32_16x16x32_bf16 v[188:191], a[144:147], v[112:115], v[236:239]
    v_cvt_pk_bf16_f32 v193, v130, v131
    v_mfma_f32_16x16x32_bf16 v[160:163], a[132:135], v[68:71], v[160:163]
    v_exp_f32 v132, v132
    v_mfma_f32_16x16x32_bf16 v[164:167], a[148:151], v[68:71], v[164:167]
    ds_read_b64_tr_b16 a[168:169], v8 offset:57344
    ds_read_b64_tr_b16 a[170:171], v8 offset:58368
    v_mfma_f32_16x16x32_bf16 v[168:171], a[132:135], v[84:87], v[168:171]
    v_exp_f32 v133, v133
    v_mfma_f32_16x16x32_bf16 v[172:175], a[148:151], v[84:87], v[172:175]
    v_cvt_pk_bf16_f32 v194, v132, v133
    v_mfma_f32_16x16x32_bf16 v[176:179], a[132:135], v[100:103], v[176:179]
    v_exp_f32 v134, v134
    v_mfma_f32_16x16x32_bf16 v[180:183], a[148:151], v[100:103], v[180:183]
    ds_read_b64_tr_b16 a[172:173], v9 offset:57344
    ds_read_b64_tr_b16 a[174:175], v9 offset:58368
    v_mfma_f32_16x16x32_bf16 v[184:187], a[132:135], v[116:119], v[184:187]
    v_exp_f32 v135, v135
    v_mfma_f32_16x16x32_bf16 v[188:191], a[148:151], v[116:119], v[188:191]
    v_cvt_pk_bf16_f32 v195, v134, v135
    v_mfma_f32_16x16x32_bf16 v[160:163], a[136:139], v[72:75], v[160:163]
    v_exp_f32 v136, v136
    v_mfma_f32_16x16x32_bf16 v[164:167], a[152:155], v[72:75], v[164:167]
    ds_read_b64_tr_b16 a[176:177], v10 offset:57344
    ds_read_b64_tr_b16 a[178:179], v10 offset:58368
    v_mfma_f32_16x16x32_bf16 v[168:171], a[136:139], v[88:91], v[168:171]
    v_exp_f32 v137, v137
    v_mfma_f32_16x16x32_bf16 v[172:175], a[152:155], v[88:91], v[172:175]
    v_cvt_pk_bf16_f32 v196, v136, v137
    v_mfma_f32_16x16x32_bf16 v[176:179], a[136:139], v[104:107], v[176:179]
    v_exp_f32 v138, v138
    v_mfma_f32_16x16x32_bf16 v[180:183], a[152:155], v[104:107], v[180:183]
    ds_read_b64_tr_b16 a[180:181], v11 offset:57344
    ds_read_b64_tr_b16 a[182:183], v11 offset:58368
    v_mfma_f32_16x16x32_bf16 v[184:187], a[136:139], v[120:123], v[184:187]
    v_exp_f32 v139, v139
    v_mfma_f32_16x16x32_bf16 v[188:191], a[152:155], v[120:123], v[188:191]
    v_cvt_pk_bf16_f32 v197, v138, v139
    s_waitcnt lgkmcnt(2)
    v_mfma_f32_16x16x32_bf16 v[160:163], a[140:143], v[76:79], v[160:163]
    v_exp_f32 v140, v140
    v_mfma_f32_16x16x32_bf16 v[164:167], a[156:159], v[76:79], v[164:167]
    ds_read_b64_tr_b16 a[184:185], v12 offset:57344
    ds_read_b64_tr_b16 a[186:187], v12 offset:58368
    v_mfma_f32_16x16x32_bf16 v[168:171], a[140:143], v[92:95], v[168:171]
    v_exp_f32 v141, v141
    v_mfma_f32_16x16x32_bf16 v[172:175], a[156:159], v[92:95], v[172:175]
    v_cvt_pk_bf16_f32 v198, v140, v141
    v_mfma_f32_16x16x32_bf16 v[176:179], a[140:143], v[108:111], v[176:179]
    v_exp_f32 v142, v142
    v_mfma_f32_16x16x32_bf16 v[180:183], a[156:159], v[108:111], v[180:183]
    ds_read_b64_tr_b16 a[188:189], v13 offset:57344
    ds_read_b64_tr_b16 a[190:191], v13 offset:58368
    v_mfma_f32_16x16x32_bf16 v[184:187], a[140:143], v[124:127], v[184:187]
    v_exp_f32 v143, v143
    v_mfma_f32_16x16x32_bf16 v[188:191], a[156:159], v[124:127], v[188:191]
    v_cvt_pk_bf16_f32 v199, v142, v143
    v_mfma_f32_16x16x32_bf16 a[0:3], a[160:163], v[208:211], a[0:3]
    v_exp_f32 v144, v144
    v_mfma_f32_16x16x32_bf16 a[16:19], a[164:167], v[208:211], a[16:19]
    v_mfma_f32_16x16x32_bf16 a[32:35], a[168:171], v[208:211], a[32:35]
    v_exp_f32 v145, v145
    v_mfma_f32_16x16x32_bf16 a[48:51], a[172:175], v[208:211], a[48:51]
    v_cvt_pk_bf16_f32 v200, v144, v145
    v_mfma_f32_16x16x32_bf16 a[64:67], a[176:179], v[208:211], a[64:67]
    v_exp_f32 v146, v146
    s_waitcnt lgkmcnt(0)
    v_mfma_f32_16x16x32_bf16 a[80:83], a[180:183], v[208:211], a[80:83]
    v_mfma_f32_16x16x32_bf16 a[96:99], a[184:187], v[208:211], a[96:99]
    v_exp_f32 v147, v147
    v_mfma_f32_16x16x32_bf16 a[112:115], a[188:191], v[208:211], a[112:115]
    v_cvt_pk_bf16_f32 v201, v146, v147
    v_mfma_f32_16x16x32_bf16 a[192:195], a[208:211], v[208:211], a[192:195]
    ds_read_b128 a[128:131], v2 offset:49152
    ds_read_b128 a[144:147], v2 offset:50176
    v_mfma_f32_16x16x32_bf16 a[4:7], a[160:163], v[212:215], a[4:7]
    v_exp_f32 v148, v148
    v_mfma_f32_16x16x32_bf16 a[20:23], a[164:167], v[212:215], a[20:23]
    v_mfma_f32_16x16x32_bf16 a[36:39], a[168:171], v[212:215], a[36:39]
    v_exp_f32 v149, v149
    v_mfma_f32_16x16x32_bf16 a[52:55], a[172:175], v[212:215], a[52:55]
    v_cvt_pk_bf16_f32 v202, v148, v149
    v_mfma_f32_16x16x32_bf16 a[68:71], a[176:179], v[212:215], a[68:71]
    v_exp_f32 v150, v150
    v_mfma_f32_16x16x32_bf16 a[84:87], a[180:183], v[212:215], a[84:87]
    v_mfma_f32_16x16x32_bf16 a[100:103], a[184:187], v[212:215], a[100:103]
    v_exp_f32 v151, v151
    v_mfma_f32_16x16x32_bf16 a[116:119], a[188:191], v[212:215], a[116:119]
    v_cvt_pk_bf16_f32 v203, v150, v151
    v_mfma_f32_16x16x32_bf16 a[196:199], a[208:211], v[212:215], a[196:199]
    ds_read_b128 a[132:135], v3 offset:49152
    ds_read_b128 a[148:151], v3 offset:50176
    v_mfma_f32_16x16x32_bf16 a[8:11], a[160:163], v[216:219], a[8:11]
    v_exp_f32 v152, v152
    v_mfma_f32_16x16x32_bf16 a[24:27], a[164:167], v[216:219], a[24:27]
    v_mfma_f32_16x16x32_bf16 a[40:43], a[168:171], v[216:219], a[40:43]
    v_exp_f32 v153, v153
    v_mfma_f32_16x16x32_bf16 a[56:59], a[172:175], v[216:219], a[56:59]
    v_cvt_pk_bf16_f32 v204, v152, v153
    v_mfma_f32_16x16x32_bf16 a[72:75], a[176:179], v[216:219], a[72:75]
    v_exp_f32 v154, v154
    v_mfma_f32_16x16x32_bf16 a[88:91], a[180:183], v[216:219], a[88:91]
    v_mfma_f32_16x16x32_bf16 a[104:107], a[184:187], v[216:219], a[104:107]
    v_exp_f32 v155, v155
    v_mfma_f32_16x16x32_bf16 a[120:123], a[188:191], v[216:219], a[120:123]
    v_cvt_pk_bf16_f32 v205, v154, v155
    v_mfma_f32_16x16x32_bf16 a[200:203], a[208:211], v[216:219], a[200:203]
    ds_read_b128 a[136:139], v4 offset:49152
    ds_read_b128 a[152:155], v4 offset:50176
    v_mfma_f32_16x16x32_bf16 a[12:15], a[160:163], v[220:223], a[12:15]
    v_exp_f32 v156, v156
    v_mfma_f32_16x16x32_bf16 a[28:31], a[164:167], v[220:223], a[28:31]
    v_mfma_f32_16x16x32_bf16 a[44:47], a[168:171], v[220:223], a[44:47]
    v_exp_f32 v157, v157
    v_mfma_f32_16x16x32_bf16 a[60:63], a[172:175], v[220:223], a[60:63]
    v_cvt_pk_bf16_f32 v206, v156, v157
    v_mfma_f32_16x16x32_bf16 a[76:79], a[176:179], v[220:223], a[76:79]
    v_exp_f32 v158, v158
    v_mfma_f32_16x16x32_bf16 a[92:95], a[180:183], v[220:223], a[92:95]
    v_mfma_f32_16x16x32_bf16 a[108:111], a[184:187], v[220:223], a[108:111]
    v_exp_f32 v159, v159
    v_mfma_f32_16x16x32_bf16 a[124:127], a[188:191], v[220:223], a[124:127]
    v_cvt_pk_bf16_f32 v207, v158, v159
    v_mfma_f32_16x16x32_bf16 a[204:207], a[208:211], v[220:223], a[204:207]
    ds_read_b128 a[140:143], v5 offset:49152
    ds_read_b128 a[156:159], v5 offset:50176
    s_waitcnt lgkmcnt(2)
    v_mfma_f32_16x16x32_bf16 v[128:131], a[128:131], v[64:67], v[224:227]
    v_exp_f32 v160, v160
    v_mfma_f32_16x16x32_bf16 v[132:135], a[144:147], v[64:67], v[224:227]
    ds_read_b64_tr_b16 a[160:161], v6 offset:0
    ds_read_b64_tr_b16 a[162:163], v6 offset:1024
    v_mfma_f32_16x16x32_bf16 v[136:139], a[128:131], v[80:83], v[228:231]
    v_exp_f32 v161, v161
    v_mfma_f32_16x16x32_bf16 v[140:143], a[144:147], v[80:83], v[228:231]
    v_cvt_pk_bf16_f32 v208, v160, v161
    v_mfma_f32_16x16x32_bf16 v[144:147], a[128:131], v[96:99], v[232:235]
    v_exp_f32 v162, v162
    v_mfma_f32_16x16x32_bf16 v[148:151], a[144:147], v[96:99], v[232:235]
    ds_read_b64_tr_b16 a[164:165], v7 offset:0
    ds_read_b64_tr_b16 a[166:167], v7 offset:1024
    v_mfma_f32_16x16x32_bf16 v[152:155], a[128:131], v[112:115], v[236:239]
    v_exp_f32 v163, v163
    v_mfma_f32_16x16x32_bf16 v[156:159], a[144:147], v[112:115], v[236:239]
    v_cvt_pk_bf16_f32 v209, v162, v163
    v_mfma_f32_16x16x32_bf16 v[128:131], a[132:135], v[68:71], v[128:131]
    v_exp_f32 v164, v164
    v_mfma_f32_16x16x32_bf16 v[132:135], a[148:151], v[68:71], v[132:135]
    ds_read_b64_tr_b16 a[168:169], v8 offset:0
    ds_read_b64_tr_b16 a[170:171], v8 offset:1024
    v_mfma_f32_16x16x32_bf16 v[136:139], a[132:135], v[84:87], v[136:139]
    v_exp_f32 v165, v165
    v_mfma_f32_16x16x32_bf16 v[140:143], a[148:151], v[84:87], v[140:143]
    v_cvt_pk_bf16_f32 v210, v164, v165
    v_mfma_f32_16x16x32_bf16 v[144:147], a[132:135], v[100:103], v[144:147]
    v_exp_f32 v166, v166
    v_mfma_f32_16x16x32_bf16 v[148:151], a[148:151], v[100:103], v[148:151]
    ds_read_b64_tr_b16 a[172:173], v9 offset:0
    ds_read_b64_tr_b16 a[174:175], v9 offset:1024
    v_mfma_f32_16x16x32_bf16 v[152:155], a[132:135], v[116:119], v[152:155]
    v_exp_f32 v167, v167
    v_mfma_f32_16x16x32_bf16 v[156:159], a[148:151], v[116:119], v[156:159]
    v_cvt_pk_bf16_f32 v211, v166, v167
    v_mfma_f32_16x16x32_bf16 v[128:131], a[136:139], v[72:75], v[128:131]
    v_exp_f32 v168, v168
    v_mfma_f32_16x16x32_bf16 v[132:135], a[152:155], v[72:75], v[132:135]
    ds_read_b64_tr_b16 a[176:177], v10 offset:0
    ds_read_b64_tr_b16 a[178:179], v10 offset:1024
    v_mfma_f32_16x16x32_bf16 v[136:139], a[136:139], v[88:91], v[136:139]
    v_exp_f32 v169, v169
    v_mfma_f32_16x16x32_bf16 v[140:143], a[152:155], v[88:91], v[140:143]
    v_cvt_pk_bf16_f32 v212, v168, v169
    v_mfma_f32_16x16x32_bf16 v[144:147], a[136:139], v[104:107], v[144:147]
    v_exp_f32 v170, v170
    v_mfma_f32_16x16x32_bf16 v[148:151], a[152:155], v[104:107], v[148:151]
    ds_read_b64_tr_b16 a[180:181], v11 offset:0
    ds_read_b64_tr_b16 a[182:183], v11 offset:1024
    v_mfma_f32_16x16x32_bf16 v[152:155], a[136:139], v[120:123], v[152:155]
    v_exp_f32 v171, v171
    v_mfma_f32_16x16x32_bf16 v[156:159], a[152:155], v[120:123], v[156:159]
    v_cvt_pk_bf16_f32 v213, v170, v171
    s_waitcnt lgkmcnt(2)
    v_mfma_f32_16x16x32_bf16 v[128:131], a[140:143], v[76:79], v[128:131]
    v_exp_f32 v172, v172
    v_mfma_f32_16x16x32_bf16 v[132:135], a[156:159], v[76:79], v[132:135]
    ds_read_b64_tr_b16 a[184:185], v12 offset:0
    ds_read_b64_tr_b16 a[186:187], v12 offset:1024
    v_mfma_f32_16x16x32_bf16 v[136:139], a[140:143], v[92:95], v[136:139]
    v_exp_f32 v173, v173
    v_mfma_f32_16x16x32_bf16 v[140:143], a[156:159], v[92:95], v[140:143]
    v_cvt_pk_bf16_f32 v214, v172, v173
    v_mfma_f32_16x16x32_bf16 v[144:147], a[140:143], v[108:111], v[144:147]
    v_exp_f32 v174, v174
    v_mfma_f32_16x16x32_bf16 v[148:151], a[156:159], v[108:111], v[148:151]
    ds_read_b64_tr_b16 a[188:189], v13 offset:0
    ds_read_b64_tr_b16 a[190:191], v13 offset:1024
    v_mfma_f32_16x16x32_bf16 v[152:155], a[140:143], v[124:127], v[152:155]
    v_exp_f32 v175, v175
    v_mfma_f32_16x16x32_bf16 v[156:159], a[156:159], v[124:127], v[156:159]
    v_cvt_pk_bf16_f32 v215, v174, v175
    v_mfma_f32_16x16x32_bf16 a[0:3], a[160:163], v[192:195], a[0:3]
    v_exp_f32 v176, v176
    v_mfma_f32_16x16x32_bf16 a[16:19], a[164:167], v[192:195], a[16:19]
    v_mfma_f32_16x16x32_bf16 a[32:35], a[168:171], v[192:195], a[32:35]
    v_exp_f32 v177, v177
    v_mfma_f32_16x16x32_bf16 a[48:51], a[172:175], v[192:195], a[48:51]
    v_cvt_pk_bf16_f32 v216, v176, v177
    v_mfma_f32_16x16x32_bf16 a[64:67], a[176:179], v[192:195], a[64:67]
    v_exp_f32 v178, v178
    s_waitcnt lgkmcnt(0)
    v_mfma_f32_16x16x32_bf16 a[80:83], a[180:183], v[192:195], a[80:83]
    v_mfma_f32_16x16x32_bf16 a[96:99], a[184:187], v[192:195], a[96:99]
    v_exp_f32 v179, v179
    v_mfma_f32_16x16x32_bf16 a[112:115], a[188:191], v[192:195], a[112:115]
    v_cvt_pk_bf16_f32 v217, v178, v179
    v_mfma_f32_16x16x32_bf16 a[192:195], a[208:211], v[192:195], a[192:195]
    ds_read_b128 a[128:131], v2 offset:57344
    ds_read_b128 a[144:147], v2 offset:58368
    v_mfma_f32_16x16x32_bf16 a[4:7], a[160:163], v[196:199], a[4:7]
    v_exp_f32 v180, v180
    v_mfma_f32_16x16x32_bf16 a[20:23], a[164:167], v[196:199], a[20:23]
    v_mfma_f32_16x16x32_bf16 a[36:39], a[168:171], v[196:199], a[36:39]
    v_exp_f32 v181, v181
    v_mfma_f32_16x16x32_bf16 a[52:55], a[172:175], v[196:199], a[52:55]
    v_cvt_pk_bf16_f32 v218, v180, v181
    v_mfma_f32_16x16x32_bf16 a[68:71], a[176:179], v[196:199], a[68:71]
    v_exp_f32 v182, v182
    v_mfma_f32_16x16x32_bf16 a[84:87], a[180:183], v[196:199], a[84:87]
    v_mfma_f32_16x16x32_bf16 a[100:103], a[184:187], v[196:199], a[100:103]
    v_exp_f32 v183, v183
    v_mfma_f32_16x16x32_bf16 a[116:119], a[188:191], v[196:199], a[116:119]
    v_cvt_pk_bf16_f32 v219, v182, v183
    v_mfma_f32_16x16x32_bf16 a[196:199], a[208:211], v[196:199], a[196:199]
    ds_read_b128 a[132:135], v3 offset:57344
    ds_read_b128 a[148:151], v3 offset:58368
    v_mfma_f32_16x16x32_bf16 a[8:11], a[160:163], v[200:203], a[8:11]
    v_exp_f32 v184, v184
    v_mfma_f32_16x16x32_bf16 a[24:27], a[164:167], v[200:203], a[24:27]
    v_mfma_f32_16x16x32_bf16 a[40:43], a[168:171], v[200:203], a[40:43]
    v_exp_f32 v185, v185
    v_mfma_f32_16x16x32_bf16 a[56:59], a[172:175], v[200:203], a[56:59]
    v_cvt_pk_bf16_f32 v220, v184, v185
    v_mfma_f32_16x16x32_bf16 a[72:75], a[176:179], v[200:203], a[72:75]
    v_exp_f32 v186, v186
    v_mfma_f32_16x16x32_bf16 a[88:91], a[180:183], v[200:203], a[88:91]
    v_mfma_f32_16x16x32_bf16 a[104:107], a[184:187], v[200:203], a[104:107]
    v_exp_f32 v187, v187
    v_mfma_f32_16x16x32_bf16 a[120:123], a[188:191], v[200:203], a[120:123]
    v_cvt_pk_bf16_f32 v221, v186, v187
    v_mfma_f32_16x16x32_bf16 a[200:203], a[208:211], v[200:203], a[200:203]
    ds_read_b128 a[136:139], v4 offset:57344
    ds_read_b128 a[152:155], v4 offset:58368
    v_mfma_f32_16x16x32_bf16 a[12:15], a[160:163], v[204:207], a[12:15]
    v_exp_f32 v188, v188
    v_mfma_f32_16x16x32_bf16 a[28:31], a[164:167], v[204:207], a[28:31]
    v_mfma_f32_16x16x32_bf16 a[44:47], a[168:171], v[204:207], a[44:47]
    v_exp_f32 v189, v189
    v_mfma_f32_16x16x32_bf16 a[60:63], a[172:175], v[204:207], a[60:63]
    v_cvt_pk_bf16_f32 v222, v188, v189
    v_mfma_f32_16x16x32_bf16 a[76:79], a[176:179], v[204:207], a[76:79]
    v_exp_f32 v190, v190
    v_mfma_f32_16x16x32_bf16 a[92:95], a[180:183], v[204:207], a[92:95]
    v_mfma_f32_16x16x32_bf16 a[108:111], a[184:187], v[204:207], a[108:111]
    v_exp_f32 v191, v191
    v_mfma_f32_16x16x32_bf16 a[124:127], a[188:191], v[204:207], a[124:127]
    v_cvt_pk_bf16_f32 v223, v190, v191
    v_mfma_f32_16x16x32_bf16 a[204:207], a[208:211], v[204:207], a[204:207]
    ds_read_b128 a[140:143], v5 offset:57344
    ds_read_b128 a[156:159], v5 offset:58368
    s_waitcnt lgkmcnt(2)
    v_mfma_f32_16x16x32_bf16 v[160:163], a[128:131], v[64:67], v[224:227]
    s_waitcnt vmcnt(0)
    s_barrier
    v_exp_f32 v128, v128
    v_mfma_f32_16x16x32_bf16 v[164:167], a[144:147], v[64:67], v[224:227]
    ds_read_b64_tr_b16 a[160:161], v6 offset:8192
    ds_read_b64_tr_b16 a[162:163], v6 offset:9216
    v_mfma_f32_16x16x32_bf16 v[168:171], a[128:131], v[80:83], v[228:231]
    v_exp_f32 v129, v129
    v_mfma_f32_16x16x32_bf16 v[172:175], a[144:147], v[80:83], v[228:231]
    v_cvt_pk_bf16_f32 v192, v128, v129
    v_mfma_f32_16x16x32_bf16 v[176:179], a[128:131], v[96:99], v[232:235]
    v_exp_f32 v130, v130
    v_mfma_f32_16x16x32_bf16 v[180:183], a[144:147], v[96:99], v[232:235]
    ds_read_b64_tr_b16 a[164:165], v7 offset:8192
    ds_read_b64_tr_b16 a[166:167], v7 offset:9216
    v_mfma_f32_16x16x32_bf16 v[184:187], a[128:131], v[112:115], v[236:239]
    v_exp_f32 v131, v131
    v_mfma_f32_16x16x32_bf16 v[188:191], a[144:147], v[112:115], v[236:239]
    v_cvt_pk_bf16_f32 v193, v130, v131
    v_mfma_f32_16x16x32_bf16 v[160:163], a[132:135], v[68:71], v[160:163]
    v_exp_f32 v132, v132
    v_mfma_f32_16x16x32_bf16 v[164:167], a[148:151], v[68:71], v[164:167]
    ds_read_b64_tr_b16 a[168:169], v8 offset:8192
    ds_read_b64_tr_b16 a[170:171], v8 offset:9216
    v_mfma_f32_16x16x32_bf16 v[168:171], a[132:135], v[84:87], v[168:171]
    v_exp_f32 v133, v133
    v_mfma_f32_16x16x32_bf16 v[172:175], a[148:151], v[84:87], v[172:175]
    v_cvt_pk_bf16_f32 v194, v132, v133
    v_mfma_f32_16x16x32_bf16 v[176:179], a[132:135], v[100:103], v[176:179]
    v_exp_f32 v134, v134
    v_mfma_f32_16x16x32_bf16 v[180:183], a[148:151], v[100:103], v[180:183]
    ds_read_b64_tr_b16 a[172:173], v9 offset:8192
    ds_read_b64_tr_b16 a[174:175], v9 offset:9216
    v_mfma_f32_16x16x32_bf16 v[184:187], a[132:135], v[116:119], v[184:187]
    v_exp_f32 v135, v135
    v_mfma_f32_16x16x32_bf16 v[188:191], a[148:151], v[116:119], v[188:191]
    v_cvt_pk_bf16_f32 v195, v134, v135
    v_mfma_f32_16x16x32_bf16 v[160:163], a[136:139], v[72:75], v[160:163]
    v_exp_f32 v136, v136
    v_mfma_f32_16x16x32_bf16 v[164:167], a[152:155], v[72:75], v[164:167]
    ds_read_b64_tr_b16 a[176:177], v10 offset:8192
    ds_read_b64_tr_b16 a[178:179], v10 offset:9216
    v_mfma_f32_16x16x32_bf16 v[168:171], a[136:139], v[88:91], v[168:171]
    v_exp_f32 v137, v137
    v_mfma_f32_16x16x32_bf16 v[172:175], a[152:155], v[88:91], v[172:175]
    v_cvt_pk_bf16_f32 v196, v136, v137
    v_mfma_f32_16x16x32_bf16 v[176:179], a[136:139], v[104:107], v[176:179]
    v_exp_f32 v138, v138
    v_mfma_f32_16x16x32_bf16 v[180:183], a[152:155], v[104:107], v[180:183]
    ds_read_b64_tr_b16 a[180:181], v11 offset:8192
    ds_read_b64_tr_b16 a[182:183], v11 offset:9216
    v_mfma_f32_16x16x32_bf16 v[184:187], a[136:139], v[120:123], v[184:187]
    v_exp_f32 v139, v139
    v_mfma_f32_16x16x32_bf16 v[188:191], a[152:155], v[120:123], v[188:191]
    v_cvt_pk_bf16_f32 v197, v138, v139
    s_waitcnt lgkmcnt(2)
    v_mfma_f32_16x16x32_bf16 v[160:163], a[140:143], v[76:79], v[160:163]
    v_exp_f32 v140, v140
    v_mfma_f32_16x16x32_bf16 v[164:167], a[156:159], v[76:79], v[164:167]
    ds_read_b64_tr_b16 a[184:185], v12 offset:8192
    ds_read_b64_tr_b16 a[186:187], v12 offset:9216
    v_mfma_f32_16x16x32_bf16 v[168:171], a[140:143], v[92:95], v[168:171]
    v_exp_f32 v141, v141
    v_mfma_f32_16x16x32_bf16 v[172:175], a[156:159], v[92:95], v[172:175]
    v_cvt_pk_bf16_f32 v198, v140, v141
    v_mfma_f32_16x16x32_bf16 v[176:179], a[140:143], v[108:111], v[176:179]
    v_exp_f32 v142, v142
    v_mfma_f32_16x16x32_bf16 v[180:183], a[156:159], v[108:111], v[180:183]
    ds_read_b64_tr_b16 a[188:189], v13 offset:8192
    ds_read_b64_tr_b16 a[190:191], v13 offset:9216
    v_mfma_f32_16x16x32_bf16 v[184:187], a[140:143], v[124:127], v[184:187]
    v_exp_f32 v143, v143
    v_mfma_f32_16x16x32_bf16 v[188:191], a[156:159], v[124:127], v[188:191]
    v_cvt_pk_bf16_f32 v199, v142, v143
    v_mfma_f32_16x16x32_bf16 a[0:3], a[160:163], v[208:211], a[0:3]
    v_exp_f32 v144, v144
    v_mfma_f32_16x16x32_bf16 a[16:19], a[164:167], v[208:211], a[16:19]
    v_mfma_f32_16x16x32_bf16 a[32:35], a[168:171], v[208:211], a[32:35]
    v_exp_f32 v145, v145
    v_mfma_f32_16x16x32_bf16 a[48:51], a[172:175], v[208:211], a[48:51]
    v_cvt_pk_bf16_f32 v200, v144, v145
    v_mfma_f32_16x16x32_bf16 a[64:67], a[176:179], v[208:211], a[64:67]
    v_exp_f32 v146, v146
    s_waitcnt lgkmcnt(0)
    v_mfma_f32_16x16x32_bf16 a[80:83], a[180:183], v[208:211], a[80:83]
    v_mfma_f32_16x16x32_bf16 a[96:99], a[184:187], v[208:211], a[96:99]
    v_exp_f32 v147, v147
    v_mfma_f32_16x16x32_bf16 a[112:115], a[188:191], v[208:211], a[112:115]
    v_cvt_pk_bf16_f32 v201, v146, v147
    v_mfma_f32_16x16x32_bf16 a[192:195], a[208:211], v[208:211], a[192:195]
    v_mfma_f32_16x16x32_bf16 a[4:7], a[160:163], v[212:215], a[4:7]
    v_exp_f32 v148, v148
    v_mfma_f32_16x16x32_bf16 a[20:23], a[164:167], v[212:215], a[20:23]
    v_mfma_f32_16x16x32_bf16 a[36:39], a[168:171], v[212:215], a[36:39]
    v_exp_f32 v149, v149
    v_mfma_f32_16x16x32_bf16 a[52:55], a[172:175], v[212:215], a[52:55]
    v_cvt_pk_bf16_f32 v202, v148, v149
    v_mfma_f32_16x16x32_bf16 a[68:71], a[176:179], v[212:215], a[68:71]
    v_exp_f32 v150, v150
    v_mfma_f32_16x16x32_bf16 a[84:87], a[180:183], v[212:215], a[84:87]
    v_mfma_f32_16x16x32_bf16 a[100:103], a[184:187], v[212:215], a[100:103]
    v_exp_f32 v151, v151
    v_mfma_f32_16x16x32_bf16 a[116:119], a[188:191], v[212:215], a[116:119]
    v_cvt_pk_bf16_f32 v203, v150, v151
    v_mfma_f32_16x16x32_bf16 a[196:199], a[208:211], v[212:215], a[196:199]
    v_mfma_f32_16x16x32_bf16 a[8:11], a[160:163], v[216:219], a[8:11]
    v_exp_f32 v152, v152
    v_mfma_f32_16x16x32_bf16 a[24:27], a[164:167], v[216:219], a[24:27]
    v_mfma_f32_16x16x32_bf16 a[40:43], a[168:171], v[216:219], a[40:43]
    v_exp_f32 v153, v153
    v_mfma_f32_16x16x32_bf16 a[56:59], a[172:175], v[216:219], a[56:59]
    v_cvt_pk_bf16_f32 v204, v152, v153
    v_mfma_f32_16x16x32_bf16 a[72:75], a[176:179], v[216:219], a[72:75]
    v_exp_f32 v154, v154
    v_mfma_f32_16x16x32_bf16 a[88:91], a[180:183], v[216:219], a[88:91]
    v_mfma_f32_16x16x32_bf16 a[104:107], a[184:187], v[216:219], a[104:107]
    v_exp_f32 v155, v155
    v_mfma_f32_16x16x32_bf16 a[120:123], a[188:191], v[216:219], a[120:123]
    v_cvt_pk_bf16_f32 v205, v154, v155
    v_mfma_f32_16x16x32_bf16 a[200:203], a[208:211], v[216:219], a[200:203]
    v_mfma_f32_16x16x32_bf16 a[12:15], a[160:163], v[220:223], a[12:15]
    v_exp_f32 v156, v156
    v_mfma_f32_16x16x32_bf16 a[28:31], a[164:167], v[220:223], a[28:31]
    v_mfma_f32_16x16x32_bf16 a[44:47], a[168:171], v[220:223], a[44:47]
    v_exp_f32 v157, v157
    v_mfma_f32_16x16x32_bf16 a[60:63], a[172:175], v[220:223], a[60:63]
    v_cvt_pk_bf16_f32 v206, v156, v157
    v_mfma_f32_16x16x32_bf16 a[76:79], a[176:179], v[220:223], a[76:79]
    v_exp_f32 v158, v158
    v_mfma_f32_16x16x32_bf16 a[92:95], a[180:183], v[220:223], a[92:95]
    v_mfma_f32_16x16x32_bf16 a[108:111], a[184:187], v[220:223], a[108:111]
    v_exp_f32 v159, v159
    v_mfma_f32_16x16x32_bf16 a[124:127], a[188:191], v[220:223], a[124:127]
    v_cvt_pk_bf16_f32 v207, v158, v159
    v_mfma_f32_16x16x32_bf16 a[204:207], a[208:211], v[220:223], a[204:207]
    v_exp_f32 v160, v160
    ds_read_b64_tr_b16 a[160:161], v6 offset:16384
    ds_read_b64_tr_b16 a[162:163], v6 offset:17408
    v_exp_f32 v161, v161
    s_nop 0
    v_cvt_pk_bf16_f32 v208, v160, v161
    v_exp_f32 v162, v162
    ds_read_b64_tr_b16 a[164:165], v7 offset:16384
    ds_read_b64_tr_b16 a[166:167], v7 offset:17408
    v_exp_f32 v163, v163
    s_nop 0
    v_cvt_pk_bf16_f32 v209, v162, v163
    v_exp_f32 v164, v164
    ds_read_b64_tr_b16 a[168:169], v8 offset:16384
    ds_read_b64_tr_b16 a[170:171], v8 offset:17408
    v_exp_f32 v165, v165
    s_nop 0
    v_cvt_pk_bf16_f32 v210, v164, v165
    v_exp_f32 v166, v166
    ds_read_b64_tr_b16 a[172:173], v9 offset:16384
    ds_read_b64_tr_b16 a[174:175], v9 offset:17408
    v_exp_f32 v167, v167
    s_nop 0
    v_cvt_pk_bf16_f32 v211, v166, v167
    v_exp_f32 v168, v168
    ds_read_b64_tr_b16 a[176:177], v10 offset:16384
    ds_read_b64_tr_b16 a[178:179], v10 offset:17408
    v_exp_f32 v169, v169
    s_nop 0
    v_cvt_pk_bf16_f32 v212, v168, v169
    v_exp_f32 v170, v170
    ds_read_b64_tr_b16 a[180:181], v11 offset:16384
    ds_read_b64_tr_b16 a[182:183], v11 offset:17408
    v_exp_f32 v171, v171
    s_nop 0
    v_cvt_pk_bf16_f32 v213, v170, v171
    v_exp_f32 v172, v172
    ds_read_b64_tr_b16 a[184:185], v12 offset:16384
    ds_read_b64_tr_b16 a[186:187], v12 offset:17408
    v_exp_f32 v173, v173
    s_nop 0
    v_cvt_pk_bf16_f32 v214, v172, v173
    v_exp_f32 v174, v174
    ds_read_b64_tr_b16 a[188:189], v13 offset:16384
    ds_read_b64_tr_b16 a[190:191], v13 offset:17408
    v_exp_f32 v175, v175
    s_nop 0
    v_cvt_pk_bf16_f32 v215, v174, v175
    s_waitcnt lgkmcnt(2)
    v_mfma_f32_16x16x32_bf16 a[0:3], a[160:163], v[192:195], a[0:3]
    v_exp_f32 v176, v176
    v_mfma_f32_16x16x32_bf16 a[16:19], a[164:167], v[192:195], a[16:19]
    v_mfma_f32_16x16x32_bf16 a[32:35], a[168:171], v[192:195], a[32:35]
    v_exp_f32 v177, v177
    v_mfma_f32_16x16x32_bf16 a[48:51], a[172:175], v[192:195], a[48:51]
    v_cvt_pk_bf16_f32 v216, v176, v177
    v_mfma_f32_16x16x32_bf16 a[64:67], a[176:179], v[192:195], a[64:67]
    v_exp_f32 v178, v178
    v_mfma_f32_16x16x32_bf16 a[80:83], a[180:183], v[192:195], a[80:83]
    v_mfma_f32_16x16x32_bf16 a[96:99], a[184:187], v[192:195], a[96:99]
    v_exp_f32 v179, v179
    s_waitcnt lgkmcnt(0)
    v_mfma_f32_16x16x32_bf16 a[112:115], a[188:191], v[192:195], a[112:115]
    v_cvt_pk_bf16_f32 v217, v178, v179
    v_mfma_f32_16x16x32_bf16 a[192:195], a[208:211], v[192:195], a[192:195]
    v_mfma_f32_16x16x32_bf16 a[4:7], a[160:163], v[196:199], a[4:7]
    v_exp_f32 v180, v180
    v_mfma_f32_16x16x32_bf16 a[20:23], a[164:167], v[196:199], a[20:23]
    v_mfma_f32_16x16x32_bf16 a[36:39], a[168:171], v[196:199], a[36:39]
    v_exp_f32 v181, v181
    v_mfma_f32_16x16x32_bf16 a[52:55], a[172:175], v[196:199], a[52:55]
    v_cvt_pk_bf16_f32 v218, v180, v181
    v_mfma_f32_16x16x32_bf16 a[68:71], a[176:179], v[196:199], a[68:71]
    v_exp_f32 v182, v182
    v_mfma_f32_16x16x32_bf16 a[84:87], a[180:183], v[196:199], a[84:87]
    v_mfma_f32_16x16x32_bf16 a[100:103], a[184:187], v[196:199], a[100:103]
    v_exp_f32 v183, v183
    v_mfma_f32_16x16x32_bf16 a[116:119], a[188:191], v[196:199], a[116:119]
    v_cvt_pk_bf16_f32 v219, v182, v183
    v_mfma_f32_16x16x32_bf16 a[196:199], a[208:211], v[196:199], a[196:199]
    v_mfma_f32_16x16x32_bf16 a[8:11], a[160:163], v[200:203], a[8:11]
    v_exp_f32 v184, v184
    v_mfma_f32_16x16x32_bf16 a[24:27], a[164:167], v[200:203], a[24:27]
    v_mfma_f32_16x16x32_bf16 a[40:43], a[168:171], v[200:203], a[40:43]
    v_exp_f32 v185, v185
    v_mfma_f32_16x16x32_bf16 a[56:59], a[172:175], v[200:203], a[56:59]
    v_cvt_pk_bf16_f32 v220, v184, v185
    v_mfma_f32_16x16x32_bf16 a[72:75], a[176:179], v[200:203], a[72:75]
    v_exp_f32 v186, v186
    v_mfma_f32_16x16x32_bf16 a[88:91], a[180:183], v[200:203], a[88:91]
    v_mfma_f32_16x16x32_bf16 a[104:107], a[184:187], v[200:203], a[104:107]
    v_exp_f32 v187, v187
    v_mfma_f32_16x16x32_bf16 a[120:123], a[188:191], v[200:203], a[120:123]
    v_cvt_pk_bf16_f32 v221, v186, v187
    v_mfma_f32_16x16x32_bf16 a[200:203], a[208:211], v[200:203], a[200:203]
    v_mfma_f32_16x16x32_bf16 a[12:15], a[160:163], v[204:207], a[12:15]
    v_exp_f32 v188, v188
    v_mfma_f32_16x16x32_bf16 a[28:31], a[164:167], v[204:207], a[28:31]
    v_mfma_f32_16x16x32_bf16 a[44:47], a[168:171], v[204:207], a[44:47]
    v_exp_f32 v189, v189
    v_mfma_f32_16x16x32_bf16 a[60:63], a[172:175], v[204:207], a[60:63]
    v_cvt_pk_bf16_f32 v222, v188, v189
    v_mfma_f32_16x16x32_bf16 a[76:79], a[176:179], v[204:207], a[76:79]
    v_exp_f32 v190, v190
    v_mfma_f32_16x16x32_bf16 a[92:95], a[180:183], v[204:207], a[92:95]
    v_mfma_f32_16x16x32_bf16 a[108:111], a[184:187], v[204:207], a[108:111]
    v_exp_f32 v191, v191
    v_mfma_f32_16x16x32_bf16 a[124:127], a[188:191], v[204:207], a[124:127]
    v_cvt_pk_bf16_f32 v223, v190, v191
    v_mfma_f32_16x16x32_bf16 a[204:207], a[208:211], v[204:207], a[204:207]
    ds_read_b64_tr_b16 a[160:161], v6 offset:24576
    ds_read_b64_tr_b16 a[162:163], v6 offset:25600
    ds_read_b64_tr_b16 a[164:165], v7 offset:24576
    ds_read_b64_tr_b16 a[166:167], v7 offset:25600
    ds_read_b64_tr_b16 a[168:169], v8 offset:24576
    ds_read_b64_tr_b16 a[170:171], v8 offset:25600
    ds_read_b64_tr_b16 a[172:173], v9 offset:24576
    ds_read_b64_tr_b16 a[174:175], v9 offset:25600
    ds_read_b64_tr_b16 a[176:177], v10 offset:24576
    ds_read_b64_tr_b16 a[178:179], v10 offset:25600
    ds_read_b64_tr_b16 a[180:181], v11 offset:24576
    ds_read_b64_tr_b16 a[182:183], v11 offset:25600
    ds_read_b64_tr_b16 a[184:185], v12 offset:24576
    ds_read_b64_tr_b16 a[186:187], v12 offset:25600
    ds_read_b64_tr_b16 a[188:189], v13 offset:24576
    ds_read_b64_tr_b16 a[190:191], v13 offset:25600
    s_waitcnt lgkmcnt(14)
    v_mfma_f32_16x16x32_bf16 a[0:3], a[160:163], v[208:211], a[0:3]
    s_waitcnt lgkmcnt(12)
    v_mfma_f32_16x16x32_bf16 a[16:19], a[164:167], v[208:211], a[16:19]
    s_waitcnt lgkmcnt(10)
    v_mfma_f32_16x16x32_bf16 a[32:35], a[168:171], v[208:211], a[32:35]
    s_waitcnt lgkmcnt(8)
    v_mfma_f32_16x16x32_bf16 a[48:51], a[172:175], v[208:211], a[48:51]
    s_waitcnt lgkmcnt(6)
    v_mfma_f32_16x16x32_bf16 a[64:67], a[176:179], v[208:211], a[64:67]
    s_waitcnt lgkmcnt(4)
    v_mfma_f32_16x16x32_bf16 a[80:83], a[180:183], v[208:211], a[80:83]
    s_waitcnt lgkmcnt(2)
    v_mfma_f32_16x16x32_bf16 a[96:99], a[184:187], v[208:211], a[96:99]
    s_waitcnt lgkmcnt(0)
    v_mfma_f32_16x16x32_bf16 a[112:115], a[188:191], v[208:211], a[112:115]
    v_mfma_f32_16x16x32_bf16 a[192:195], a[208:211], v[208:211], a[192:195]
    v_mfma_f32_16x16x32_bf16 a[4:7], a[160:163], v[212:215], a[4:7]
    v_mfma_f32_16x16x32_bf16 a[20:23], a[164:167], v[212:215], a[20:23]
    v_mfma_f32_16x16x32_bf16 a[36:39], a[168:171], v[212:215], a[36:39]
    v_mfma_f32_16x16x32_bf16 a[52:55], a[172:175], v[212:215], a[52:55]
    v_mfma_f32_16x16x32_bf16 a[68:71], a[176:179], v[212:215], a[68:71]
    v_mfma_f32_16x16x32_bf16 a[84:87], a[180:183], v[212:215], a[84:87]
    v_mfma_f32_16x16x32_bf16 a[100:103], a[184:187], v[212:215], a[100:103]
    v_mfma_f32_16x16x32_bf16 a[116:119], a[188:191], v[212:215], a[116:119]
    v_mfma_f32_16x16x32_bf16 a[196:199], a[208:211], v[212:215], a[196:199]
    v_mfma_f32_16x16x32_bf16 a[8:11], a[160:163], v[216:219], a[8:11]
    v_mfma_f32_16x16x32_bf16 a[24:27], a[164:167], v[216:219], a[24:27]
    v_mfma_f32_16x16x32_bf16 a[40:43], a[168:171], v[216:219], a[40:43]
    v_mfma_f32_16x16x32_bf16 a[56:59], a[172:175], v[216:219], a[56:59]
    v_mfma_f32_16x16x32_bf16 a[72:75], a[176:179], v[216:219], a[72:75]
    v_mfma_f32_16x16x32_bf16 a[88:91], a[180:183], v[216:219], a[88:91]
    v_mfma_f32_16x16x32_bf16 a[104:107], a[184:187], v[216:219], a[104:107]
    v_mfma_f32_16x16x32_bf16 a[120:123], a[188:191], v[216:219], a[120:123]
    v_mfma_f32_16x16x32_bf16 a[200:203], a[208:211], v[216:219], a[200:203]
    v_mfma_f32_16x16x32_bf16 a[12:15], a[160:163], v[220:223], a[12:15]
    v_mfma_f32_16x16x32_bf16 a[28:31], a[164:167], v[220:223], a[28:31]
    v_mfma_f32_16x16x32_bf16 a[44:47], a[168:171], v[220:223], a[44:47]
    v_mfma_f32_16x16x32_bf16 a[60:63], a[172:175], v[220:223], a[60:63]
    v_mfma_f32_16x16x32_bf16 a[76:79], a[176:179], v[220:223], a[76:79]
    v_mfma_f32_16x16x32_bf16 a[92:95], a[180:183], v[220:223], a[92:95]
    v_mfma_f32_16x16x32_bf16 a[108:111], a[184:187], v[220:223], a[108:111]
    v_mfma_f32_16x16x32_bf16 a[124:127], a[188:191], v[220:223], a[124:127]
    v_mfma_f32_16x16x32_bf16 a[204:207], a[208:211], v[220:223], a[204:207]
    s_nop 7
    v_accvgpr_read_b32 v48, a192
    v_accvgpr_read_b32 v49, a196
    v_accvgpr_read_b32 v50, a200
    v_accvgpr_read_b32 v51, a204
    v_mov_b32 v56, 0
    s_mov_b32 s52, 0x35800000
    s_mov_b32 s53, 0x5d800000
    v_rcp_f32 v52, v48
    v_rcp_f32 v53, v49
    v_rcp_f32 v54, v50
    v_rcp_f32 v55, v51
    v_accvgpr_read_b32 v128, a0
    v_accvgpr_read_b32 v129, a1
    v_accvgpr_read_b32 v130, a2
    v_accvgpr_read_b32 v131, a3
    v_accvgpr_read_b32 v132, a16
    v_accvgpr_read_b32 v133, a17
    v_accvgpr_read_b32 v134, a18
    v_accvgpr_read_b32 v135, a19
    v_pk_mul_f32 v[128:129], v[128:129], v[52:53] op_sel_hi:[1,0]
    v_pk_mul_f32 v[130:131], v[130:131], v[52:53] op_sel_hi:[1,0]
    v_pk_mul_f32 v[132:133], v[132:133], v[52:53] op_sel_hi:[1,0]
    v_pk_mul_f32 v[134:135], v[134:135], v[52:53] op_sel_hi:[1,0]
    v_cvt_pk_bf16_f32 v192, v128, v129
    v_cvt_pk_bf16_f32 v193, v130, v131
    v_cvt_pk_bf16_f32 v194, v132, v133
    v_cvt_pk_bf16_f32 v195, v134, v135
    buffer_store_dwordx4 v[192:195], v32, s[28:31], s61 offen offset:0 sc1
    v_accvgpr_read_b32 v136, a32
    v_accvgpr_read_b32 v137, a33
    v_accvgpr_read_b32 v138, a34
    v_accvgpr_read_b32 v139, a35
    v_accvgpr_read_b32 v140, a48
    v_accvgpr_read_b32 v141, a49
    v_accvgpr_read_b32 v142, a50
    v_accvgpr_read_b32 v143, a51
    v_pk_mul_f32 v[136:137], v[136:137], v[52:53] op_sel_hi:[1,0]
    v_pk_mul_f32 v[138:139], v[138:139], v[52:53] op_sel_hi:[1,0]
    v_pk_mul_f32 v[140:141], v[140:141], v[52:53] op_sel_hi:[1,0]
    v_pk_mul_f32 v[142:143], v[142:143], v[52:53] op_sel_hi:[1,0]
    v_cvt_pk_bf16_f32 v196, v136, v137
    v_cvt_pk_bf16_f32 v197, v138, v139
    v_cvt_pk_bf16_f32 v198, v140, v141
    v_cvt_pk_bf16_f32 v199, v142, v143
    buffer_store_dwordx4 v[196:199], v32, s[28:31], s61 offen offset:1024 sc1
    v_accvgpr_read_b32 v144, a64
    v_accvgpr_read_b32 v145, a65
    v_accvgpr_read_b32 v146, a66
    v_accvgpr_read_b32 v147, a67
    v_accvgpr_read_b32 v148, a80
    v_accvgpr_read_b32 v149, a81
    v_accvgpr_read_b32 v150, a82
    v_accvgpr_read_b32 v151, a83
    v_pk_mul_f32 v[144:145], v[144:145], v[52:53] op_sel_hi:[1,0]
    v_pk_mul_f32 v[146:147], v[146:147], v[52:53] op_sel_hi:[1,0]
    v_pk_mul_f32 v[148:149], v[148:149], v[52:53] op_sel_hi:[1,0]
    v_pk_mul_f32 v[150:151], v[150:151], v[52:53] op_sel_hi:[1,0]
    v_cvt_pk_bf16_f32 v200, v144, v145
    v_cvt_pk_bf16_f32 v201, v146, v147
    v_cvt_pk_bf16_f32 v202, v148, v149
    v_cvt_pk_bf16_f32 v203, v150, v151
    buffer_store_dwordx4 v[200:203], v32, s[28:31], s61 offen offset:2048 sc1
    v_accvgpr_read_b32 v152, a96
    v_accvgpr_read_b32 v153, a97
    v_accvgpr_read_b32 v154, a98
    v_accvgpr_read_b32 v155, a99
    v_accvgpr_read_b32 v156, a112
    v_accvgpr_read_b32 v157, a113
    v_accvgpr_read_b32 v158, a114
    v_accvgpr_read_b32 v159, a115
    v_pk_mul_f32 v[152:153], v[152:153], v[52:53] op_sel_hi:[1,0]
    v_pk_mul_f32 v[154:155], v[154:155], v[52:53] op_sel_hi:[1,0]
    v_pk_mul_f32 v[156:157], v[156:157], v[52:53] op_sel_hi:[1,0]
    v_pk_mul_f32 v[158:159], v[158:159], v[52:53] op_sel_hi:[1,0]
    v_cvt_pk_bf16_f32 v204, v152, v153
    v_cvt_pk_bf16_f32 v205, v154, v155
    v_cvt_pk_bf16_f32 v206, v156, v157
    v_cvt_pk_bf16_f32 v207, v158, v159
    buffer_store_dwordx4 v[204:207], v32, s[28:31], s61 offen offset:3072 sc1
    s_add_u32 s61, s61, 131072
    v_accvgpr_read_b32 v128, a4
    v_accvgpr_read_b32 v129, a5
    v_accvgpr_read_b32 v130, a6
    v_accvgpr_read_b32 v131, a7
    v_accvgpr_read_b32 v132, a20
    v_accvgpr_read_b32 v133, a21
    v_accvgpr_read_b32 v134, a22
    v_accvgpr_read_b32 v135, a23
    v_pk_mul_f32 v[128:129], v[128:129], v[52:53] op_sel:[0,1] op_sel_hi:[1,1]
    v_pk_mul_f32 v[130:131], v[130:131], v[52:53] op_sel:[0,1] op_sel_hi:[1,1]
    v_pk_mul_f32 v[132:133], v[132:133], v[52:53] op_sel:[0,1] op_sel_hi:[1,1]
    v_pk_mul_f32 v[134:135], v[134:135], v[52:53] op_sel:[0,1] op_sel_hi:[1,1]
    v_cvt_pk_bf16_f32 v208, v128, v129
    v_cvt_pk_bf16_f32 v209, v130, v131
    v_cvt_pk_bf16_f32 v210, v132, v133
    v_cvt_pk_bf16_f32 v211, v134, v135
    buffer_store_dwordx4 v[208:211], v32, s[28:31], s61 offen offset:0 sc1
    v_accvgpr_read_b32 v136, a36
    v_accvgpr_read_b32 v137, a37
    v_accvgpr_read_b32 v138, a38
    v_accvgpr_read_b32 v139, a39
    v_accvgpr_read_b32 v140, a52
    v_accvgpr_read_b32 v141, a53
    v_accvgpr_read_b32 v142, a54
    v_accvgpr_read_b32 v143, a55
    v_pk_mul_f32 v[136:137], v[136:137], v[52:53] op_sel:[0,1] op_sel_hi:[1,1]
    v_pk_mul_f32 v[138:139], v[138:139], v[52:53] op_sel:[0,1] op_sel_hi:[1,1]
    v_pk_mul_f32 v[140:141], v[140:141], v[52:53] op_sel:[0,1] op_sel_hi:[1,1]
    v_pk_mul_f32 v[142:143], v[142:143], v[52:53] op_sel:[0,1] op_sel_hi:[1,1]
    v_cvt_pk_bf16_f32 v212, v136, v137
    v_cvt_pk_bf16_f32 v213, v138, v139
    v_cvt_pk_bf16_f32 v214, v140, v141
    v_cvt_pk_bf16_f32 v215, v142, v143
    buffer_store_dwordx4 v[212:215], v32, s[28:31], s61 offen offset:1024 sc1
    v_accvgpr_read_b32 v144, a68
    v_accvgpr_read_b32 v145, a69
    v_accvgpr_read_b32 v146, a70
    v_accvgpr_read_b32 v147, a71
    v_accvgpr_read_b32 v148, a84
    v_accvgpr_read_b32 v149, a85
    v_accvgpr_read_b32 v150, a86
    v_accvgpr_read_b32 v151, a87
    v_pk_mul_f32 v[144:145], v[144:145], v[52:53] op_sel:[0,1] op_sel_hi:[1,1]
    v_pk_mul_f32 v[146:147], v[146:147], v[52:53] op_sel:[0,1] op_sel_hi:[1,1]
    v_pk_mul_f32 v[148:149], v[148:149], v[52:53] op_sel:[0,1] op_sel_hi:[1,1]
    v_pk_mul_f32 v[150:151], v[150:151], v[52:53] op_sel:[0,1] op_sel_hi:[1,1]
    v_cvt_pk_bf16_f32 v216, v144, v145
    v_cvt_pk_bf16_f32 v217, v146, v147
    v_cvt_pk_bf16_f32 v218, v148, v149
    v_cvt_pk_bf16_f32 v219, v150, v151
    buffer_store_dwordx4 v[216:219], v32, s[28:31], s61 offen offset:2048 sc1
    v_accvgpr_read_b32 v152, a100
    v_accvgpr_read_b32 v153, a101
    v_accvgpr_read_b32 v154, a102
    v_accvgpr_read_b32 v155, a103
    v_accvgpr_read_b32 v156, a116
    v_accvgpr_read_b32 v157, a117
    v_accvgpr_read_b32 v158, a118
    v_accvgpr_read_b32 v159, a119
    v_pk_mul_f32 v[152:153], v[152:153], v[52:53] op_sel:[0,1] op_sel_hi:[1,1]
    v_pk_mul_f32 v[154:155], v[154:155], v[52:53] op_sel:[0,1] op_sel_hi:[1,1]
    v_pk_mul_f32 v[156:157], v[156:157], v[52:53] op_sel:[0,1] op_sel_hi:[1,1]
    v_pk_mul_f32 v[158:159], v[158:159], v[52:53] op_sel:[0,1] op_sel_hi:[1,1]
    v_cvt_pk_bf16_f32 v220, v152, v153
    v_cvt_pk_bf16_f32 v221, v154, v155
    v_cvt_pk_bf16_f32 v222, v156, v157
    v_cvt_pk_bf16_f32 v223, v158, v159
    buffer_store_dwordx4 v[220:223], v32, s[28:31], s61 offen offset:3072 sc1
    s_add_u32 s61, s61, 131072
    v_accvgpr_read_b32 v128, a8
    v_accvgpr_read_b32 v129, a9
    v_accvgpr_read_b32 v130, a10
    v_accvgpr_read_b32 v131, a11
    v_accvgpr_read_b32 v132, a24
    v_accvgpr_read_b32 v133, a25
    v_accvgpr_read_b32 v134, a26
    v_accvgpr_read_b32 v135, a27
    v_pk_mul_f32 v[128:129], v[128:129], v[54:55] op_sel_hi:[1,0]
    v_pk_mul_f32 v[130:131], v[130:131], v[54:55] op_sel_hi:[1,0]
    v_pk_mul_f32 v[132:133], v[132:133], v[54:55] op_sel_hi:[1,0]
    v_pk_mul_f32 v[134:135], v[134:135], v[54:55] op_sel_hi:[1,0]
    v_cvt_pk_bf16_f32 v224, v128, v129
    v_cvt_pk_bf16_f32 v225, v130, v131
    v_cvt_pk_bf16_f32 v226, v132, v133
    v_cvt_pk_bf16_f32 v227, v134, v135
    buffer_store_dwordx4 v[224:227], v32, s[28:31], s61 offen offset:0 sc1
    v_accvgpr_read_b32 v136, a40
    v_accvgpr_read_b32 v137, a41
    v_accvgpr_read_b32 v138, a42
    v_accvgpr_read_b32 v139, a43
    v_accvgpr_read_b32 v140, a56
    v_accvgpr_read_b32 v141, a57
    v_accvgpr_read_b32 v142, a58
    v_accvgpr_read_b32 v143, a59
    v_pk_mul_f32 v[136:137], v[136:137], v[54:55] op_sel_hi:[1,0]
    v_pk_mul_f32 v[138:139], v[138:139], v[54:55] op_sel_hi:[1,0]
    v_pk_mul_f32 v[140:141], v[140:141], v[54:55] op_sel_hi:[1,0]
    v_pk_mul_f32 v[142:143], v[142:143], v[54:55] op_sel_hi:[1,0]
    v_cvt_pk_bf16_f32 v228, v136, v137
    v_cvt_pk_bf16_f32 v229, v138, v139
    v_cvt_pk_bf16_f32 v230, v140, v141
    v_cvt_pk_bf16_f32 v231, v142, v143
    buffer_store_dwordx4 v[228:231], v32, s[28:31], s61 offen offset:1024 sc1
    v_accvgpr_read_b32 v144, a72
    v_accvgpr_read_b32 v145, a73
    v_accvgpr_read_b32 v146, a74
    v_accvgpr_read_b32 v147, a75
    v_accvgpr_read_b32 v148, a88
    v_accvgpr_read_b32 v149, a89
    v_accvgpr_read_b32 v150, a90
    v_accvgpr_read_b32 v151, a91
    v_pk_mul_f32 v[144:145], v[144:145], v[54:55] op_sel_hi:[1,0]
    v_pk_mul_f32 v[146:147], v[146:147], v[54:55] op_sel_hi:[1,0]
    v_pk_mul_f32 v[148:149], v[148:149], v[54:55] op_sel_hi:[1,0]
    v_pk_mul_f32 v[150:151], v[150:151], v[54:55] op_sel_hi:[1,0]
    v_cvt_pk_bf16_f32 v232, v144, v145
    v_cvt_pk_bf16_f32 v233, v146, v147
    v_cvt_pk_bf16_f32 v234, v148, v149
    v_cvt_pk_bf16_f32 v235, v150, v151
    buffer_store_dwordx4 v[232:235], v32, s[28:31], s61 offen offset:2048 sc1
    v_accvgpr_read_b32 v152, a104
    v_accvgpr_read_b32 v153, a105
    v_accvgpr_read_b32 v154, a106
    v_accvgpr_read_b32 v155, a107
    v_accvgpr_read_b32 v156, a120
    v_accvgpr_read_b32 v157, a121
    v_accvgpr_read_b32 v158, a122
    v_accvgpr_read_b32 v159, a123
    v_pk_mul_f32 v[152:153], v[152:153], v[54:55] op_sel_hi:[1,0]
    v_pk_mul_f32 v[154:155], v[154:155], v[54:55] op_sel_hi:[1,0]
    v_pk_mul_f32 v[156:157], v[156:157], v[54:55] op_sel_hi:[1,0]
    v_pk_mul_f32 v[158:159], v[158:159], v[54:55] op_sel_hi:[1,0]
    v_cvt_pk_bf16_f32 v236, v152, v153
    v_cvt_pk_bf16_f32 v237, v154, v155
    v_cvt_pk_bf16_f32 v238, v156, v157
    v_cvt_pk_bf16_f32 v239, v158, v159
    buffer_store_dwordx4 v[236:239], v32, s[28:31], s61 offen offset:3072 sc1
    s_add_u32 s61, s61, 131072
    v_accvgpr_read_b32 v128, a12
    v_accvgpr_read_b32 v129, a13
    v_accvgpr_read_b32 v130, a14
    v_accvgpr_read_b32 v131, a15
    v_accvgpr_read_b32 v132, a28
    v_accvgpr_read_b32 v133, a29
    v_accvgpr_read_b32 v134, a30
    v_accvgpr_read_b32 v135, a31
    v_pk_mul_f32 v[128:129], v[128:129], v[54:55] op_sel:[0,1] op_sel_hi:[1,1]
    v_pk_mul_f32 v[130:131], v[130:131], v[54:55] op_sel:[0,1] op_sel_hi:[1,1]
    v_pk_mul_f32 v[132:133], v[132:133], v[54:55] op_sel:[0,1] op_sel_hi:[1,1]
    v_pk_mul_f32 v[134:135], v[134:135], v[54:55] op_sel:[0,1] op_sel_hi:[1,1]
    v_cvt_pk_bf16_f32 v240, v128, v129
    v_cvt_pk_bf16_f32 v241, v130, v131
    v_cvt_pk_bf16_f32 v242, v132, v133
    v_cvt_pk_bf16_f32 v243, v134, v135
    buffer_store_dwordx4 v[240:243], v32, s[28:31], s61 offen offset:0 sc1
    v_accvgpr_read_b32 v136, a44
    v_accvgpr_read_b32 v137, a45
    v_accvgpr_read_b32 v138, a46
    v_accvgpr_read_b32 v139, a47
    v_accvgpr_read_b32 v140, a60
    v_accvgpr_read_b32 v141, a61
    v_accvgpr_read_b32 v142, a62
    v_accvgpr_read_b32 v143, a63
    v_pk_mul_f32 v[136:137], v[136:137], v[54:55] op_sel:[0,1] op_sel_hi:[1,1]
    v_pk_mul_f32 v[138:139], v[138:139], v[54:55] op_sel:[0,1] op_sel_hi:[1,1]
    v_pk_mul_f32 v[140:141], v[140:141], v[54:55] op_sel:[0,1] op_sel_hi:[1,1]
    v_pk_mul_f32 v[142:143], v[142:143], v[54:55] op_sel:[0,1] op_sel_hi:[1,1]
    v_cvt_pk_bf16_f32 v244, v136, v137
    v_cvt_pk_bf16_f32 v245, v138, v139
    v_cvt_pk_bf16_f32 v246, v140, v141
    v_cvt_pk_bf16_f32 v247, v142, v143
    buffer_store_dwordx4 v[244:247], v32, s[28:31], s61 offen offset:1024 sc1
    v_accvgpr_read_b32 v144, a76
    v_accvgpr_read_b32 v145, a77
    v_accvgpr_read_b32 v146, a78
    v_accvgpr_read_b32 v147, a79
    v_accvgpr_read_b32 v148, a92
    v_accvgpr_read_b32 v149, a93
    v_accvgpr_read_b32 v150, a94
    v_accvgpr_read_b32 v151, a95
    v_pk_mul_f32 v[144:145], v[144:145], v[54:55] op_sel:[0,1] op_sel_hi:[1,1]
    v_pk_mul_f32 v[146:147], v[146:147], v[54:55] op_sel:[0,1] op_sel_hi:[1,1]
    v_pk_mul_f32 v[148:149], v[148:149], v[54:55] op_sel:[0,1] op_sel_hi:[1,1]
    v_pk_mul_f32 v[150:151], v[150:151], v[54:55] op_sel:[0,1] op_sel_hi:[1,1]
    v_cvt_pk_bf16_f32 v248, v144, v145
    v_cvt_pk_bf16_f32 v249, v146, v147
    v_cvt_pk_bf16_f32 v250, v148, v149
    v_cvt_pk_bf16_f32 v251, v150, v151
    buffer_store_dwordx4 v[248:251], v32, s[28:31], s61 offen offset:2048 sc1
    v_accvgpr_read_b32 v152, a108
    v_accvgpr_read_b32 v153, a109
    v_accvgpr_read_b32 v154, a110
    v_accvgpr_read_b32 v155, a111
    v_accvgpr_read_b32 v156, a124
    v_accvgpr_read_b32 v157, a125
    v_accvgpr_read_b32 v158, a126
    v_accvgpr_read_b32 v159, a127
    v_pk_mul_f32 v[152:153], v[152:153], v[54:55] op_sel:[0,1] op_sel_hi:[1,1]
    v_pk_mul_f32 v[154:155], v[154:155], v[54:55] op_sel:[0,1] op_sel_hi:[1,1]
    v_pk_mul_f32 v[156:157], v[156:157], v[54:55] op_sel:[0,1] op_sel_hi:[1,1]
    v_pk_mul_f32 v[158:159], v[158:159], v[54:55] op_sel:[0,1] op_sel_hi:[1,1]
    v_cvt_pk_bf16_f32 v252, v152, v153
    v_cvt_pk_bf16_f32 v253, v154, v155
    v_cvt_pk_bf16_f32 v254, v156, v157
    v_cvt_pk_bf16_f32 v255, v158, v159
    buffer_store_dwordx4 v[252:255], v32, s[28:31], s61 offen offset:3072 sc1
    v_mov_b32 v57, 0
    v_mov_b32 v58, 0
    v_mov_b32 v59, 0
    v_dot2_f32_bf16 v56, v192, 0, v56
    v_dot2_f32_bf16 v57, v193, 0, v57
    v_dot2_f32_bf16 v58, v194, 0, v58
    v_dot2_f32_bf16 v59, v195, 0, v59
    v_dot2_f32_bf16 v56, v196, 0, v56
    v_dot2_f32_bf16 v57, v197, 0, v57
    v_dot2_f32_bf16 v58, v198, 0, v58
    v_dot2_f32_bf16 v59, v199, 0, v59
    v_dot2_f32_bf16 v56, v200, 0, v56
    v_dot2_f32_bf16 v57, v201, 0, v57
    v_dot2_f32_bf16 v58, v202, 0, v58
    v_dot2_f32_bf16 v59, v203, 0, v59
    v_dot2_f32_bf16 v56, v204, 0, v56
    v_dot2_f32_bf16 v57, v205, 0, v57
    v_dot2_f32_bf16 v58, v206, 0, v58
    v_dot2_f32_bf16 v59, v207, 0, v59
    v_dot2_f32_bf16 v56, v208, 0, v56
    v_dot2_f32_bf16 v57, v209, 0, v57
    v_dot2_f32_bf16 v58, v210, 0, v58
    v_dot2_f32_bf16 v59, v211, 0, v59
    v_dot2_f32_bf16 v56, v212, 0, v56
    v_dot2_f32_bf16 v57, v213, 0, v57
    v_dot2_f32_bf16 v58, v214, 0, v58
    v_dot2_f32_bf16 v59, v215, 0, v59
    v_dot2_f32_bf16 v56, v216, 0, v56
    v_dot2_f32_bf16 v57, v217, 0, v57
    v_dot2_f32_bf16 v58, v218, 0, v58
    v_dot2_f32_bf16 v59, v219, 0, v59
    v_dot2_f32_bf16 v56, v220, 0, v56
    v_dot2_f32_bf16 v57, v221, 0, v57
    v_dot2_f32_bf16 v58, v222, 0, v58
    v_dot2_f32_bf16 v59, v223, 0, v59
    v_dot2_f32_bf16 v56, v224, 0, v56
    v_dot2_f32_bf16 v57, v225, 0, v57
    v_dot2_f32_bf16 v58, v226, 0, v58
    v_dot2_f32_bf16 v59, v227, 0, v59
    v_dot2_f32_bf16 v56, v228, 0, v56
    v_dot2_f32_bf16 v57, v229, 0, v57
    v_dot2_f32_bf16 v58, v230, 0, v58
    v_dot2_f32_bf16 v59, v231, 0, v59
    v_dot2_f32_bf16 v56, v232, 0, v56
    v_dot2_f32_bf16 v57, v233, 0, v57
    v_dot2_f32_bf16 v58, v234, 0, v58
    v_dot2_f32_bf16 v59, v235, 0, v59
    v_dot2_f32_bf16 v56, v236, 0, v56
    v_dot2_f32_bf16 v57, v237, 0, v57
    v_dot2_f32_bf16 v58, v238, 0, v58
    v_dot2_f32_bf16 v59, v239, 0, v59
    v_dot2_f32_bf16 v56, v240, 0, v56
    v_dot2_f32_bf16 v57, v241, 0, v57
    v_dot2_f32_bf16 v58, v242, 0, v58
    v_dot2_f32_bf16 v59, v243, 0, v59
    v_dot2_f32_bf16 v56, v244, 0, v56
    v_dot2_f32_bf16 v57, v245, 0, v57
    v_dot2_f32_bf16 v58, v246, 0, v58
    v_dot2_f32_bf16 v59, v247, 0, v59
    v_dot2_f32_bf16 v56, v248, 0, v56
    v_dot2_f32_bf16 v57, v249, 0, v57
    v_dot2_f32_bf16 v58, v250, 0, v58
    v_dot2_f32_bf16 v59, v251, 0, v59
    v_dot2_f32_bf16 v56, v252, 0, v56
    v_dot2_f32_bf16 v57, v253, 0, v57
    v_dot2_f32_bf16 v58, v254, 0, v58
    v_dot2_f32_bf16 v59, v255, 0, v59
    v_add_f32 v56, v56, v57
    v_add_f32 v58, v58, v59
    v_add_f32 v56, v56, v58
    s_sub_u32 s61, s61, 393216
    s_cmp_lg_u32 s49, 0
    s_cbranch_scc1 attn_kernel_drain
    v_cmp_u_f32 vcc, v56, v56
    s_mov_b64 s[54:55], vcc
    v_cmp_nlt_f32 vcc, s52, v48
    s_or_b64 s[54:55], s[54:55], vcc
    v_cmp_ngt_f32 vcc, s53, v48
    s_or_b64 s[54:55], s[54:55], vcc
    v_cmp_nlt_f32 vcc, s52, v49
    s_or_b64 s[54:55], s[54:55], vcc
    v_cmp_ngt_f32 vcc, s53, v49
    s_or_b64 s[54:55], s[54:55], vcc
    v_cmp_nlt_f32 vcc, s52, v50
    s_or_b64 s[54:55], s[54:55], vcc
    v_cmp_ngt_f32 vcc, s53, v50
    s_or_b64 s[54:55], s[54:55], vcc
    v_cmp_nlt_f32 vcc, s52, v51
    s_or_b64 s[54:55], s[54:55], vcc
    v_cmp_ngt_f32 vcc, s53, v51
    s_or_b64 s[54:55], s[54:55], vcc
    s_cmp_lg_u64 s[54:55], 0
    s_cselect_b32 s52, 1, 0
    v_mov_b32 v58, s52
    s_lshl_b32 s53, s42, 2
    s_add_u32 s53, s53, 131072
    v_mov_b32 v59, s53
    ds_write_b32 v59, v58
    v_mov_b32 v59, 131072
    s_waitcnt vmcnt(0) lgkmcnt(0)
    s_barrier
    ds_read_b128 v[60:63], v59
    s_waitcnt lgkmcnt(0)
    v_or_b32 v60, v60, v61
    v_or3_b32 v60, v60, v62, v63
    s_nop 0
    v_readfirstlane_b32 s52, v60
    s_cmp_eq_u32 s52, 0
    s_cbranch_scc1 attn_kernel_pub
    s_waitcnt vmcnt(0)
    v_mov_b32 v48, 0xff7fffff
    v_mov_b32 v49, 0xff7fffff
    v_mov_b32 v50, 0xff7fffff
    v_mov_b32 v51, 0xff7fffff
    s_mov_b32 s46, 0
    s_mov_b32 s48, 32
attn_kernel_mx:
    s_barrier
    s_add_u32 m0, s43, 0
    s_nop 0
    buffer_load_dwordx4 v22, s[4:7], s46 offen offset:0 lds
    buffer_load_dwordx4 v22, s[4:7], s46 offen offset:1024 lds
    buffer_load_dwordx4 v23, s[4:7], s46 offen offset:2048 lds
    buffer_load_dwordx4 v23, s[4:7], s46 offen offset:3072 lds
    s_add_u32 s46, s46, 16384
    s_waitcnt vmcnt(0)
    s_barrier
    ds_read_b128 a[128:131], v2 offset:0
    ds_read_b128 a[144:147], v2 offset:1024
    ds_read_b128 a[132:135], v3 offset:0
    ds_read_b128 a[148:151], v3 offset:1024
    ds_read_b128 a[136:139], v4 offset:0
    ds_read_b128 a[152:155], v4 offset:1024
    ds_read_b128 a[140:143], v5 offset:0
    ds_read_b128 a[156:159], v5 offset:1024
    s_waitcnt lgkmcnt(0)
    v_mfma_f32_16x16x32_bf16 v[128:131], a[128:131], v[64:67], 0
    v_mfma_f32_16x16x32_bf16 v[132:135], a[144:147], v[64:67], 0
    v_mfma_f32_16x16x32_bf16 v[136:139], a[128:131], v[80:83], 0
    v_mfma_f32_16x16x32_bf16 v[140:143], a[144:147], v[80:83], 0
    v_mfma_f32_16x16x32_bf16 v[144:147], a[128:131], v[96:99], 0
    v_mfma_f32_16x16x32_bf16 v[148:151], a[144:147], v[96:99], 0
    v_mfma_f32_16x16x32_bf16 v[152:155], a[128:131], v[112:115], 0
    v_mfma_f32_16x16x32_bf16 v[156:159], a[144:147], v[112:115], 0
    v_mfma_f32_16x16x32_bf16 v[128:131], a[132:135], v[68:71], v[128:131]
    v_mfma_f32_16x16x32_bf16 v[132:135], a[148:151], v[68:71], v[132:135]
    v_mfma_f32_16x16x32_bf16 v[136:139], a[132:135], v[84:87], v[136:139]
    v_mfma_f32_16x16x32_bf16 v[140:143], a[148:151], v[84:87], v[140:143]
    v_mfma_f32_16x16x32_bf16 v[144:147], a[132:135], v[100:103], v[144:147]
    v_mfma_f32_16x16x32_bf16 v[148:151], a[148:151], v[100:103], v[148:151]
    v_mfma_f32_16x16x32_bf16 v[152:155], a[132:135], v[116:119], v[152:155]
    v_mfma_f32_16x16x32_bf16 v[156:159], a[148:151], v[116:119], v[156:159]
    v_mfma_f32_16x16x32_bf16 v[128:131], a[136:139], v[72:75], v[128:131]
    v_mfma_f32_16x16x32_bf16 v[132:135], a[152:155], v[72:75], v[132:135]
    v_mfma_f32_16x16x32_bf16 v[136:139], a[136:139], v[88:91], v[136:139]
    v_mfma_f32_16x16x32_bf16 v[140:143], a[152:155], v[88:91], v[140:143]
    v_mfma_f32_16x16x32_bf16 v[144:147], a[136:139], v[104:107], v[144:147]
    v_mfma_f32_16x16x32_bf16 v[148:151], a[152:155], v[104:107], v[148:151]
    v_mfma_f32_16x16x32_bf16 v[152:155], a[136:139], v[120:123], v[152:155]
    v_mfma_f32_16x16x32_bf16 v[156:159], a[152:155], v[120:123], v[156:159]
    v_mfma_f32_16x16x32_bf16 v[128:131], a[140:143], v[76:79], v[128:131]
    v_mfma_f32_16x16x32_bf16 v[132:135], a[156:159], v[76:79], v[132:135]
    v_mfma_f32_16x16x32_bf16 v[136:139], a[140:143], v[92:95], v[136:139]
    v_mfma_f32_16x16x32_bf16 v[140:143], a[156:159], v[92:95], v[140:143]
    v_mfma_f32_16x16x32_bf16 v[144:147], a[140:143], v[108:111], v[144:147]
    v_mfma_f32_16x16x32_bf16 v[148:151], a[156:159], v[108:111], v[148:151]
    v_mfma_f32_16x16x32_bf16 v[152:155], a[140:143], v[124:127], v[152:155]
    v_mfma_f32_16x16x32_bf16 v[156:159], a[156:159], v[124:127], v[156:159]
    s_nop 7
    s_nop 7
    v_max3_f32 v48, v128, v129, v48
    v_max3_f32 v48, v130, v131, v48
    v_max3_f32 v48, v132, v133, v48
    v_max3_f32 v48, v134, v135, v48
    v_max3_f32 v49, v136, v137, v49
    v_max3_f32 v49, v138, v139, v49
    v_max3_f32 v49, v140, v141, v49
    v_max3_f32 v49, v142, v143, v49
    v_max3_f32 v50, v144, v145, v50
    v_max3_f32 v50, v146, v147, v50
    v_max3_f32 v50, v148, v149, v50
    v_max3_f32 v50, v150, v151, v50
    v_max3_f32 v51, v152, v153, v51
    v_max3_f32 v51, v154, v155, v51
    v_max3_f32 v51, v156, v157, v51
    v_max3_f32 v51, v158, v159, v51
    ds_read_b128 a[128:131], v2 offset:8192
    ds_read_b128 a[144:147], v2 offset:9216
    ds_read_b128 a[132:135], v3 offset:8192
    ds_read_b128 a[148:151], v3 offset:9216
    ds_read_b128 a[136:139], v4 offset:8192
    ds_read_b128 a[152:155], v4 offset:9216
    ds_read_b128 a[140:143], v5 offset:8192
    ds_read_b128 a[156:159], v5 offset:9216
    s_waitcnt lgkmcnt(0)
    v_mfma_f32_16x16x32_bf16 v[128:131], a[128:131], v[64:67], 0
    v_mfma_f32_16x16x32_bf16 v[132:135], a[144:147], v[64:67], 0
    v_mfma_f32_16x16x32_bf16 v[136:139], a[128:131], v[80:83], 0
    v_mfma_f32_16x16x32_bf16 v[140:143], a[144:147], v[80:83], 0
    v_mfma_f32_16x16x32_bf16 v[144:147], a[128:131], v[96:99], 0
    v_mfma_f32_16x16x32_bf16 v[148:151], a[144:147], v[96:99], 0
    v_mfma_f32_16x16x32_bf16 v[152:155], a[128:131], v[112:115], 0
    v_mfma_f32_16x16x32_bf16 v[156:159], a[144:147], v[112:115], 0
    v_mfma_f32_16x16x32_bf16 v[128:131], a[132:135], v[68:71], v[128:131]
    v_mfma_f32_16x16x32_bf16 v[132:135], a[148:151], v[68:71], v[132:135]
    v_mfma_f32_16x16x32_bf16 v[136:139], a[132:135], v[84:87], v[136:139]
    v_mfma_f32_16x16x32_bf16 v[140:143], a[148:151], v[84:87], v[140:143]
    v_mfma_f32_16x16x32_bf16 v[144:147], a[132:135], v[100:103], v[144:147]
    v_mfma_f32_16x16x32_bf16 v[148:151], a[148:151], v[100:103], v[148:151]
    v_mfma_f32_16x16x32_bf16 v[152:155], a[132:135], v[116:119], v[152:155]
    v_mfma_f32_16x16x32_bf16 v[156:159], a[148:151], v[116:119], v[156:159]
    v_mfma_f32_16x16x32_bf16 v[128:131], a[136:139], v[72:75], v[128:131]
    v_mfma_f32_16x16x32_bf16 v[132:135], a[152:155], v[72:75], v[132:135]
    v_mfma_f32_16x16x32_bf16 v[136:139], a[136:139], v[88:91], v[136:139]
    v_mfma_f32_16x16x32_bf16 v[140:143], a[152:155], v[88:91], v[140:143]
    v_mfma_f32_16x16x32_bf16 v[144:147], a[136:139], v[104:107], v[144:147]
    v_mfma_f32_16x16x32_bf16 v[148:151], a[152:155], v[104:107], v[148:151]
    v_mfma_f32_16x16x32_bf16 v[152:155], a[136:139], v[120:123], v[152:155]
    v_mfma_f32_16x16x32_bf16 v[156:159], a[152:155], v[120:123], v[156:159]
    v_mfma_f32_16x16x32_bf16 v[128:131], a[140:143], v[76:79], v[128:131]
    v_mfma_f32_16x16x32_bf16 v[132:135], a[156:159], v[76:79], v[132:135]
    v_mfma_f32_16x16x32_bf16 v[136:139], a[140:143], v[92:95], v[136:139]
    v_mfma_f32_16x16x32_bf16 v[140:143], a[156:159], v[92:95], v[140:143]
    v_mfma_f32_16x16x32_bf16 v[144:147], a[140:143], v[108:111], v[144:147]
    v_mfma_f32_16x16x32_bf16 v[148:151], a[156:159], v[108:111], v[148:151]
    v_mfma_f32_16x16x32_bf16 v[152:155], a[140:143], v[124:127], v[152:155]
    v_mfma_f32_16x16x32_bf16 v[156:159], a[156:159], v[124:127], v[156:159]
    s_nop 7
    s_nop 7
    v_max3_f32 v48, v128, v129, v48
    v_max3_f32 v48, v130, v131, v48
    v_max3_f32 v48, v132, v133, v48
    v_max3_f32 v48, v134, v135, v48
    v_max3_f32 v49, v136, v137, v49
    v_max3_f32 v49, v138, v139, v49
    v_max3_f32 v49, v140, v141, v49
    v_max3_f32 v49, v142, v143, v49
    v_max3_f32 v50, v144, v145, v50
    v_max3_f32 v50, v146, v147, v50
    v_max3_f32 v50, v148, v149, v50
    v_max3_f32 v50, v150, v151, v50
    v_max3_f32 v51, v152, v153, v51
    v_max3_f32 v51, v154, v155, v51
    v_max3_f32 v51, v156, v157, v51
    v_max3_f32 v51, v158, v159, v51
    s_sub_u32 s48, s48, 1
    s_cmp_lg_u32 s48, 0
    s_cbranch_scc1 attn_kernel_mx
    v_mov_b32 v52, v48
    v_mov_b32 v53, v49
    v_mov_b32 v54, v50
    v_mov_b32 v55, v51
    s_nop 1
    v_permlane16_swap_b32 v52, v48
    v_permlane16_swap_b32 v53, v49
    v_permlane16_swap_b32 v54, v50
    v_permlane16_swap_b32 v55, v51
    s_nop 1
    v_max_f32 v48, v48, v52
    v_max_f32 v49, v49, v53
    v_max_f32 v50, v50, v54
    v_max_f32 v51, v51, v55
    v_mov_b32 v52, v48
    v_mov_b32 v53, v49
    v_mov_b32 v54, v50
    v_mov_b32 v55, v51
    s_nop 1
    v_permlane32_swap_b32 v52, v48
    v_permlane32_swap_b32 v53, v49
    v_permlane32_swap_b32 v54, v50
    v_permlane32_swap_b32 v55, v51
    s_nop 1
    v_max_f32 v48, v48, v52
    v_max_f32 v49, v49, v53
    v_max_f32 v50, v50, v54
    v_max_f32 v51, v51, v55
    v_sub_f32 v224, 0, v48
    v_sub_f32 v225, 0, v48
    v_sub_f32 v226, 0, v48
    v_sub_f32 v227, 0, v48
    v_sub_f32 v228, 0, v49
    v_sub_f32 v229, 0, v49
    v_sub_f32 v230, 0, v49
    v_sub_f32 v231, 0, v49
    v_sub_f32 v232, 0, v50
    v_sub_f32 v233, 0, v50
    v_sub_f32 v234, 0, v50
    v_sub_f32 v235, 0, v50
    v_sub_f32 v236, 0, v51
    v_sub_f32 v237, 0, v51
    v_sub_f32 v238, 0, v51
    v_sub_f32 v239, 0, v51
    s_mov_b32 s46, 0
    s_mov_b32 s47, 0
    s_mov_b32 s49, 1
    s_barrier
    s_add_u32 m0, s43, 0
    s_nop 0
    buffer_load_dwordx4 v22, s[4:7], s46 offen offset:0 lds
    buffer_load_dwordx4 v22, s[4:7], s46 offen offset:1024 lds
    buffer_load_dwordx4 v23, s[4:7], s46 offen offset:2048 lds
    buffer_load_dwordx4 v23, s[4:7], s46 offen offset:3072 lds
    s_add_u32 s46, s46, 16384
    s_add_u32 m0, s43, 16384
    s_nop 0
    buffer_load_dwordx4 v22, s[4:7], s46 offen offset:0 lds
    buffer_load_dwordx4 v22, s[4:7], s46 offen offset:1024 lds
    buffer_load_dwordx4 v23, s[4:7], s46 offen offset:2048 lds
    buffer_load_dwordx4 v23, s[4:7], s46 offen offset:3072 lds
    s_add_u32 s46, s46, 16384
    s_add_u32 m0, s43, 32768
    s_nop 0
    buffer_load_dwordx4 v22, s[4:7], s46 offen offset:0 lds
    buffer_load_dwordx4 v22, s[4:7], s46 offen offset:1024 lds
    buffer_load_dwordx4 v23, s[4:7], s46 offen offset:2048 lds
    buffer_load_dwordx4 v23, s[4:7], s46 offen offset:3072 lds
    s_add_u32 s46, s46, 16384
    s_add_u32 m0, s51, 32768
    s_nop 0
    buffer_load_dwordx4 v24, s[8:11], s47 offen offset:0 lds
    buffer_load_dwordx4 v24, s[8:11], s47 offen offset:1024 lds
    buffer_load_dwordx4 v25, s[8:11], s47 offen offset:2048 lds
    buffer_load_dwordx4 v25, s[8:11], s47 offen offset:3072 lds
    s_add_u32 s47, s47, 16384
    s_add_u32 m0, s51, 49152
    s_nop 0
    buffer_load_dwordx4 v24, s[8:11], s47 offen offset:0 lds
    buffer_load_dwordx4 v24, s[8:11], s47 offen offset:1024 lds
    buffer_load_dwordx4 v25, s[8:11], s47 offen offset:2048 lds
    buffer_load_dwordx4 v25, s[8:11], s47 offen offset:3072 lds
    s_add_u32 s47, s47, 16384
    s_waitcnt vmcnt(0)
    s_branch attn_kernel_att
attn_kernel_drain:
    s_waitcnt vmcnt(0)
    s_barrier
attn_kernel_pub:
    s_cmp_lg_u32 s42, 0
    s_cbranch_scc1 attn_kernel_nfl
    s_add_u32 s36, s20, 0x298000
    s_addc_u32 s37, s21, 0
    s_and_b32 s37, s37, 0xffff
    s_mov_b32 s38, 0x8000
    s_mov_b32 s39, 0x20000
    s_lshl_b32 s52, s41, 5
    s_add_u32 s52, s52, s40
    s_lshl_b32 s52, s52, 7
    v_mov_b32 v48, s3
    s_mov_b64 exec, 1
    buffer_store_dword v48, off, s[36:39], s52 sc1
    s_mov_b64 exec, -1
attn_kernel_nfl:
    s_cmp_eq_u32 s2, 255
    s_cbranch_scc1 attn_kernel_epoch
    s_cmp_ge_u32 s2, 240
    s_cbranch_scc1 attn_kernel_end
    s_load_dwordx2 s[56:57], s[0:1], 0
    s_load_dwordx2 s[58:59], s[0:1], 32
    s_load_dwordx4 s[60:63], s[0:1], 64
    s_load_dwordx2 s[64:65], s[0:1], 80
    s_load_dwordx2 s[66:67], s[0:1], 96
    s_and_b32 s48, s2, 7
    s_mul_i32 s48, s48, 30
    s_lshr_b32 s49, s2, 3
    s_add_u32 s48, s48, s49
    s_mul_i32 s33, s48, 205
    s_lshr_b32 s33, s33, 14
    s_mul_i32 s49, s33, 80
    s_sub_u32 s34, s48, s49
    s_mul_i32 s35, s34, 205
    s_lshr_b32 s35, s35, 10
    s_mul_i32 s49, s35, 5
    s_sub_u32 s36, s34, s49
    v_lshrrev_b32 v16, 6, v0
    v_and_b32 v1, 63, v0
    v_readfirstlane_b32 s32, v16
    v_lshlrev_b32 v2, 4, v1
    v_lshrrev_b32 v16, 4, v1
    v_and_b32 v17, 15, v1
    s_lshl_b32 s48, s32, 4
    v_add_u32 v18, s48, v16
    s_movk_i32 s49, 1280
    v_mul_lo_u32 v18, v18, s49
    v_or_b32 v19, 0, v16
    v_lshlrev_b32 v19, 1, v19
    v_xor_b32 v19, v19, v17
    v_lshl_add_u32 v19, v19, 4, v18
    v_add_u32 v4, 0, v19
    v_or_b32 v19, 4, v16
    v_lshlrev_b32 v19, 1, v19
    v_xor_b32 v19, v19, v17
    v_lshl_add_u32 v19, v19, 4, v18
    v_add_u32 v5, 4096, v19
    v_or_b32 v19, 0, v16
    v_lshlrev_b32 v19, 1, v19
    v_xor_b32 v19, v19, v17
    v_lshl_add_u32 v19, v19, 4, v18
    v_add_u32 v6, 8192, v19
    v_or_b32 v19, 4, v16
    v_lshlrev_b32 v19, 1, v19
    v_xor_b32 v19, v19, v17
    v_lshl_add_u32 v19, v19, 4, v18
    v_add_u32 v7, 12288, v19
    v_lshrrev_b32 v18, 2, v1
    v_and_b32 v19, 7, v18
    v_lshlrev_b32 v18, 8, v18
    v_and_b32 v20, 3, v1
    v_lshl_add_u32 v18, v20, 3, v18
    v_xor_b32 v20, 0, v19
    v_lshl_add_u32 v8, v20, 5, v18
    v_xor_b32 v20, 1, v19
    v_lshl_add_u32 v9, v20, 5, v18
    v_xor_b32 v20, 2, v19
    v_lshl_add_u32 v10, v20, 5, v18
    v_xor_b32 v20, 3, v19
    v_lshl_add_u32 v11, v20, 5, v18
    v_xor_b32 v20, 4, v19
    v_lshl_add_u32 v12, v20, 5, v18
    v_xor_b32 v20, 5, v19
    v_lshl_add_u32 v13, v20, 5, v18
    v_xor_b32 v20, 6, v19
    v_lshl_add_u32 v14, v20, 5, v18
    v_xor_b32 v20, 7, v19
    v_lshl_add_u32 v15, v20, 5, v18
    s_lshl_b32 s38, s32, 12
    s_lshl_b32 s48, s35, 7
    s_lshl_b32 s50, s32, 5
    s_add_u32 s48, s48, s50
    s_lshl_b32 s50, s33, 4
    s_add_u32 s48, s48, s50
    v_add_u32 v18, s48, v17
    v_mul_lo_u32 v18, v18, s49
    s_lshl_b32 s51, s36, 8
    v_lshlrev_b32 v19, 3, v16
    v_add_u32 v19, s51, v19
    v_add_u32 v3, v18, v19
    s_lshl_b32 s48, s34, 16
    s_lshl_b32 s49, s32, 13
    s_add_u32 s48, s48, s49
    s_and_b32 s50, s33, 1
    s_lshl_b32 s49, s50, 15
    s_add_u32 s42, s48, s49
    s_xor_b32 s49, s49, 0x8000
    s_add_u32 s43, s48, s49
    s_lshl_b32 s48, s34, 15
    s_lshl_b32 s49, s32, 12
    s_add_u32 s48, s48, s49
    s_lshl_b32 s49, s50, 14
    s_add_u32 s44, s48, s49
    s_mul_i32 s48, s34, 384
    s_lshl_b32 s49, s33, 7
    s_add_u32 s45, s48, s49
    s_lshl_b32 s49, s50, 7
    s_xor_b32 s49, s49, 128
    s_add_u32 s46, s48, s49
    s_add_u32 s47, s48, 256
    s_lshl_b32 s48, s35, 3
    s_lshl_b32 s49, s32, 1
    s_add_u32 s48, s48, s49
    s_waitcnt lgkmcnt(0)
    s_mov_b32 s12, s56
    s_and_b32 s13, s57, 0xffff
    s_mov_b32 s14, 0x280000
    s_mov_b32 s15, 0x20000
    s_mov_b32 s16, s64
    s_and_b32 s17, s65, 0xffff
    s_mov_b32 s18, 0x280000
    s_mov_b32 s19, 0x20000
    s_add_u32 s20, s66, 0x1a00000
    s_addc_u32 s21, s67, 0
    s_and_b32 s21, s21, 0xffff
    s_mov_b32 s22, 0x500000
    s_mov_b32 s23, 0x20000
    s_add_u32 s24, s66, 0x2200000
    s_addc_u32 s25, s67, 0
    s_and_b32 s25, s25, 0xffff
    s_mov_b32 s26, 0x280000
    s_mov_b32 s27, 0x20000
    s_add_u32 s28, s66, 0x290000
    s_addc_u32 s29, s67, 0
    s_and_b32 s29, s29, 0xffff
    s_mov_b32 s30, 0x10000
    s_mov_b32 s31, 0x20000
    s_lshr_b32 s52, s35, 1
    s_lshl_b32 s52, s52, 5
    s_and_b32 s53, s33, 1
    s_lshl_b32 s53, s53, 4
    s_add_u32 s52, s52, s53
    s_add_u32 s52, s52, 256
    s_cmp_eq_u32 s33, 2
    s_cselect_b32 s53, 26, 15
    v_min_u32 v31, s53, v1
    v_add_u32 v31, s52, v31
    v_lshlrev_b32 v31, 7, v31
    s_cmp_lg_u32 s32, 0
    s_cbranch_scc1 attn_kernel_o_nopoll
    buffer_load_dword v30, v31, s[28:31], 0 offen sc1
attn_kernel_o_nopoll:
    s_cmp_eq_u32 s33, 2
    s_cbranch_scc1 attn_kernel_o_hpro
    s_mov_b32 s4, s58
    s_and_b32 s5, s59, 0xffff
    s_mov_b32 s6, 0x500000
    s_mov_b32 s7, 0x20000
    s_add_u32 s8, s66, 0xa00000
    s_addc_u32 s9, s67, 0
    s_and_b32 s9, s9, 0xffff
    s_mov_b32 s10, 0x1000000
    s_mov_b32 s11, 0x20000
    s_mul_i32 s37, s33, 2621440
    s_add_u32 s37, s37, s51
    s_add_u32 s40, s48, s33
    s_lshl_b32 s40, s40, 17
    s_xor_b32 s41, s40, 131072
    s_lshl_b32 s49, s33, 16
    s_add_u32 s40, s40, s49
    s_add_u32 s41, s41, s49
    s_mov_b32 s39, 7
    buffer_load_dwordx2 v[48:49], v3, s[12:15], 0 offen offset:0
    buffer_load_dwordx2 v[50:51], v3, s[12:15], 0 offen offset:32
    buffer_load_dwordx2 v[52:53], v3, s[12:15], 0 offen offset:64
    buffer_load_dwordx2 v[54:55], v3, s[12:15], 0 offen offset:96
    buffer_load_dwordx2 v[56:57], v3, s[12:15], 0 offen offset:128
    buffer_load_dwordx2 v[58:59], v3, s[12:15], 0 offen offset:160
    buffer_load_dwordx2 v[60:61], v3, s[12:15], 0 offen offset:192
    buffer_load_dwordx2 v[62:63], v3, s[12:15], 0 offen offset:224
    s_add_u32 m0, s38, 0
    s_nop 0
    buffer_load_dwordx4 v4, s[4:7], s37 offen offset:0 lds
    buffer_load_dwordx4 v5, s[4:7], s37 offen offset:1024 lds
    buffer_load_dwordx4 v6, s[4:7], s37 offen offset:2048 lds
    buffer_load_dwordx4 v7, s[4:7], s37 offen offset:3072 lds
    s_add_u32 s37, s37, 81920
    s_add_u32 m0, s38, 16384
    s_nop 0
    buffer_load_dwordx4 v4, s[4:7], s37 offen offset:0 lds
    buffer_load_dwordx4 v5, s[4:7], s37 offen offset:1024 lds
    buffer_load_dwordx4 v6, s[4:7], s37 offen offset:2048 lds
    buffer_load_dwordx4 v7, s[4:7], s37 offen offset:3072 lds
    s_add_u32 s37, s37, 81920
    s_add_u32 m0, s38, 32768
    s_nop 0
    buffer_load_dwordx4 v4, s[4:7], s37 offen offset:0 lds
    buffer_load_dwordx4 v5, s[4:7], s37 offen offset:1024 lds
    buffer_load_dwordx4 v6, s[4:7], s37 offen offset:2048 lds
    buffer_load_dwordx4 v7, s[4:7], s37 offen offset:3072 lds
    s_add_u32 s37, s37, 81920
    s_add_u32 m0, s38, 49152
    s_nop 0
    buffer_load_dwordx4 v4, s[4:7], s37 offen offset:0 lds
    buffer_load_dwordx4 v5, s[4:7], s37 offen offset:1024 lds
    buffer_load_dwordx4 v6, s[4:7], s37 offen offset:2048 lds
    buffer_load_dwordx4 v7, s[4:7], s37 offen offset:3072 lds
    s_add_u32 s37, s37, 81920
    v_mov_b32 v64, 0
    v_mov_b32 v65, 0
    v_mov_b32 v66, 0
    v_mov_b32 v67, 0
    v_mov_b32 v68, 0
    v_mov_b32 v69, 0
    v_mov_b32 v70, 0
    v_mov_b32 v71, 0
    v_mov_b32 v72, 0
    v_mov_b32 v73, 0
    v_mov_b32 v74, 0
    v_mov_b32 v75, 0
    v_mov_b32 v76, 0
    v_mov_b32 v77, 0
    v_mov_b32 v78, 0
    v_mov_b32 v79, 0
    v_mov_b32 v80, 0
    v_mov_b32 v81, 0
    v_mov_b32 v82, 0
    v_mov_b32 v83, 0
    v_mov_b32 v84, 0
    v_mov_b32 v85, 0
    v_mov_b32 v86, 0
    v_mov_b32 v87, 0
    v_mov_b32 v88, 0
    v_mov_b32 v89, 0
    v_mov_b32 v90, 0
    v_mov_b32 v91, 0
    v_mov_b32 v92, 0
    v_mov_b32 v93, 0
    v_mov_b32 v94, 0
    v_mov_b32 v95, 0
    v_mov_b32 v96, 0
    v_mov_b32 v97, 0
    v_mov_b32 v98, 0
    v_mov_b32 v99, 0
    v_mov_b32 v100, 0
    v_mov_b32 v101, 0
    v_mov_b32 v102, 0
    v_mov_b32 v103, 0
    v_mov_b32 v104, 0
    v_mov_b32 v105, 0
    v_mov_b32 v106, 0
    v_mov_b32 v107, 0
    v_mov_b32 v108, 0
    v_mov_b32 v109, 0
    v_mov_b32 v110, 0
    v_mov_b32 v111, 0
    v_mov_b32 v112, 0
    v_mov_b32 v113, 0
    v_mov_b32 v114, 0
    v_mov_b32 v115, 0
    v_mov_b32 v116, 0
    v_mov_b32 v117, 0
    v_mov_b32 v118, 0
    v_mov_b32 v119, 0
    v_mov_b32 v120, 0
    v_mov_b32 v121, 0
    v_mov_b32 v122, 0
    v_mov_b32 v123, 0
    v_mov_b32 v124, 0
    v_mov_b32 v125, 0
    v_mov_b32 v126, 0
    v_mov_b32 v127, 0
    s_cmp_lg_u32 s32, 0
    s_cbranch_scc1 attn_kernel_o_rdy0
    s_mov_b32 s70, 0x4000
    s_waitcnt vmcnt(24)
attn_kernel_o_chk0:
    v_cmp_ne_u32 vcc, s3, v30
    s_nop 1
    s_cmp_eq_u64 vcc, 0
    s_cbranch_scc1 attn_kernel_o_rdy0
    buffer_load_dword v30, v31, s[28:31], 0 offen sc1
    s_sub_u32 s70, s70, 1
    s_cmp_lg_u32 s70, 0
    s_waitcnt vmcnt(0)
    s_cbranch_scc1 attn_kernel_o_chk0
attn_kernel_o_rdy0:
    s_barrier
    buffer_load_dwordx4 a[64:67], v2, s[8:11], s40 offen offset:0 sc1
    buffer_load_dwordx4 a[68:71], v2, s[8:11], s41 offen offset:0 sc1
    buffer_load_dwordx4 a[72:75], v2, s[8:11], s40 offen offset:1024 sc1
    buffer_load_dwordx4 a[76:79], v2, s[8:11], s41 offen offset:1024 sc1
    s_add_u32 s40, s40, 2048
    s_add_u32 s41, s41, 2048
    buffer_load_dwordx4 a[80:83], v2, s[8:11], s40 offen offset:0 sc1
    buffer_load_dwordx4 a[84:87], v2, s[8:11], s41 offen offset:0 sc1
    buffer_load_dwordx4 a[88:91], v2, s[8:11], s40 offen offset:1024 sc1
    buffer_load_dwordx4 a[92:95], v2, s[8:11], s41 offen offset:1024 sc1
    s_add_u32 s40, s40, 2048
    s_add_u32 s41, s41, 2048
    buffer_load_dwordx4 a[96:99], v2, s[8:11], s40 offen offset:0 sc1
    buffer_load_dwordx4 a[100:103], v2, s[8:11], s41 offen offset:0 sc1
    buffer_load_dwordx4 a[104:107], v2, s[8:11], s40 offen offset:1024 sc1
    buffer_load_dwordx4 a[108:111], v2, s[8:11], s41 offen offset:1024 sc1
    s_add_u32 s40, s40, 2048
    s_add_u32 s41, s41, 2048
    s_waitcnt vmcnt(0)
    s_barrier
    ds_read_b64_tr_b16 a[0:1], v8 offset:0
    ds_read_b64_tr_b16 a[2:3], v8 offset:4096
    ds_read_b64_tr_b16 a[4:5], v9 offset:0
    ds_read_b64_tr_b16 a[6:7], v9 offset:4096
    ds_read_b64_tr_b16 a[8:9], v10 offset:0
    ds_read_b64_tr_b16 a[10:11], v10 offset:4096
    ds_read_b64_tr_b16 a[12:13], v11 offset:0
    ds_read_b64_tr_b16 a[14:15], v11 offset:4096
    ds_read_b64_tr_b16 a[16:17], v12 offset:0
    ds_read_b64_tr_b16 a[18:19], v12 offset:4096
    ds_read_b64_tr_b16 a[20:21], v13 offset:0
    ds_read_b64_tr_b16 a[22:23], v13 offset:4096
    ds_read_b64_tr_b16 a[24:25], v14 offset:0
    ds_read_b64_tr_b16 a[26:27], v14 offset:4096
    ds_read_b64_tr_b16 a[28:29], v15 offset:0
    ds_read_b64_tr_b16 a[30:31], v15 offset:4096
    s_branch attn_kernel_o_loop
attn_kernel_o_hpro:
    s_mov_b32 s4, s60
    s_and_b32 s5, s61, 0xffff
    s_mov_b32 s6, 0x21c000
    s_mov_b32 s7, 0x20000
    s_add_u32 s8, s66, 0x300000
    s_addc_u32 s9, s67, 0
    s_and_b32 s9, s9, 0xffff
    s_mov_b32 s10, 0x6c0000
    s_mov_b32 s11, 0x20000
    s_mov_b32 s12, s62
    s_and_b32 s13, s63, 0xffff
    s_mov_b32 s14, 0x500
    s_mov_b32 s15, 0x20000
    s_mov_b32 s37, s51
    s_mul_i32 s40, s48, 55296
    s_add_u32 s41, s40, 55296
    s_mov_b32 s39, 6
    buffer_load_dwordx2 v[48:49], v19, s[12:15], 0 offen offset:0
    buffer_load_dwordx2 v[50:51], v19, s[12:15], 0 offen offset:32
    buffer_load_dwordx2 v[52:53], v19, s[12:15], 0 offen offset:64
    buffer_load_dwordx2 v[54:55], v19, s[12:15], 0 offen offset:96
    buffer_load_dwordx2 v[56:57], v19, s[12:15], 0 offen offset:128
    buffer_load_dwordx2 v[58:59], v19, s[12:15], 0 offen offset:160
    buffer_load_dwordx2 v[60:61], v19, s[12:15], 0 offen offset:192
    buffer_load_dwordx2 v[62:63], v19, s[12:15], 0 offen offset:224
    s_add_u32 m0, s38, 16384
    s_nop 0
    buffer_load_dwordx4 v4, s[4:7], s37 offen offset:0 lds
    buffer_load_dwordx4 v5, s[4:7], s37 offen offset:1024 lds
    buffer_load_dwordx4 v6, s[4:7], s37 offen offset:2048 lds
    buffer_load_dwordx4 v7, s[4:7], s37 offen offset:3072 lds
    s_add_u32 s37, s37, 81920
    s_add_u32 m0, s38, 32768
    s_nop 0
    buffer_load_dwordx4 v4, s[4:7], s37 offen offset:0 lds
    buffer_load_dwordx4 v5, s[4:7], s37 offen offset:1024 lds
    buffer_load_dwordx4 v6, s[4:7], s37 offen offset:2048 lds
    buffer_load_dwordx4 v7, s[4:7], s37 offen offset:3072 lds
    s_add_u32 s37, s37, 81920
    s_add_u32 m0, s38, 49152
    s_nop 0
    buffer_load_dwordx4 v4, s[4:7], s37 offen offset:0 lds
    buffer_load_dwordx4 v5, s[4:7], s37 offen offset:1024 lds
    buffer_load_dwordx4 v6, s[4:7], s37 offen offset:2048 lds
    buffer_load_dwordx4 v7, s[4:7], s37 offen offset:3072 lds
    s_add_u32 s37, s37, 81920
    s_add_u32 m0, s38, 0
    s_nop 0
    buffer_load_dwordx4 v4, s[4:7], s37 offen offset:0 lds
    buffer_load_dwordx4 v5, s[4:7], s37 offen offset:1024 lds
    buffer_load_dwordx4 v6, s[4:7], s37 offen offset:2048 lds
    buffer_load_dwordx4 v7, s[4:7], s37 offen offset:3072 lds
    s_add_u32 s37, s37, 81920
    v_mov_b32 v64, 0
    v_mov_b32 v65, 0
    v_mov_b32 v66, 0
    v_mov_b32 v67, 0
    v_mov_b32 v68, 0
    v_mov_b32 v69, 0
    v_mov_b32 v70, 0
    v_mov_b32 v71, 0
    v_mov_b32 v72, 0
    v_mov_b32 v73, 0
    v_mov_b32 v74, 0
    v_mov_b32 v75, 0
    v_mov_b32 v76, 0
    v_mov_b32 v77, 0
    v_mov_b32 v78, 0
    v_mov_b32 v79, 0
    v_mov_b32 v80, 0
    v_mov_b32 v81, 0
    v_mov_b32 v82, 0
    v_mov_b32 v83, 0
    v_mov_b32 v84, 0
    v_mov_b32 v85, 0
    v_mov_b32 v86, 0
    v_mov_b32 v87, 0
    v_mov_b32 v88, 0
    v_mov_b32 v89, 0
    v_mov_b32 v90, 0
    v_mov_b32 v91, 0
    v_mov_b32 v92, 0
    v_mov_b32 v93, 0
    v_mov_b32 v94, 0
    v_mov_b32 v95, 0
    v_mov_b32 v96, 0
    v_mov_b32 v97, 0
    v_mov_b32 v98, 0
    v_mov_b32 v99, 0
    v_mov_b32 v100, 0
    v_mov_b32 v101, 0
    v_mov_b32 v102, 0
    v_mov_b32 v103, 0
    v_mov_b32 v104, 0
    v_mov_b32 v105, 0
    v_mov_b32 v106, 0
    v_mov_b32 v107, 0
    v_mov_b32 v108, 0
    v_mov_b32 v109, 0
    v_mov_b32 v110, 0
    v_mov_b32 v111, 0
    v_mov_b32 v112, 0
    v_mov_b32 v113, 0
    v_mov_b32 v114, 0
    v_mov_b32 v115, 0
    v_mov_b32 v116, 0
    v_mov_b32 v117, 0
    v_mov_b32 v118, 0
    v_mov_b32 v119, 0
    v_mov_b32 v120, 0
    v_mov_b32 v121, 0
    v_mov_b32 v122, 0
    v_mov_b32 v123, 0
    v_mov_b32 v124, 0
    v_mov_b32 v125, 0
    v_mov_b32 v126, 0
    v_mov_b32 v127, 0
    s_cmp_lg_u32 s32, 0
    s_cbranch_scc1 attn_kernel_o_rdy5
    s_mov_b32 s70, 0x4000
    s_waitcnt vmcnt(24)
attn_kernel_o_chk5:
    v_cmp_ne_u32 vcc, s3, v30
    s_nop 1
    s_cmp_eq_u64 vcc, 0
    s_cbranch_scc1 attn_kernel_o_rdy5
    buffer_load_dword v30, v31, s[28:31], 0 offen sc1
    s_sub_u32 s70, s70, 1
    s_cmp_lg_u32 s70, 0
    s_waitcnt vmcnt(0)
    s_cbranch_scc1 attn_kernel_o_chk5
attn_kernel_o_rdy5:
    s_barrier
    buffer_load_dwordx4 a[80:83], v2, s[8:11], s40 offen offset:0 sc1
    buffer_load_dwordx4 a[84:87], v2, s[8:11], s41 offen offset:0 sc1
    buffer_load_dwordx4 a[88:91], v2, s[8:11], s40 offen offset:1024 sc1
    buffer_load_dwordx4 a[92:95], v2, s[8:11], s41 offen offset:1024 sc1
    s_add_u32 s40, s40, 2048
    s_add_u32 s41, s41, 2048
    buffer_load_dwordx4 a[96:99], v2, s[8:11], s40 offen offset:0 sc1
    buffer_load_dwordx4 a[100:103], v2, s[8:11], s41 offen offset:0 sc1
    buffer_load_dwordx4 a[104:107], v2, s[8:11], s40 offen offset:1024 sc1
    buffer_load_dwordx4 a[108:111], v2, s[8:11], s41 offen offset:1024 sc1
    s_add_u32 s40, s40, 2048
    s_add_u32 s41, s41, 2048
    buffer_load_dwordx4 a[112:115], v2, s[8:11], s40 offen offset:0 sc1
    buffer_load_dwordx4 a[116:119], v2, s[8:11], s41 offen offset:0 sc1
    buffer_load_dwordx4 a[120:123], v2, s[8:11], s40 offen offset:1024 sc1
    buffer_load_dwordx4 a[124:127], v2, s[8:11], s41 offen offset:1024 sc1
    s_add_u32 s40, s40, 2048
    s_add_u32 s41, s41, 2048
    s_waitcnt vmcnt(0)
    s_barrier
    ds_read_b64_tr_b16 a[0:1], v8 offset:16384
    ds_read_b64_tr_b16 a[2:3], v8 offset:20480
    ds_read_b64_tr_b16 a[4:5], v9 offset:16384
    ds_read_b64_tr_b16 a[6:7], v9 offset:20480
    ds_read_b64_tr_b16 a[8:9], v10 offset:16384
    ds_read_b64_tr_b16 a[10:11], v10 offset:20480
    ds_read_b64_tr_b16 a[12:13], v11 offset:16384
    ds_read_b64_tr_b16 a[14:15], v11 offset:20480
    ds_read_b64_tr_b16 a[16:17], v12 offset:16384
    ds_read_b64_tr_b16 a[18:19], v12 offset:20480
    ds_read_b64_tr_b16 a[20:21], v13 offset:16384
    ds_read_b64_tr_b16 a[22:23], v13 offset:20480
    ds_read_b64_tr_b16 a[24:25], v14 offset:16384
    ds_read_b64_tr_b16 a[26:27], v14 offset:20480
    ds_read_b64_tr_b16 a[28:29], v15 offset:16384
    ds_read_b64_tr_b16 a[30:31], v15 offset:20480
    s_branch attn_kernel_o_ent1
attn_kernel_o_loop:
    s_waitcnt lgkmcnt(14)
    v_mfma_f32_16x16x32_bf16 v[64:67], a[0:3], a[64:67], v[64:67]
    ds_read_b64_tr_b16 a[32:33], v8 offset:8192
    ds_read_b64_tr_b16 a[34:35], v8 offset:12288
    v_mfma_f32_16x16x32_bf16 v[96:99], a[0:3], a[68:71], v[96:99]
    ds_read_b64_tr_b16 a[36:37], v9 offset:8192
    ds_read_b64_tr_b16 a[38:39], v9 offset:12288
    buffer_load_dwordx4 a[112:115], v2, s[8:11], s40 offen offset:0 sc1
    s_waitcnt lgkmcnt(15)
    v_mfma_f32_16x16x32_bf16 v[68:71], a[4:7], a[64:67], v[68:71]
    ds_read_b64_tr_b16 a[40:41], v10 offset:8192
    ds_read_b64_tr_b16 a[42:43], v10 offset:12288
    v_mfma_f32_16x16x32_bf16 v[100:103], a[4:7], a[68:71], v[100:103]
    ds_read_b64_tr_b16 a[44:45], v11 offset:8192
    ds_read_b64_tr_b16 a[46:47], v11 offset:12288
    s_waitcnt lgkmcnt(15)
    v_mfma_f32_16x16x32_bf16 v[72:75], a[8:11], a[64:67], v[72:75]
    ds_read_b64_tr_b16 a[48:49], v12 offset:8192
    ds_read_b64_tr_b16 a[50:51], v12 offset:12288
    v_mfma_f32_16x16x32_bf16 v[104:107], a[8:11], a[68:71], v[104:107]
    ds_read_b64_tr_b16 a[52:53], v13 offset:8192
    ds_read_b64_tr_b16 a[54:55], v13 offset:12288
    buffer_load_dwordx4 a[116:119], v2, s[8:11], s41 offen offset:0 sc1
    v_mfma_f32_16x16x32_bf16 v[76:79], a[12:15], a[64:67], v[76:79]
    ds_read_b64_tr_b16 a[56:57], v14 offset:8192
    ds_read_b64_tr_b16 a[58:59], v14 offset:12288
    v_mfma_f32_16x16x32_bf16 v[108:111], a[12:15], a[68:71], v[108:111]
    ds_read_b64_tr_b16 a[60:61], v15 offset:8192
    ds_read_b64_tr_b16 a[62:63], v15 offset:12288
    s_waitcnt lgkmcnt(15)
    v_mfma_f32_16x16x32_bf16 v[80:83], a[16:19], a[64:67], v[80:83]
    v_mfma_f32_16x16x32_bf16 v[112:115], a[16:19], a[68:71], v[112:115]
    buffer_load_dwordx4 a[120:123], v2, s[8:11], s40 offen offset:1024 sc1
    v_mfma_f32_16x16x32_bf16 v[84:87], a[20:23], a[64:67], v[84:87]
    v_mfma_f32_16x16x32_bf16 v[116:119], a[20:23], a[68:71], v[116:119]
    v_mfma_f32_16x16x32_bf16 v[88:91], a[24:27], a[64:67], v[88:91]
    v_mfma_f32_16x16x32_bf16 v[120:123], a[24:27], a[68:71], v[120:123]
    buffer_load_dwordx4 a[124:127], v2, s[8:11], s41 offen offset:1024 sc1
    v_mfma_f32_16x16x32_bf16 v[92:95], a[28:31], a[64:67], v[92:95]
    v_mfma_f32_16x16x32_bf16 v[124:127], a[28:31], a[68:71], v[124:127]
    s_add_u32 s40, s40, 2048
    s_add_u32 s41, s41, 2048
    s_waitcnt lgkmcnt(0)
    v_mfma_f32_16x16x32_bf16 v[64:67], a[32:35], a[72:75], v[64:67]
    v_mfma_f32_16x16x32_bf16 v[96:99], a[32:35], a[76:79], v[96:99]
    s_waitcnt vmcnt(16)
    s_barrier
    s_add_u32 m0, s38, 0
    v_mfma_f32_16x16x32_bf16 v[68:71], a[36:39], a[72:75], v[68:71]
    ds_read_b64_tr_b16 a[0:1], v8 offset:16384
    ds_read_b64_tr_b16 a[2:3], v8 offset:20480
    buffer_load_dwordx4 v4, s[4:7], s37 offen offset:0 lds
    v_mfma_f32_16x16x32_bf16 v[100:103], a[36:39], a[76:79], v[100:103]
    ds_read_b64_tr_b16 a[4:5], v9 offset:16384
    ds_read_b64_tr_b16 a[6:7], v9 offset:20480
    v_mfma_f32_16x16x32_bf16 v[72:75], a[40:43], a[72:75], v[72:75]
    ds_read_b64_tr_b16 a[8:9], v10 offset:16384
    ds_read_b64_tr_b16 a[10:11], v10 offset:20480
    v_mfma_f32_16x16x32_bf16 v[104:107], a[40:43], a[76:79], v[104:107]
    ds_read_b64_tr_b16 a[12:13], v11 offset:16384
    ds_read_b64_tr_b16 a[14:15], v11 offset:20480
    v_mfma_f32_16x16x32_bf16 v[76:79], a[44:47], a[72:75], v[76:79]
    ds_read_b64_tr_b16 a[16:17], v12 offset:16384
    ds_read_b64_tr_b16 a[18:19], v12 offset:20480
    buffer_load_dwordx4 v5, s[4:7], s37 offen offset:1024 lds
    v_mfma_f32_16x16x32_bf16 v[108:111], a[44:47], a[76:79], v[108:111]
    ds_read_b64_tr_b16 a[20:21], v13 offset:16384
    ds_read_b64_tr_b16 a[22:23], v13 offset:20480
    v_mfma_f32_16x16x32_bf16 v[80:83], a[48:51], a[72:75], v[80:83]
    ds_read_b64_tr_b16 a[24:25], v14 offset:16384
    ds_read_b64_tr_b16 a[26:27], v14 offset:20480
    v_mfma_f32_16x16x32_bf16 v[112:115], a[48:51], a[76:79], v[112:115]
    ds_read_b64_tr_b16 a[28:29], v15 offset:16384
    ds_read_b64_tr_b16 a[30:31], v15 offset:20480
    v_mfma_f32_16x16x32_bf16 v[84:87], a[52:55], a[72:75], v[84:87]
    buffer_load_dwordx4 v6, s[4:7], s37 offen offset:2048 lds
    v_mfma_f32_16x16x32_bf16 v[116:119], a[52:55], a[76:79], v[116:119]
    v_mfma_f32_16x16x32_bf16 v[88:91], a[56:59], a[72:75], v[88:91]
    v_mfma_f32_16x16x32_bf16 v[120:123], a[56:59], a[76:79], v[120:123]
    v_mfma_f32_16x16x32_bf16 v[92:95], a[60:63], a[72:75], v[92:95]
    buffer_load_dwordx4 v7, s[4:7], s37 offen offset:3072 lds
    v_mfma_f32_16x16x32_bf16 v[124:127], a[60:63], a[76:79], v[124:127]
    s_add_u32 s37, s37, 81920
attn_kernel_o_ent1:
    s_waitcnt lgkmcnt(14)
    v_mfma_f32_16x16x32_bf16 v[64:67], a[0:3], a[80:83], v[64:67]
    ds_read_b64_tr_b16 a[32:33], v8 offset:24576
    ds_read_b64_tr_b16 a[34:35], v8 offset:28672
    v_mfma_f32_16x16x32_bf16 v[96:99], a[0:3], a[84:87], v[96:99]
    ds_read_b64_tr_b16 a[36:37], v9 offset:24576
    ds_read_b64_tr_b16 a[38:39], v9 offset:28672
    buffer_load_dwordx4 a[64:67], v2, s[8:11], s40 offen offset:0 sc1
    s_waitcnt lgkmcnt(15)
    v_mfma_f32_16x16x32_bf16 v[68:71], a[4:7], a[80:83], v[68:71]
    ds_read_b64_tr_b16 a[40:41], v10 offset:24576
    ds_read_b64_tr_b16 a[42:43], v10 offset:28672
    v_mfma_f32_16x16x32_bf16 v[100:103], a[4:7], a[84:87], v[100:103]
    ds_read_b64_tr_b16 a[44:45], v11 offset:24576
    ds_read_b64_tr_b16 a[46:47], v11 offset:28672
    s_waitcnt lgkmcnt(15)
    v_mfma_f32_16x16x32_bf16 v[72:75], a[8:11], a[80:83], v[72:75]
    ds_read_b64_tr_b16 a[48:49], v12 offset:24576
    ds_read_b64_tr_b16 a[50:51], v12 offset:28672
    v_mfma_f32_16x16x32_bf16 v[104:107], a[8:11], a[84:87], v[104:107]
    ds_read_b64_tr_b16 a[52:53], v13 offset:24576
    ds_read_b64_tr_b16 a[54:55], v13 offset:28672
    buffer_load_dwordx4 a[68:71], v2, s[8:11], s41 offen offset:0 sc1
    v_mfma_f32_16x16x32_bf16 v[76:79], a[12:15], a[80:83], v[76:79]
    ds_read_b64_tr_b16 a[56:57], v14 offset:24576
    ds_read_b64_tr_b16 a[58:59], v14 offset:28672
    v_mfma_f32_16x16x32_bf16 v[108:111], a[12:15], a[84:87], v[108:111]
    ds_read_b64_tr_b16 a[60:61], v15 offset:24576
    ds_read_b64_tr_b16 a[62:63], v15 offset:28672
    s_waitcnt lgkmcnt(15)
    v_mfma_f32_16x16x32_bf16 v[80:83], a[16:19], a[80:83], v[80:83]
    v_mfma_f32_16x16x32_bf16 v[112:115], a[16:19], a[84:87], v[112:115]
    buffer_load_dwordx4 a[72:75], v2, s[8:11], s40 offen offset:1024 sc1
    v_mfma_f32_16x16x32_bf16 v[84:87], a[20:23], a[80:83], v[84:87]
    v_mfma_f32_16x16x32_bf16 v[116:119], a[20:23], a[84:87], v[116:119]
    v_mfma_f32_16x16x32_bf16 v[88:91], a[24:27], a[80:83], v[88:91]
    v_mfma_f32_16x16x32_bf16 v[120:123], a[24:27], a[84:87], v[120:123]
    buffer_load_dwordx4 a[76:79], v2, s[8:11], s41 offen offset:1024 sc1
    v_mfma_f32_16x16x32_bf16 v[92:95], a[28:31], a[80:83], v[92:95]
    v_mfma_f32_16x16x32_bf16 v[124:127], a[28:31], a[84:87], v[124:127]
    s_add_u32 s40, s40, 2048
    s_add_u32 s41, s41, 2048
    s_waitcnt lgkmcnt(0)
    v_mfma_f32_16x16x32_bf16 v[64:67], a[32:35], a[88:91], v[64:67]
    v_mfma_f32_16x16x32_bf16 v[96:99], a[32:35], a[92:95], v[96:99]
    s_waitcnt vmcnt(16)
    s_barrier
    s_add_u32 m0, s38, 16384
    v_mfma_f32_16x16x32_bf16 v[68:71], a[36:39], a[88:91], v[68:71]
    ds_read_b64_tr_b16 a[0:1], v8 offset:32768
    ds_read_b64_tr_b16 a[2:3], v8 offset:36864
    buffer_load_dwordx4 v4, s[4:7], s37 offen offset:0 lds
    v_mfma_f32_16x16x32_bf16 v[100:103], a[36:39], a[92:95], v[100:103]
    ds_read_b64_tr_b16 a[4:5], v9 offset:32768
    ds_read_b64_tr_b16 a[6:7], v9 offset:36864
    v_mfma_f32_16x16x32_bf16 v[72:75], a[40:43], a[88:91], v[72:75]
    ds_read_b64_tr_b16 a[8:9], v10 offset:32768
    ds_read_b64_tr_b16 a[10:11], v10 offset:36864
    v_mfma_f32_16x16x32_bf16 v[104:107], a[40:43], a[92:95], v[104:107]
    ds_read_b64_tr_b16 a[12:13], v11 offset:32768
    ds_read_b64_tr_b16 a[14:15], v11 offset:36864
    v_mfma_f32_16x16x32_bf16 v[76:79], a[44:47], a[88:91], v[76:79]
    ds_read_b64_tr_b16 a[16:17], v12 offset:32768
    ds_read_b64_tr_b16 a[18:19], v12 offset:36864
    buffer_load_dwordx4 v5, s[4:7], s37 offen offset:1024 lds
    v_mfma_f32_16x16x32_bf16 v[108:111], a[44:47], a[92:95], v[108:111]
    ds_read_b64_tr_b16 a[20:21], v13 offset:32768
    ds_read_b64_tr_b16 a[22:23], v13 offset:36864
    v_mfma_f32_16x16x32_bf16 v[80:83], a[48:51], a[88:91], v[80:83]
    ds_read_b64_tr_b16 a[24:25], v14 offset:32768
    ds_read_b64_tr_b16 a[26:27], v14 offset:36864
    v_mfma_f32_16x16x32_bf16 v[112:115], a[48:51], a[92:95], v[112:115]
    ds_read_b64_tr_b16 a[28:29], v15 offset:32768
    ds_read_b64_tr_b16 a[30:31], v15 offset:36864
    v_mfma_f32_16x16x32_bf16 v[84:87], a[52:55], a[88:91], v[84:87]
    buffer_load_dwordx4 v6, s[4:7], s37 offen offset:2048 lds
    v_mfma_f32_16x16x32_bf16 v[116:119], a[52:55], a[92:95], v[116:119]
    v_mfma_f32_16x16x32_bf16 v[88:91], a[56:59], a[88:91], v[88:91]
    v_mfma_f32_16x16x32_bf16 v[120:123], a[56:59], a[92:95], v[120:123]
    v_mfma_f32_16x16x32_bf16 v[92:95], a[60:63], a[88:91], v[92:95]
    buffer_load_dwordx4 v7, s[4:7], s37 offen offset:3072 lds
    v_mfma_f32_16x16x32_bf16 v[124:127], a[60:63], a[92:95], v[124:127]
    s_add_u32 s37, s37, 81920
    s_waitcnt lgkmcnt(14)
    v_mfma_f32_16x16x32_bf16 v[64:67], a[0:3], a[96:99], v[64:67]
    ds_read_b64_tr_b16 a[32:33], v8 offset:40960
    ds_read_b64_tr_b16 a[34:35], v8 offset:45056
    v_mfma_f32_16x16x32_bf16 v[96:99], a[0:3], a[100:103], v[96:99]
    ds_read_b64_tr_b16 a[36:37], v9 offset:40960
    ds_read_b64_tr_b16 a[38:39], v9 offset:45056
    buffer_load_dwordx4 a[80:83], v2, s[8:11], s40 offen offset:0 sc1
    s_waitcnt lgkmcnt(15)
    v_mfma_f32_16x16x32_bf16 v[68:71], a[4:7], a[96:99], v[68:71]
    ds_read_b64_tr_b16 a[40:41], v10 offset:40960
    ds_read_b64_tr_b16 a[42:43], v10 offset:45056
    v_mfma_f32_16x16x32_bf16 v[100:103], a[4:7], a[100:103], v[100:103]
    ds_read_b64_tr_b16 a[44:45], v11 offset:40960
    ds_read_b64_tr_b16 a[46:47], v11 offset:45056
    s_waitcnt lgkmcnt(15)
    v_mfma_f32_16x16x32_bf16 v[72:75], a[8:11], a[96:99], v[72:75]
    ds_read_b64_tr_b16 a[48:49], v12 offset:40960
    ds_read_b64_tr_b16 a[50:51], v12 offset:45056
    v_mfma_f32_16x16x32_bf16 v[104:107], a[8:11], a[100:103], v[104:107]
    ds_read_b64_tr_b16 a[52:53], v13 offset:40960
    ds_read_b64_tr_b16 a[54:55], v13 offset:45056
    buffer_load_dwordx4 a[84:87], v2, s[8:11], s41 offen offset:0 sc1
    v_mfma_f32_16x16x32_bf16 v[76:79], a[12:15], a[96:99], v[76:79]
    ds_read_b64_tr_b16 a[56:57], v14 offset:40960
    ds_read_b64_tr_b16 a[58:59], v14 offset:45056
    v_mfma_f32_16x16x32_bf16 v[108:111], a[12:15], a[100:103], v[108:111]
    ds_read_b64_tr_b16 a[60:61], v15 offset:40960
    ds_read_b64_tr_b16 a[62:63], v15 offset:45056
    s_waitcnt lgkmcnt(15)
    v_mfma_f32_16x16x32_bf16 v[80:83], a[16:19], a[96:99], v[80:83]
    v_mfma_f32_16x16x32_bf16 v[112:115], a[16:19], a[100:103], v[112:115]
    buffer_load_dwordx4 a[88:91], v2, s[8:11], s40 offen offset:1024 sc1
    v_mfma_f32_16x16x32_bf16 v[84:87], a[20:23], a[96:99], v[84:87]
    v_mfma_f32_16x16x32_bf16 v[116:119], a[20:23], a[100:103], v[116:119]
    v_mfma_f32_16x16x32_bf16 v[88:91], a[24:27], a[96:99], v[88:91]
    v_mfma_f32_16x16x32_bf16 v[120:123], a[24:27], a[100:103], v[120:123]
    buffer_load_dwordx4 a[92:95], v2, s[8:11], s41 offen offset:1024 sc1
    v_mfma_f32_16x16x32_bf16 v[92:95], a[28:31], a[96:99], v[92:95]
    v_mfma_f32_16x16x32_bf16 v[124:127], a[28:31], a[100:103], v[124:127]
    s_add_u32 s40, s40, 2048
    s_add_u32 s41, s41, 2048
    s_waitcnt lgkmcnt(0)
    v_mfma_f32_16x16x32_bf16 v[64:67], a[32:35], a[104:107], v[64:67]
    v_mfma_f32_16x16x32_bf16 v[96:99], a[32:35], a[108:111], v[96:99]
    s_waitcnt vmcnt(16)
    s_barrier
    s_add_u32 m0, s38, 32768
    v_mfma_f32_16x16x32_bf16 v[68:71], a[36:39], a[104:107], v[68:71]
    ds_read_b64_tr_b16 a[0:1], v8 offset:49152
    ds_read_b64_tr_b16 a[2:3], v8 offset:53248
    buffer_load_dwordx4 v4, s[4:7], s37 offen offset:0 lds
    v_mfma_f32_16x16x32_bf16 v[100:103], a[36:39], a[108:111], v[100:103]
    ds_read_b64_tr_b16 a[4:5], v9 offset:49152
    ds_read_b64_tr_b16 a[6:7], v9 offset:53248
    v_mfma_f32_16x16x32_bf16 v[72:75], a[40:43], a[104:107], v[72:75]
    ds_read_b64_tr_b16 a[8:9], v10 offset:49152
    ds_read_b64_tr_b16 a[10:11], v10 offset:53248
    v_mfma_f32_16x16x32_bf16 v[104:107], a[40:43], a[108:111], v[104:107]
    ds_read_b64_tr_b16 a[12:13], v11 offset:49152
    ds_read_b64_tr_b16 a[14:15], v11 offset:53248
    v_mfma_f32_16x16x32_bf16 v[76:79], a[44:47], a[104:107], v[76:79]
    ds_read_b64_tr_b16 a[16:17], v12 offset:49152
    ds_read_b64_tr_b16 a[18:19], v12 offset:53248
    buffer_load_dwordx4 v5, s[4:7], s37 offen offset:1024 lds
    v_mfma_f32_16x16x32_bf16 v[108:111], a[44:47], a[108:111], v[108:111]
    ds_read_b64_tr_b16 a[20:21], v13 offset:49152
    ds_read_b64_tr_b16 a[22:23], v13 offset:53248
    v_mfma_f32_16x16x32_bf16 v[80:83], a[48:51], a[104:107], v[80:83]
    ds_read_b64_tr_b16 a[24:25], v14 offset:49152
    ds_read_b64_tr_b16 a[26:27], v14 offset:53248
    v_mfma_f32_16x16x32_bf16 v[112:115], a[48:51], a[108:111], v[112:115]
    ds_read_b64_tr_b16 a[28:29], v15 offset:49152
    ds_read_b64_tr_b16 a[30:31], v15 offset:53248
    v_mfma_f32_16x16x32_bf16 v[84:87], a[52:55], a[104:107], v[84:87]
    buffer_load_dwordx4 v6, s[4:7], s37 offen offset:2048 lds
    v_mfma_f32_16x16x32_bf16 v[116:119], a[52:55], a[108:111], v[116:119]
    v_mfma_f32_16x16x32_bf16 v[88:91], a[56:59], a[104:107], v[88:91]
    v_mfma_f32_16x16x32_bf16 v[120:123], a[56:59], a[108:111], v[120:123]
    v_mfma_f32_16x16x32_bf16 v[92:95], a[60:63], a[104:107], v[92:95]
    buffer_load_dwordx4 v7, s[4:7], s37 offen offset:3072 lds
    v_mfma_f32_16x16x32_bf16 v[124:127], a[60:63], a[108:111], v[124:127]
    s_add_u32 s37, s37, 81920
    s_waitcnt lgkmcnt(14)
    v_mfma_f32_16x16x32_bf16 v[64:67], a[0:3], a[112:115], v[64:67]
    ds_read_b64_tr_b16 a[32:33], v8 offset:57344
    ds_read_b64_tr_b16 a[34:35], v8 offset:61440
    v_mfma_f32_16x16x32_bf16 v[96:99], a[0:3], a[116:119], v[96:99]
    ds_read_b64_tr_b16 a[36:37], v9 offset:57344
    ds_read_b64_tr_b16 a[38:39], v9 offset:61440
    buffer_load_dwordx4 a[96:99], v2, s[8:11], s40 offen offset:0 sc1
    s_waitcnt lgkmcnt(15)
    v_mfma_f32_16x16x32_bf16 v[68:71], a[4:7], a[112:115], v[68:71]
    ds_read_b64_tr_b16 a[40:41], v10 offset:57344
    ds_read_b64_tr_b16 a[42:43], v10 offset:61440
    v_mfma_f32_16x16x32_bf16 v[100:103], a[4:7], a[116:119], v[100:103]
    ds_read_b64_tr_b16 a[44:45], v11 offset:57344
    ds_read_b64_tr_b16 a[46:47], v11 offset:61440
    s_waitcnt lgkmcnt(15)
    v_mfma_f32_16x16x32_bf16 v[72:75], a[8:11], a[112:115], v[72:75]
    ds_read_b64_tr_b16 a[48:49], v12 offset:57344
    ds_read_b64_tr_b16 a[50:51], v12 offset:61440
    v_mfma_f32_16x16x32_bf16 v[104:107], a[8:11], a[116:119], v[104:107]
    ds_read_b64_tr_b16 a[52:53], v13 offset:57344
    ds_read_b64_tr_b16 a[54:55], v13 offset:61440
    buffer_load_dwordx4 a[100:103], v2, s[8:11], s41 offen offset:0 sc1
    v_mfma_f32_16x16x32_bf16 v[76:79], a[12:15], a[112:115], v[76:79]
    ds_read_b64_tr_b16 a[56:57], v14 offset:57344
    ds_read_b64_tr_b16 a[58:59], v14 offset:61440
    v_mfma_f32_16x16x32_bf16 v[108:111], a[12:15], a[116:119], v[108:111]
    ds_read_b64_tr_b16 a[60:61], v15 offset:57344
    ds_read_b64_tr_b16 a[62:63], v15 offset:61440
    s_waitcnt lgkmcnt(15)
    v_mfma_f32_16x16x32_bf16 v[80:83], a[16:19], a[112:115], v[80:83]
    v_mfma_f32_16x16x32_bf16 v[112:115], a[16:19], a[116:119], v[112:115]
    buffer_load_dwordx4 a[104:107], v2, s[8:11], s40 offen offset:1024 sc1
    v_mfma_f32_16x16x32_bf16 v[84:87], a[20:23], a[112:115], v[84:87]
    v_mfma_f32_16x16x32_bf16 v[116:119], a[20:23], a[116:119], v[116:119]
    v_mfma_f32_16x16x32_bf16 v[88:91], a[24:27], a[112:115], v[88:91]
    v_mfma_f32_16x16x32_bf16 v[120:123], a[24:27], a[116:119], v[120:123]
    buffer_load_dwordx4 a[108:111], v2, s[8:11], s41 offen offset:1024 sc1
    v_mfma_f32_16x16x32_bf16 v[92:95], a[28:31], a[112:115], v[92:95]
    v_mfma_f32_16x16x32_bf16 v[124:127], a[28:31], a[116:119], v[124:127]
    s_add_u32 s40, s40, 2048
    s_add_u32 s41, s41, 2048
    s_waitcnt lgkmcnt(0)
    v_mfma_f32_16x16x32_bf16 v[64:67], a[32:35], a[120:123], v[64:67]
    v_mfma_f32_16x16x32_bf16 v[96:99], a[32:35], a[124:127], v[96:99]
    s_waitcnt vmcnt(16)
    s_barrier
    s_add_u32 m0, s38, 49152
    v_mfma_f32_16x16x32_bf16 v[68:71], a[36:39], a[120:123], v[68:71]
    ds_read_b64_tr_b16 a[0:1], v8 offset:0
    ds_read_b64_tr_b16 a[2:3], v8 offset:4096
    buffer_load_dwordx4 v4, s[4:7], s37 offen offset:0 lds
    v_mfma_f32_16x16x32_bf16 v[100:103], a[36:39], a[124:127], v[100:103]
    ds_read_b64_tr_b16 a[4:5], v9 offset:0
    ds_read_b64_tr_b16 a[6:7], v9 offset:4096
    v_mfma_f32_16x16x32_bf16 v[72:75], a[40:43], a[120:123], v[72:75]
    ds_read_b64_tr_b16 a[8:9], v10 offset:0
    ds_read_b64_tr_b16 a[10:11], v10 offset:4096
    v_mfma_f32_16x16x32_bf16 v[104:107], a[40:43], a[124:127], v[104:107]
    ds_read_b64_tr_b16 a[12:13], v11 offset:0
    ds_read_b64_tr_b16 a[14:15], v11 offset:4096
    v_mfma_f32_16x16x32_bf16 v[76:79], a[44:47], a[120:123], v[76:79]
    ds_read_b64_tr_b16 a[16:17], v12 offset:0
    ds_read_b64_tr_b16 a[18:19], v12 offset:4096
    buffer_load_dwordx4 v5, s[4:7], s37 offen offset:1024 lds
    v_mfma_f32_16x16x32_bf16 v[108:111], a[44:47], a[124:127], v[108:111]
    ds_read_b64_tr_b16 a[20:21], v13 offset:0
    ds_read_b64_tr_b16 a[22:23], v13 offset:4096
    v_mfma_f32_16x16x32_bf16 v[80:83], a[48:51], a[120:123], v[80:83]
    ds_read_b64_tr_b16 a[24:25], v14 offset:0
    ds_read_b64_tr_b16 a[26:27], v14 offset:4096
    v_mfma_f32_16x16x32_bf16 v[112:115], a[48:51], a[124:127], v[112:115]
    ds_read_b64_tr_b16 a[28:29], v15 offset:0
    ds_read_b64_tr_b16 a[30:31], v15 offset:4096
    v_mfma_f32_16x16x32_bf16 v[84:87], a[52:55], a[120:123], v[84:87]
    buffer_load_dwordx4 v6, s[4:7], s37 offen offset:2048 lds
    v_mfma_f32_16x16x32_bf16 v[116:119], a[52:55], a[124:127], v[116:119]
    v_mfma_f32_16x16x32_bf16 v[88:91], a[56:59], a[120:123], v[88:91]
    v_mfma_f32_16x16x32_bf16 v[120:123], a[56:59], a[124:127], v[120:123]
    v_mfma_f32_16x16x32_bf16 v[92:95], a[60:63], a[120:123], v[92:95]
    buffer_load_dwordx4 v7, s[4:7], s37 offen offset:3072 lds
    v_mfma_f32_16x16x32_bf16 v[124:127], a[60:63], a[124:127], v[124:127]
    s_add_u32 s37, s37, 81920
    s_sub_u32 s39, s39, 1
    s_cmp_lg_u32 s39, 0
    s_cbranch_scc1 attn_kernel_o_loop
    s_waitcnt lgkmcnt(14)
    v_mfma_f32_16x16x32_bf16 v[64:67], a[0:3], a[64:67], v[64:67]
    ds_read_b64_tr_b16 a[32:33], v8 offset:8192
    ds_read_b64_tr_b16 a[34:35], v8 offset:12288
    v_mfma_f32_16x16x32_bf16 v[96:99], a[0:3], a[68:71], v[96:99]
    ds_read_b64_tr_b16 a[36:37], v9 offset:8192
    ds_read_b64_tr_b16 a[38:39], v9 offset:12288
    buffer_load_dwordx4 a[112:115], v2, s[8:11], s40 offen offset:0 sc1
    s_waitcnt lgkmcnt(15)
    v_mfma_f32_16x16x32_bf16 v[68:71], a[4:7], a[64:67], v[68:71]
    ds_read_b64_tr_b16 a[40:41], v10 offset:8192
    ds_read_b64_tr_b16 a[42:43], v10 offset:12288
    v_mfma_f32_16x16x32_bf16 v[100:103], a[4:7], a[68:71], v[100:103]
    ds_read_b64_tr_b16 a[44:45], v11 offset:8192
    ds_read_b64_tr_b16 a[46:47], v11 offset:12288
    s_waitcnt lgkmcnt(15)
    v_mfma_f32_16x16x32_bf16 v[72:75], a[8:11], a[64:67], v[72:75]
    ds_read_b64_tr_b16 a[48:49], v12 offset:8192
    ds_read_b64_tr_b16 a[50:51], v12 offset:12288
    v_mfma_f32_16x16x32_bf16 v[104:107], a[8:11], a[68:71], v[104:107]
    ds_read_b64_tr_b16 a[52:53], v13 offset:8192
    ds_read_b64_tr_b16 a[54:55], v13 offset:12288
    buffer_load_dwordx4 a[116:119], v2, s[8:11], s41 offen offset:0 sc1
    v_mfma_f32_16x16x32_bf16 v[76:79], a[12:15], a[64:67], v[76:79]
    ds_read_b64_tr_b16 a[56:57], v14 offset:8192
    ds_read_b64_tr_b16 a[58:59], v14 offset:12288
    v_mfma_f32_16x16x32_bf16 v[108:111], a[12:15], a[68:71], v[108:111]
    ds_read_b64_tr_b16 a[60:61], v15 offset:8192
    ds_read_b64_tr_b16 a[62:63], v15 offset:12288
    s_waitcnt lgkmcnt(15)
    v_mfma_f32_16x16x32_bf16 v[80:83], a[16:19], a[64:67], v[80:83]
    v_mfma_f32_16x16x32_bf16 v[112:115], a[16:19], a[68:71], v[112:115]
    buffer_load_dwordx4 a[120:123], v2, s[8:11], s40 offen offset:1024 sc1
    v_mfma_f32_16x16x32_bf16 v[84:87], a[20:23], a[64:67], v[84:87]
    v_mfma_f32_16x16x32_bf16 v[116:119], a[20:23], a[68:71], v[116:119]
    v_mfma_f32_16x16x32_bf16 v[88:91], a[24:27], a[64:67], v[88:91]
    v_mfma_f32_16x16x32_bf16 v[120:123], a[24:27], a[68:71], v[120:123]
    buffer_load_dwordx4 a[124:127], v2, s[8:11], s41 offen offset:1024 sc1
    v_mfma_f32_16x16x32_bf16 v[92:95], a[28:31], a[64:67], v[92:95]
    v_mfma_f32_16x16x32_bf16 v[124:127], a[28:31], a[68:71], v[124:127]
    s_add_u32 s40, s40, 2048
    s_add_u32 s41, s41, 2048
    s_waitcnt lgkmcnt(0)
    v_mfma_f32_16x16x32_bf16 v[64:67], a[32:35], a[72:75], v[64:67]
    v_mfma_f32_16x16x32_bf16 v[96:99], a[32:35], a[76:79], v[96:99]
    s_waitcnt vmcnt(16)
    s_barrier
    v_mfma_f32_16x16x32_bf16 v[68:71], a[36:39], a[72:75], v[68:71]
    ds_read_b64_tr_b16 a[0:1], v8 offset:16384
    ds_read_b64_tr_b16 a[2:3], v8 offset:20480
    v_mfma_f32_16x16x32_bf16 v[100:103], a[36:39], a[76:79], v[100:103]
    ds_read_b64_tr_b16 a[4:5], v9 offset:16384
    ds_read_b64_tr_b16 a[6:7], v9 offset:20480
    v_mfma_f32_16x16x32_bf16 v[72:75], a[40:43], a[72:75], v[72:75]
    ds_read_b64_tr_b16 a[8:9], v10 offset:16384
    ds_read_b64_tr_b16 a[10:11], v10 offset:20480
    v_mfma_f32_16x16x32_bf16 v[104:107], a[40:43], a[76:79], v[104:107]
    ds_read_b64_tr_b16 a[12:13], v11 offset:16384
    ds_read_b64_tr_b16 a[14:15], v11 offset:20480
    v_mfma_f32_16x16x32_bf16 v[76:79], a[44:47], a[72:75], v[76:79]
    ds_read_b64_tr_b16 a[16:17], v12 offset:16384
    ds_read_b64_tr_b16 a[18:19], v12 offset:20480
    v_mfma_f32_16x16x32_bf16 v[108:111], a[44:47], a[76:79], v[108:111]
    ds_read_b64_tr_b16 a[20:21], v13 offset:16384
    ds_read_b64_tr_b16 a[22:23], v13 offset:20480
    v_mfma_f32_16x16x32_bf16 v[80:83], a[48:51], a[72:75], v[80:83]
    ds_read_b64_tr_b16 a[24:25], v14 offset:16384
    ds_read_b64_tr_b16 a[26:27], v14 offset:20480
    v_mfma_f32_16x16x32_bf16 v[112:115], a[48:51], a[76:79], v[112:115]
    ds_read_b64_tr_b16 a[28:29], v15 offset:16384
    ds_read_b64_tr_b16 a[30:31], v15 offset:20480
    v_mfma_f32_16x16x32_bf16 v[84:87], a[52:55], a[72:75], v[84:87]
    v_mfma_f32_16x16x32_bf16 v[116:119], a[52:55], a[76:79], v[116:119]
    v_mfma_f32_16x16x32_bf16 v[88:91], a[56:59], a[72:75], v[88:91]
    v_mfma_f32_16x16x32_bf16 v[120:123], a[56:59], a[76:79], v[120:123]
    v_mfma_f32_16x16x32_bf16 v[92:95], a[60:63], a[72:75], v[92:95]
    v_mfma_f32_16x16x32_bf16 v[124:127], a[60:63], a[76:79], v[124:127]
    s_waitcnt lgkmcnt(14)
    v_mfma_f32_16x16x32_bf16 v[64:67], a[0:3], a[80:83], v[64:67]
    ds_read_b64_tr_b16 a[32:33], v8 offset:24576
    ds_read_b64_tr_b16 a[34:35], v8 offset:28672
    v_mfma_f32_16x16x32_bf16 v[96:99], a[0:3], a[84:87], v[96:99]
    ds_read_b64_tr_b16 a[36:37], v9 offset:24576
    ds_read_b64_tr_b16 a[38:39], v9 offset:28672
    s_waitcnt lgkmcnt(15)
    v_mfma_f32_16x16x32_bf16 v[68:71], a[4:7], a[80:83], v[68:71]
    ds_read_b64_tr_b16 a[40:41], v10 offset:24576
    ds_read_b64_tr_b16 a[42:43], v10 offset:28672
    v_mfma_f32_16x16x32_bf16 v[100:103], a[4:7], a[84:87], v[100:103]
    ds_read_b64_tr_b16 a[44:45], v11 offset:24576
    ds_read_b64_tr_b16 a[46:47], v11 offset:28672
    s_waitcnt lgkmcnt(15)
    v_mfma_f32_16x16x32_bf16 v[72:75], a[8:11], a[80:83], v[72:75]
    ds_read_b64_tr_b16 a[48:49], v12 offset:24576
    ds_read_b64_tr_b16 a[50:51], v12 offset:28672
    v_mfma_f32_16x16x32_bf16 v[104:107], a[8:11], a[84:87], v[104:107]
    ds_read_b64_tr_b16 a[52:53], v13 offset:24576
    ds_read_b64_tr_b16 a[54:55], v13 offset:28672
    v_mfma_f32_16x16x32_bf16 v[76:79], a[12:15], a[80:83], v[76:79]
    ds_read_b64_tr_b16 a[56:57], v14 offset:24576
    ds_read_b64_tr_b16 a[58:59], v14 offset:28672
    v_mfma_f32_16x16x32_bf16 v[108:111], a[12:15], a[84:87], v[108:111]
    ds_read_b64_tr_b16 a[60:61], v15 offset:24576
    ds_read_b64_tr_b16 a[62:63], v15 offset:28672
    s_waitcnt lgkmcnt(15)
    v_mfma_f32_16x16x32_bf16 v[80:83], a[16:19], a[80:83], v[80:83]
    v_mfma_f32_16x16x32_bf16 v[112:115], a[16:19], a[84:87], v[112:115]
    v_mfma_f32_16x16x32_bf16 v[84:87], a[20:23], a[80:83], v[84:87]
    v_mfma_f32_16x16x32_bf16 v[116:119], a[20:23], a[84:87], v[116:119]
    v_mfma_f32_16x16x32_bf16 v[88:91], a[24:27], a[80:83], v[88:91]
    v_mfma_f32_16x16x32_bf16 v[120:123], a[24:27], a[84:87], v[120:123]
    v_mfma_f32_16x16x32_bf16 v[92:95], a[28:31], a[80:83], v[92:95]
    v_mfma_f32_16x16x32_bf16 v[124:127], a[28:31], a[84:87], v[124:127]
    s_waitcnt lgkmcnt(0)
    v_mfma_f32_16x16x32_bf16 v[64:67], a[32:35], a[88:91], v[64:67]
    v_mfma_f32_16x16x32_bf16 v[96:99], a[32:35], a[92:95], v[96:99]
    s_waitcnt vmcnt(8)
    s_barrier
    v_mfma_f32_16x16x32_bf16 v[68:71], a[36:39], a[88:91], v[68:71]
    ds_read_b64_tr_b16 a[0:1], v8 offset:32768
    ds_read_b64_tr_b16 a[2:3], v8 offset:36864
    v_mfma_f32_16x16x32_bf16 v[100:103], a[36:39], a[92:95], v[100:103]
    ds_read_b64_tr_b16 a[4:5], v9 offset:32768
    ds_read_b64_tr_b16 a[6:7], v9 offset:36864
    v_mfma_f32_16x16x32_bf16 v[72:75], a[40:43], a[88:91], v[72:75]
    ds_read_b64_tr_b16 a[8:9], v10 offset:32768
    ds_read_b64_tr_b16 a[10:11], v10 offset:36864
    v_mfma_f32_16x16x32_bf16 v[104:107], a[40:43], a[92:95], v[104:107]
    ds_read_b64_tr_b16 a[12:13], v11 offset:32768
    ds_read_b64_tr_b16 a[14:15], v11 offset:36864
    v_mfma_f32_16x16x32_bf16 v[76:79], a[44:47], a[88:91], v[76:79]
    ds_read_b64_tr_b16 a[16:17], v12 offset:32768
    ds_read_b64_tr_b16 a[18:19], v12 offset:36864
    v_mfma_f32_16x16x32_bf16 v[108:111], a[44:47], a[92:95], v[108:111]
    ds_read_b64_tr_b16 a[20:21], v13 offset:32768
    ds_read_b64_tr_b16 a[22:23], v13 offset:36864
    v_mfma_f32_16x16x32_bf16 v[80:83], a[48:51], a[88:91], v[80:83]
    ds_read_b64_tr_b16 a[24:25], v14 offset:32768
    ds_read_b64_tr_b16 a[26:27], v14 offset:36864
    v_mfma_f32_16x16x32_bf16 v[112:115], a[48:51], a[92:95], v[112:115]
    ds_read_b64_tr_b16 a[28:29], v15 offset:32768
    ds_read_b64_tr_b16 a[30:31], v15 offset:36864
    v_mfma_f32_16x16x32_bf16 v[84:87], a[52:55], a[88:91], v[84:87]
    v_mfma_f32_16x16x32_bf16 v[116:119], a[52:55], a[92:95], v[116:119]
    v_mfma_f32_16x16x32_bf16 v[88:91], a[56:59], a[88:91], v[88:91]
    v_mfma_f32_16x16x32_bf16 v[120:123], a[56:59], a[92:95], v[120:123]
    v_mfma_f32_16x16x32_bf16 v[92:95], a[60:63], a[88:91], v[92:95]
    v_mfma_f32_16x16x32_bf16 v[124:127], a[60:63], a[92:95], v[124:127]
    s_waitcnt lgkmcnt(14)
    v_mfma_f32_16x16x32_bf16 v[64:67], a[0:3], a[96:99], v[64:67]
    ds_read_b64_tr_b16 a[32:33], v8 offset:40960
    ds_read_b64_tr_b16 a[34:35], v8 offset:45056
    v_mfma_f32_16x16x32_bf16 v[96:99], a[0:3], a[100:103], v[96:99]
    ds_read_b64_tr_b16 a[36:37], v9 offset:40960
    ds_read_b64_tr_b16 a[38:39], v9 offset:45056
    s_waitcnt lgkmcnt(15)
    v_mfma_f32_16x16x32_bf16 v[68:71], a[4:7], a[96:99], v[68:71]
    ds_read_b64_tr_b16 a[40:41], v10 offset:40960
    ds_read_b64_tr_b16 a[42:43], v10 offset:45056
    v_mfma_f32_16x16x32_bf16 v[100:103], a[4:7], a[100:103], v[100:103]
    ds_read_b64_tr_b16 a[44:45], v11 offset:40960
    ds_read_b64_tr_b16 a[46:47], v11 offset:45056
    s_waitcnt lgkmcnt(15)
    v_mfma_f32_16x16x32_bf16 v[72:75], a[8:11], a[96:99], v[72:75]
    ds_read_b64_tr_b16 a[48:49], v12 offset:40960
    ds_read_b64_tr_b16 a[50:51], v12 offset:45056
    v_mfma_f32_16x16x32_bf16 v[104:107], a[8:11], a[100:103], v[104:107]
    ds_read_b64_tr_b16 a[52:53], v13 offset:40960
    ds_read_b64_tr_b16 a[54:55], v13 offset:45056
    v_mfma_f32_16x16x32_bf16 v[76:79], a[12:15], a[96:99], v[76:79]
    ds_read_b64_tr_b16 a[56:57], v14 offset:40960
    ds_read_b64_tr_b16 a[58:59], v14 offset:45056
    v_mfma_f32_16x16x32_bf16 v[108:111], a[12:15], a[100:103], v[108:111]
    ds_read_b64_tr_b16 a[60:61], v15 offset:40960
    ds_read_b64_tr_b16 a[62:63], v15 offset:45056
    s_waitcnt lgkmcnt(15)
    v_mfma_f32_16x16x32_bf16 v[80:83], a[16:19], a[96:99], v[80:83]
    v_mfma_f32_16x16x32_bf16 v[112:115], a[16:19], a[100:103], v[112:115]
    v_mfma_f32_16x16x32_bf16 v[84:87], a[20:23], a[96:99], v[84:87]
    v_mfma_f32_16x16x32_bf16 v[116:119], a[20:23], a[100:103], v[116:119]
    v_mfma_f32_16x16x32_bf16 v[88:91], a[24:27], a[96:99], v[88:91]
    v_mfma_f32_16x16x32_bf16 v[120:123], a[24:27], a[100:103], v[120:123]
    v_mfma_f32_16x16x32_bf16 v[92:95], a[28:31], a[96:99], v[92:95]
    v_mfma_f32_16x16x32_bf16 v[124:127], a[28:31], a[100:103], v[124:127]
    s_waitcnt lgkmcnt(0)
    v_mfma_f32_16x16x32_bf16 v[64:67], a[32:35], a[104:107], v[64:67]
    v_mfma_f32_16x16x32_bf16 v[96:99], a[32:35], a[108:111], v[96:99]
    s_waitcnt vmcnt(0)
    s_barrier
    v_mfma_f32_16x16x32_bf16 v[68:71], a[36:39], a[104:107], v[68:71]
    ds_read_b64_tr_b16 a[0:1], v8 offset:49152
    ds_read_b64_tr_b16 a[2:3], v8 offset:53248
    v_mfma_f32_16x16x32_bf16 v[100:103], a[36:39], a[108:111], v[100:103]
    ds_read_b64_tr_b16 a[4:5], v9 offset:49152
    ds_read_b64_tr_b16 a[6:7], v9 offset:53248
    v_mfma_f32_16x16x32_bf16 v[72:75], a[40:43], a[104:107], v[72:75]
    ds_read_b64_tr_b16 a[8:9], v10 offset:49152
    ds_read_b64_tr_b16 a[10:11], v10 offset:53248
    v_mfma_f32_16x16x32_bf16 v[104:107], a[40:43], a[108:111], v[104:107]
    ds_read_b64_tr_b16 a[12:13], v11 offset:49152
    ds_read_b64_tr_b16 a[14:15], v11 offset:53248
    v_mfma_f32_16x16x32_bf16 v[76:79], a[44:47], a[104:107], v[76:79]
    ds_read_b64_tr_b16 a[16:17], v12 offset:49152
    ds_read_b64_tr_b16 a[18:19], v12 offset:53248
    v_mfma_f32_16x16x32_bf16 v[108:111], a[44:47], a[108:111], v[108:111]
    ds_read_b64_tr_b16 a[20:21], v13 offset:49152
    ds_read_b64_tr_b16 a[22:23], v13 offset:53248
    v_mfma_f32_16x16x32_bf16 v[80:83], a[48:51], a[104:107], v[80:83]
    ds_read_b64_tr_b16 a[24:25], v14 offset:49152
    ds_read_b64_tr_b16 a[26:27], v14 offset:53248
    v_mfma_f32_16x16x32_bf16 v[112:115], a[48:51], a[108:111], v[112:115]
    ds_read_b64_tr_b16 a[28:29], v15 offset:49152
    ds_read_b64_tr_b16 a[30:31], v15 offset:53248
    v_mfma_f32_16x16x32_bf16 v[84:87], a[52:55], a[104:107], v[84:87]
    v_mfma_f32_16x16x32_bf16 v[116:119], a[52:55], a[108:111], v[116:119]
    v_mfma_f32_16x16x32_bf16 v[88:91], a[56:59], a[104:107], v[88:91]
    v_mfma_f32_16x16x32_bf16 v[120:123], a[56:59], a[108:111], v[120:123]
    v_mfma_f32_16x16x32_bf16 v[92:95], a[60:63], a[104:107], v[92:95]
    v_mfma_f32_16x16x32_bf16 v[124:127], a[60:63], a[108:111], v[124:127]
    s_waitcnt lgkmcnt(14)
    v_mfma_f32_16x16x32_bf16 v[64:67], a[0:3], a[112:115], v[64:67]
    ds_read_b64_tr_b16 a[32:33], v8 offset:57344
    ds_read_b64_tr_b16 a[34:35], v8 offset:61440
    v_mfma_f32_16x16x32_bf16 v[96:99], a[0:3], a[116:119], v[96:99]
    ds_read_b64_tr_b16 a[36:37], v9 offset:57344
    ds_read_b64_tr_b16 a[38:39], v9 offset:61440
    s_waitcnt lgkmcnt(15)
    v_mfma_f32_16x16x32_bf16 v[68:71], a[4:7], a[112:115], v[68:71]
    ds_read_b64_tr_b16 a[40:41], v10 offset:57344
    ds_read_b64_tr_b16 a[42:43], v10 offset:61440
    v_mfma_f32_16x16x32_bf16 v[100:103], a[4:7], a[116:119], v[100:103]
    ds_read_b64_tr_b16 a[44:45], v11 offset:57344
    ds_read_b64_tr_b16 a[46:47], v11 offset:61440
    s_waitcnt lgkmcnt(15)
    v_mfma_f32_16x16x32_bf16 v[72:75], a[8:11], a[112:115], v[72:75]
    ds_read_b64_tr_b16 a[48:49], v12 offset:57344
    ds_read_b64_tr_b16 a[50:51], v12 offset:61440
    v_mfma_f32_16x16x32_bf16 v[104:107], a[8:11], a[116:119], v[104:107]
    ds_read_b64_tr_b16 a[52:53], v13 offset:57344
    ds_read_b64_tr_b16 a[54:55], v13 offset:61440
    v_mfma_f32_16x16x32_bf16 v[76:79], a[12:15], a[112:115], v[76:79]
    ds_read_b64_tr_b16 a[56:57], v14 offset:57344
    ds_read_b64_tr_b16 a[58:59], v14 offset:61440
    v_mfma_f32_16x16x32_bf16 v[108:111], a[12:15], a[116:119], v[108:111]
    ds_read_b64_tr_b16 a[60:61], v15 offset:57344
    ds_read_b64_tr_b16 a[62:63], v15 offset:61440
    s_waitcnt lgkmcnt(15)
    v_mfma_f32_16x16x32_bf16 v[80:83], a[16:19], a[112:115], v[80:83]
    v_mfma_f32_16x16x32_bf16 v[112:115], a[16:19], a[116:119], v[112:115]
    v_mfma_f32_16x16x32_bf16 v[84:87], a[20:23], a[112:115], v[84:87]
    v_mfma_f32_16x16x32_bf16 v[116:119], a[20:23], a[116:119], v[116:119]
    v_mfma_f32_16x16x32_bf16 v[88:91], a[24:27], a[112:115], v[88:91]
    v_mfma_f32_16x16x32_bf16 v[120:123], a[24:27], a[116:119], v[120:123]
    v_mfma_f32_16x16x32_bf16 v[92:95], a[28:31], a[112:115], v[92:95]
    v_mfma_f32_16x16x32_bf16 v[124:127], a[28:31], a[116:119], v[124:127]
    s_waitcnt lgkmcnt(0)
    v_mfma_f32_16x16x32_bf16 v[64:67], a[32:35], a[120:123], v[64:67]
    v_mfma_f32_16x16x32_bf16 v[96:99], a[32:35], a[124:127], v[96:99]
    v_mfma_f32_16x16x32_bf16 v[68:71], a[36:39], a[120:123], v[68:71]
    v_mfma_f32_16x16x32_bf16 v[100:103], a[36:39], a[124:127], v[100:103]
    v_mfma_f32_16x16x32_bf16 v[72:75], a[40:43], a[120:123], v[72:75]
    v_mfma_f32_16x16x32_bf16 v[104:107], a[40:43], a[124:127], v[104:107]
    v_mfma_f32_16x16x32_bf16 v[76:79], a[44:47], a[120:123], v[76:79]
    v_mfma_f32_16x16x32_bf16 v[108:111], a[44:47], a[124:127], v[108:111]
    v_mfma_f32_16x16x32_bf16 v[80:83], a[48:51], a[120:123], v[80:83]
    v_mfma_f32_16x16x32_bf16 v[112:115], a[48:51], a[124:127], v[112:115]
    v_mfma_f32_16x16x32_bf16 v[84:87], a[52:55], a[120:123], v[84:87]
    v_mfma_f32_16x16x32_bf16 v[116:119], a[52:55], a[124:127], v[116:119]
    v_mfma_f32_16x16x32_bf16 v[88:91], a[56:59], a[120:123], v[88:91]
    v_mfma_f32_16x16x32_bf16 v[120:123], a[56:59], a[124:127], v[120:123]
    v_mfma_f32_16x16x32_bf16 v[92:95], a[60:63], a[120:123], v[92:95]
    v_mfma_f32_16x16x32_bf16 v[124:127], a[60:63], a[124:127], v[124:127]
    s_cmp_eq_u32 s33, 2
    s_cbranch_scc1 attn_kernel_o_gate
    s_nop 7
    buffer_store_dwordx4 v[96:99], v2, s[20:23], s42 offen offset:0 sc1
    buffer_store_dwordx4 v[100:103], v2, s[20:23], s42 offen offset:1024 sc1
    buffer_store_dwordx4 v[104:107], v2, s[20:23], s42 offen offset:2048 sc1
    buffer_store_dwordx4 v[108:111], v2, s[20:23], s42 offen offset:3072 sc1
    s_add_u32 s48, s42, 4096
    buffer_store_dwordx4 v[112:115], v2, s[20:23], s48 offen offset:0 sc1
    buffer_store_dwordx4 v[116:119], v2, s[20:23], s48 offen offset:1024 sc1
    buffer_store_dwordx4 v[120:123], v2, s[20:23], s48 offen offset:2048 sc1
    buffer_store_dwordx4 v[124:127], v2, s[20:23], s48 offen offset:3072 sc1
    s_waitcnt vmcnt(0)
    s_barrier
    s_cmp_lg_u32 s32, 0
    s_cbranch_scc1 attn_kernel_o_nofl
    v_mov_b32 v16, s3
    s_mov_b64 exec, 1
    buffer_store_dword v16, off, s[28:31], s45 sc1
    s_mov_b64 exec, -1
attn_kernel_o_nofl:
    s_mov_b32 s39, 0x4000
attn_kernel_o_poll:
    buffer_load_dword v16, off, s[28:31], s46 sc1
    buffer_load_dword v17, off, s[28:31], s47 sc1
    s_waitcnt vmcnt(0)
    v_xor_b32 v16, s3, v16
    v_xor_b32 v17, s3, v17
    v_or_b32 v16, v16, v17
    s_nop 0
    v_readfirstlane_b32 s48, v16
    s_cmp_eq_u32 s48, 0
    s_cbranch_scc1 attn_kernel_o_got
    s_sub_u32 s39, s39, 1
    s_cmp_lg_u32 s39, 0
    s_cbranch_scc1 attn_kernel_o_poll
attn_kernel_o_got:
    buffer_load_dwordx4 v[96:99], v2, s[20:23], s43 offen offset:0 sc1
    buffer_load_dwordx4 v[100:103], v2, s[20:23], s43 offen offset:1024 sc1
    buffer_load_dwordx4 v[32:35], v2, s[24:27], s44 offen offset:0 sc1
    buffer_load_dwordx4 v[104:107], v2, s[20:23], s43 offen offset:2048 sc1
    buffer_load_dwordx4 v[108:111], v2, s[20:23], s43 offen offset:3072 sc1
    buffer_load_dwordx4 v[36:39], v2, s[24:27], s44 offen offset:1024 sc1
    s_add_u32 s48, s43, 4096
    buffer_load_dwordx4 v[112:115], v2, s[20:23], s48 offen offset:0 sc1
    buffer_load_dwordx4 v[116:119], v2, s[20:23], s48 offen offset:1024 sc1
    buffer_load_dwordx4 v[40:43], v2, s[24:27], s44 offen offset:2048 sc1
    buffer_load_dwordx4 v[120:123], v2, s[20:23], s48 offen offset:2048 sc1
    buffer_load_dwordx4 v[124:127], v2, s[20:23], s48 offen offset:3072 sc1
    buffer_load_dwordx4 v[44:47], v2, s[24:27], s44 offen offset:3072 sc1
    s_waitcnt vmcnt(9)
    v_add_f32 v64, v64, v96
    v_add_f32 v65, v65, v97
    v_add_f32 v66, v66, v98
    v_add_f32 v67, v67, v99
    v_lshlrev_b32 v16, 16, v32
    v_and_b32 v17, 0xffff0000, v32
    v_lshlrev_b32 v18, 16, v33
    v_and_b32 v19, 0xffff0000, v33
    v_lshlrev_b32 v20, 16, v48
    v_and_b32 v21, 0xffff0000, v48
    v_lshlrev_b32 v22, 16, v49
    v_and_b32 v23, 0xffff0000, v49
    v_fmac_f32 v20, v16, v64
    v_fmac_f32 v21, v17, v65
    v_fmac_f32 v22, v18, v66
    v_fmac_f32 v23, v19, v67
    v_cvt_pk_bf16_f32 v24, v20, v21
    v_cvt_pk_bf16_f32 v25, v22, v23
    v_add_f32 v68, v68, v100
    v_add_f32 v69, v69, v101
    v_add_f32 v70, v70, v102
    v_add_f32 v71, v71, v103
    v_lshlrev_b32 v16, 16, v34
    v_and_b32 v17, 0xffff0000, v34
    v_lshlrev_b32 v18, 16, v35
    v_and_b32 v19, 0xffff0000, v35
    v_lshlrev_b32 v20, 16, v50
    v_and_b32 v21, 0xffff0000, v50
    v_lshlrev_b32 v22, 16, v51
    v_and_b32 v23, 0xffff0000, v51
    v_fmac_f32 v20, v16, v68
    v_fmac_f32 v21, v17, v69
    v_fmac_f32 v22, v18, v70
    v_fmac_f32 v23, v19, v71
    v_cvt_pk_bf16_f32 v26, v20, v21
    v_cvt_pk_bf16_f32 v27, v22, v23
    buffer_store_dwordx2 v[24:25], v3, s[16:19], 0 offen offset:0
    buffer_store_dwordx2 v[26:27], v3, s[16:19], 0 offen offset:32
    s_nop 0
    s_waitcnt vmcnt(8)
    v_add_f32 v72, v72, v104
    v_add_f32 v73, v73, v105
    v_add_f32 v74, v74, v106
    v_add_f32 v75, v75, v107
    v_lshlrev_b32 v16, 16, v36
    v_and_b32 v17, 0xffff0000, v36
    v_lshlrev_b32 v18, 16, v37
    v_and_b32 v19, 0xffff0000, v37
    v_lshlrev_b32 v20, 16, v52
    v_and_b32 v21, 0xffff0000, v52
    v_lshlrev_b32 v22, 16, v53
    v_and_b32 v23, 0xffff0000, v53
    v_fmac_f32 v20, v16, v72
    v_fmac_f32 v21, v17, v73
    v_fmac_f32 v22, v18, v74
    v_fmac_f32 v23, v19, v75
    v_cvt_pk_bf16_f32 v24, v20, v21
    v_cvt_pk_bf16_f32 v25, v22, v23
    v_add_f32 v76, v76, v108
    v_add_f32 v77, v77, v109
    v_add_f32 v78, v78, v110
    v_add_f32 v79, v79, v111
    v_lshlrev_b32 v16, 16, v38
    v_and_b32 v17, 0xffff0000, v38
    v_lshlrev_b32 v18, 16, v39
    v_and_b32 v19, 0xffff0000, v39
    v_lshlrev_b32 v20, 16, v54
    v_and_b32 v21, 0xffff0000, v54
    v_lshlrev_b32 v22, 16, v55
    v_and_b32 v23, 0xffff0000, v55
    v_fmac_f32 v20, v16, v76
    v_fmac_f32 v21, v17, v77
    v_fmac_f32 v22, v18, v78
    v_fmac_f32 v23, v19, v79
    v_cvt_pk_bf16_f32 v26, v20, v21
    v_cvt_pk_bf16_f32 v27, v22, v23
    buffer_store_dwordx2 v[24:25], v3, s[16:19], 0 offen offset:64
    buffer_store_dwordx2 v[26:27], v3, s[16:19], 0 offen offset:96
    s_nop 0
    s_waitcnt vmcnt(7)
    v_add_f32 v80, v80, v112
    v_add_f32 v81, v81, v113
    v_add_f32 v82, v82, v114
    v_add_f32 v83, v83, v115
    v_lshlrev_b32 v16, 16, v40
    v_and_b32 v17, 0xffff0000, v40
    v_lshlrev_b32 v18, 16, v41
    v_and_b32 v19, 0xffff0000, v41
    v_lshlrev_b32 v20, 16, v56
    v_and_b32 v21, 0xffff0000, v56
    v_lshlrev_b32 v22, 16, v57
    v_and_b32 v23, 0xffff0000, v57
    v_fmac_f32 v20, v16, v80
    v_fmac_f32 v21, v17, v81
    v_fmac_f32 v22, v18, v82
    v_fmac_f32 v23, v19, v83
    v_cvt_pk_bf16_f32 v24, v20, v21
    v_cvt_pk_bf16_f32 v25, v22, v23
    v_add_f32 v84, v84, v116
    v_add_f32 v85, v85, v117
    v_add_f32 v86, v86, v118
    v_add_f32 v87, v87, v119
    v_lshlrev_b32 v16, 16, v42
    v_and_b32 v17, 0xffff0000, v42
    v_lshlrev_b32 v18, 16, v43
    v_and_b32 v19, 0xffff0000, v43
    v_lshlrev_b32 v20, 16, v58
    v_and_b32 v21, 0xffff0000, v58
    v_lshlrev_b32 v22, 16, v59
    v_and_b32 v23, 0xffff0000, v59
    v_fmac_f32 v20, v16, v84
    v_fmac_f32 v21, v17, v85
    v_fmac_f32 v22, v18, v86
    v_fmac_f32 v23, v19, v87
    v_cvt_pk_bf16_f32 v26, v20, v21
    v_cvt_pk_bf16_f32 v27, v22, v23
    buffer_store_dwordx2 v[24:25], v3, s[16:19], 0 offen offset:128
    buffer_store_dwordx2 v[26:27], v3, s[16:19], 0 offen offset:160
    s_nop 0
    s_waitcnt vmcnt(6)
    v_add_f32 v88, v88, v120
    v_add_f32 v89, v89, v121
    v_add_f32 v90, v90, v122
    v_add_f32 v91, v91, v123
    v_lshlrev_b32 v16, 16, v44
    v_and_b32 v17, 0xffff0000, v44
    v_lshlrev_b32 v18, 16, v45
    v_and_b32 v19, 0xffff0000, v45
    v_lshlrev_b32 v20, 16, v60
    v_and_b32 v21, 0xffff0000, v60
    v_lshlrev_b32 v22, 16, v61
    v_and_b32 v23, 0xffff0000, v61
    v_fmac_f32 v20, v16, v88
    v_fmac_f32 v21, v17, v89
    v_fmac_f32 v22, v18, v90
    v_fmac_f32 v23, v19, v91
    v_cvt_pk_bf16_f32 v24, v20, v21
    v_cvt_pk_bf16_f32 v25, v22, v23
    v_add_f32 v92, v92, v124
    v_add_f32 v93, v93, v125
    v_add_f32 v94, v94, v126
    v_add_f32 v95, v95, v127
    v_lshlrev_b32 v16, 16, v46
    v_and_b32 v17, 0xffff0000, v46
    v_lshlrev_b32 v18, 16, v47
    v_and_b32 v19, 0xffff0000, v47
    v_lshlrev_b32 v20, 16, v62
    v_and_b32 v21, 0xffff0000, v62
    v_lshlrev_b32 v22, 16, v63
    v_and_b32 v23, 0xffff0000, v63
    v_fmac_f32 v20, v16, v92
    v_fmac_f32 v21, v17, v93
    v_fmac_f32 v22, v18, v94
    v_fmac_f32 v23, v19, v95
    v_cvt_pk_bf16_f32 v26, v20, v21
    v_cvt_pk_bf16_f32 v27, v22, v23
    buffer_store_dwordx2 v[24:25], v3, s[16:19], 0 offen offset:192
    buffer_store_dwordx2 v[26:27], v3, s[16:19], 0 offen offset:224
    s_nop 0
    s_branch attn_kernel_o_fin
attn_kernel_o_gate:
    s_nop 7
    v_lshlrev_b32 v32, 16, v48
    v_and_b32 v33, 0xffff0000, v48
    v_lshlrev_b32 v34, 16, v49
    v_and_b32 v35, 0xffff0000, v49
    v_add_f32 v64, v64, v32
    v_add_f32 v65, v65, v33
    v_add_f32 v66, v66, v34
    v_add_f32 v67, v67, v35
    v_mul_f32 v16, 0xbfb8aa3b, v64
    v_mul_f32 v17, 0xbfb8aa3b, v65
    v_mul_f32 v18, 0xbfb8aa3b, v66
    v_mul_f32 v19, 0xbfb8aa3b, v67
    v_exp_f32 v16, v16
    v_exp_f32 v17, v17
    v_exp_f32 v18, v18
    v_exp_f32 v19, v19
    v_add_f32 v96, v96, v32
    v_add_f32 v97, v97, v33
    v_add_f32 v98, v98, v34
    v_add_f32 v99, v99, v35
    v_mul_f32 v20, 0xbfb8aa3b, v96
    v_mul_f32 v21, 0xbfb8aa3b, v97
    v_mul_f32 v22, 0xbfb8aa3b, v98
    v_mul_f32 v23, 0xbfb8aa3b, v99
    v_exp_f32 v20, v20
    v_exp_f32 v21, v21
    v_exp_f32 v22, v22
    v_exp_f32 v23, v23
    v_add_f32 v16, 1.0, v16
    v_add_f32 v17, 1.0, v17
    v_add_f32 v18, 1.0, v18
    v_add_f32 v19, 1.0, v19
    v_add_f32 v20, 1.0, v20
    v_add_f32 v21, 1.0, v21
    v_add_f32 v22, 1.0, v22
    v_add_f32 v23, 1.0, v23
    v_rcp_f32 v16, v16
    v_rcp_f32 v17, v17
    v_rcp_f32 v18, v18
    v_rcp_f32 v19, v19
    v_rcp_f32 v20, v20
    v_rcp_f32 v21, v21
    v_rcp_f32 v22, v22
    v_rcp_f32 v23, v23
    v_mul_f32 v64, v64, v16
    v_mul_f32 v65, v65, v17
    v_mul_f32 v66, v66, v18
    v_mul_f32 v67, v67, v19
    v_mul_f32 v96, v96, v20
    v_mul_f32 v97, v97, v21
    v_mul_f32 v98, v98, v22
    v_mul_f32 v99, v99, v23
    v_cvt_pk_bf16_f32 v40, v64, v65
    v_cvt_pk_bf16_f32 v41, v66, v67
    v_cvt_pk_bf16_f32 v44, v96, v97
    v_cvt_pk_bf16_f32 v45, v98, v99
    v_lshlrev_b32 v36, 16, v50
    v_and_b32 v37, 0xffff0000, v50
    v_lshlrev_b32 v38, 16, v51
    v_and_b32 v39, 0xffff0000, v51
    v_add_f32 v68, v68, v36
    v_add_f32 v69, v69, v37
    v_add_f32 v70, v70, v38
    v_add_f32 v71, v71, v39
    v_mul_f32 v16, 0xbfb8aa3b, v68
    v_mul_f32 v17, 0xbfb8aa3b, v69
    v_mul_f32 v18, 0xbfb8aa3b, v70
    v_mul_f32 v19, 0xbfb8aa3b, v71
    v_exp_f32 v16, v16
    v_exp_f32 v17, v17
    v_exp_f32 v18, v18
    v_exp_f32 v19, v19
    v_add_f32 v100, v100, v36
    v_add_f32 v101, v101, v37
    v_add_f32 v102, v102, v38
    v_add_f32 v103, v103, v39
    v_mul_f32 v20, 0xbfb8aa3b, v100
    v_mul_f32 v21, 0xbfb8aa3b, v101
    v_mul_f32 v22, 0xbfb8aa3b, v102
    v_mul_f32 v23, 0xbfb8aa3b, v103
    v_exp_f32 v20, v20
    v_exp_f32 v21, v21
    v_exp_f32 v22, v22
    v_exp_f32 v23, v23
    v_add_f32 v16, 1.0, v16
    v_add_f32 v17, 1.0, v17
    v_add_f32 v18, 1.0, v18
    v_add_f32 v19, 1.0, v19
    v_add_f32 v20, 1.0, v20
    v_add_f32 v21, 1.0, v21
    v_add_f32 v22, 1.0, v22
    v_add_f32 v23, 1.0, v23
    v_rcp_f32 v16, v16
    v_rcp_f32 v17, v17
    v_rcp_f32 v18, v18
    v_rcp_f32 v19, v19
    v_rcp_f32 v20, v20
    v_rcp_f32 v21, v21
    v_rcp_f32 v22, v22
    v_rcp_f32 v23, v23
    v_mul_f32 v68, v68, v16
    v_mul_f32 v69, v69, v17
    v_mul_f32 v70, v70, v18
    v_mul_f32 v71, v71, v19
    v_mul_f32 v100, v100, v20
    v_mul_f32 v101, v101, v21
    v_mul_f32 v102, v102, v22
    v_mul_f32 v103, v103, v23
    v_cvt_pk_bf16_f32 v42, v68, v69
    v_cvt_pk_bf16_f32 v43, v70, v71
    v_cvt_pk_bf16_f32 v46, v100, v101
    v_cvt_pk_bf16_f32 v47, v102, v103
    buffer_store_dwordx4 v[40:43], v2, s[24:27], s44 offen offset:0 sc1
    s_add_u32 s48, s44, 16384
    buffer_store_dwordx4 v[44:47], v2, s[24:27], s48 offen offset:0 sc1
    s_nop 1
    v_lshlrev_b32 v32, 16, v52
    v_and_b32 v33, 0xffff0000, v52
    v_lshlrev_b32 v34, 16, v53
    v_and_b32 v35, 0xffff0000, v53
    v_add_f32 v72, v72, v32
    v_add_f32 v73, v73, v33
    v_add_f32 v74, v74, v34
    v_add_f32 v75, v75, v35
    v_mul_f32 v16, 0xbfb8aa3b, v72
    v_mul_f32 v17, 0xbfb8aa3b, v73
    v_mul_f32 v18, 0xbfb8aa3b, v74
    v_mul_f32 v19, 0xbfb8aa3b, v75
    v_exp_f32 v16, v16
    v_exp_f32 v17, v17
    v_exp_f32 v18, v18
    v_exp_f32 v19, v19
    v_add_f32 v104, v104, v32
    v_add_f32 v105, v105, v33
    v_add_f32 v106, v106, v34
    v_add_f32 v107, v107, v35
    v_mul_f32 v20, 0xbfb8aa3b, v104
    v_mul_f32 v21, 0xbfb8aa3b, v105
    v_mul_f32 v22, 0xbfb8aa3b, v106
    v_mul_f32 v23, 0xbfb8aa3b, v107
    v_exp_f32 v20, v20
    v_exp_f32 v21, v21
    v_exp_f32 v22, v22
    v_exp_f32 v23, v23
    v_add_f32 v16, 1.0, v16
    v_add_f32 v17, 1.0, v17
    v_add_f32 v18, 1.0, v18
    v_add_f32 v19, 1.0, v19
    v_add_f32 v20, 1.0, v20
    v_add_f32 v21, 1.0, v21
    v_add_f32 v22, 1.0, v22
    v_add_f32 v23, 1.0, v23
    v_rcp_f32 v16, v16
    v_rcp_f32 v17, v17
    v_rcp_f32 v18, v18
    v_rcp_f32 v19, v19
    v_rcp_f32 v20, v20
    v_rcp_f32 v21, v21
    v_rcp_f32 v22, v22
    v_rcp_f32 v23, v23
    v_mul_f32 v72, v72, v16
    v_mul_f32 v73, v73, v17
    v_mul_f32 v74, v74, v18
    v_mul_f32 v75, v75, v19
    v_mul_f32 v104, v104, v20
    v_mul_f32 v105, v105, v21
    v_mul_f32 v106, v106, v22
    v_mul_f32 v107, v107, v23
    v_cvt_pk_bf16_f32 v40, v72, v73
    v_cvt_pk_bf16_f32 v41, v74, v75
    v_cvt_pk_bf16_f32 v44, v104, v105
    v_cvt_pk_bf16_f32 v45, v106, v107
    v_lshlrev_b32 v36, 16, v54
    v_and_b32 v37, 0xffff0000, v54
    v_lshlrev_b32 v38, 16, v55
    v_and_b32 v39, 0xffff0000, v55
    v_add_f32 v76, v76, v36
    v_add_f32 v77, v77, v37
    v_add_f32 v78, v78, v38
    v_add_f32 v79, v79, v39
    v_mul_f32 v16, 0xbfb8aa3b, v76
    v_mul_f32 v17, 0xbfb8aa3b, v77
    v_mul_f32 v18, 0xbfb8aa3b, v78
    v_mul_f32 v19, 0xbfb8aa3b, v79
    v_exp_f32 v16, v16
    v_exp_f32 v17, v17
    v_exp_f32 v18, v18
    v_exp_f32 v19, v19
    v_add_f32 v108, v108, v36
    v_add_f32 v109, v109, v37
    v_add_f32 v110, v110, v38
    v_add_f32 v111, v111, v39
    v_mul_f32 v20, 0xbfb8aa3b, v108
    v_mul_f32 v21, 0xbfb8aa3b, v109
    v_mul_f32 v22, 0xbfb8aa3b, v110
    v_mul_f32 v23, 0xbfb8aa3b, v111
    v_exp_f32 v20, v20
    v_exp_f32 v21, v21
    v_exp_f32 v22, v22
    v_exp_f32 v23, v23
    v_add_f32 v16, 1.0, v16
    v_add_f32 v17, 1.0, v17
    v_add_f32 v18, 1.0, v18
    v_add_f32 v19, 1.0, v19
    v_add_f32 v20, 1.0, v20
    v_add_f32 v21, 1.0, v21
    v_add_f32 v22, 1.0, v22
    v_add_f32 v23, 1.0, v23
    v_rcp_f32 v16, v16
    v_rcp_f32 v17, v17
    v_rcp_f32 v18, v18
    v_rcp_f32 v19, v19
    v_rcp_f32 v20, v20
    v_rcp_f32 v21, v21
    v_rcp_f32 v22, v22
    v_rcp_f32 v23, v23
    v_mul_f32 v76, v76, v16
    v_mul_f32 v77, v77, v17
    v_mul_f32 v78, v78, v18
    v_mul_f32 v79, v79, v19
    v_mul_f32 v108, v108, v20
    v_mul_f32 v109, v109, v21
    v_mul_f32 v110, v110, v22
    v_mul_f32 v111, v111, v23
    v_cvt_pk_bf16_f32 v42, v76, v77
    v_cvt_pk_bf16_f32 v43, v78, v79
    v_cvt_pk_bf16_f32 v46, v108, v109
    v_cvt_pk_bf16_f32 v47, v110, v111
    buffer_store_dwordx4 v[40:43], v2, s[24:27], s44 offen offset:1024 sc1
    buffer_store_dwordx4 v[44:47], v2, s[24:27], s48 offen offset:1024 sc1
    s_nop 1
    v_lshlrev_b32 v32, 16, v56
    v_and_b32 v33, 0xffff0000, v56
    v_lshlrev_b32 v34, 16, v57
    v_and_b32 v35, 0xffff0000, v57
    v_add_f32 v80, v80, v32
    v_add_f32 v81, v81, v33
    v_add_f32 v82, v82, v34
    v_add_f32 v83, v83, v35
    v_mul_f32 v16, 0xbfb8aa3b, v80
    v_mul_f32 v17, 0xbfb8aa3b, v81
    v_mul_f32 v18, 0xbfb8aa3b, v82
    v_mul_f32 v19, 0xbfb8aa3b, v83
    v_exp_f32 v16, v16
    v_exp_f32 v17, v17
    v_exp_f32 v18, v18
    v_exp_f32 v19, v19
    v_add_f32 v112, v112, v32
    v_add_f32 v113, v113, v33
    v_add_f32 v114, v114, v34
    v_add_f32 v115, v115, v35
    v_mul_f32 v20, 0xbfb8aa3b, v112
    v_mul_f32 v21, 0xbfb8aa3b, v113
    v_mul_f32 v22, 0xbfb8aa3b, v114
    v_mul_f32 v23, 0xbfb8aa3b, v115
    v_exp_f32 v20, v20
    v_exp_f32 v21, v21
    v_exp_f32 v22, v22
    v_exp_f32 v23, v23
    v_add_f32 v16, 1.0, v16
    v_add_f32 v17, 1.0, v17
    v_add_f32 v18, 1.0, v18
    v_add_f32 v19, 1.0, v19
    v_add_f32 v20, 1.0, v20
    v_add_f32 v21, 1.0, v21
    v_add_f32 v22, 1.0, v22
    v_add_f32 v23, 1.0, v23
    v_rcp_f32 v16, v16
    v_rcp_f32 v17, v17
    v_rcp_f32 v18, v18
    v_rcp_f32 v19, v19
    v_rcp_f32 v20, v20
    v_rcp_f32 v21, v21
    v_rcp_f32 v22, v22
    v_rcp_f32 v23, v23
    v_mul_f32 v80, v80, v16
    v_mul_f32 v81, v81, v17
    v_mul_f32 v82, v82, v18
    v_mul_f32 v83, v83, v19
    v_mul_f32 v112, v112, v20
    v_mul_f32 v113, v113, v21
    v_mul_f32 v114, v114, v22
    v_mul_f32 v115, v115, v23
    v_cvt_pk_bf16_f32 v40, v80, v81
    v_cvt_pk_bf16_f32 v41, v82, v83
    v_cvt_pk_bf16_f32 v44, v112, v113
    v_cvt_pk_bf16_f32 v45, v114, v115
    v_lshlrev_b32 v36, 16, v58
    v_and_b32 v37, 0xffff0000, v58
    v_lshlrev_b32 v38, 16, v59
    v_and_b32 v39, 0xffff0000, v59
    v_add_f32 v84, v84, v36
    v_add_f32 v85, v85, v37
    v_add_f32 v86, v86, v38
    v_add_f32 v87, v87, v39
    v_mul_f32 v16, 0xbfb8aa3b, v84
    v_mul_f32 v17, 0xbfb8aa3b, v85
    v_mul_f32 v18, 0xbfb8aa3b, v86
    v_mul_f32 v19, 0xbfb8aa3b, v87
    v_exp_f32 v16, v16
    v_exp_f32 v17, v17
    v_exp_f32 v18, v18
    v_exp_f32 v19, v19
    v_add_f32 v116, v116, v36
    v_add_f32 v117, v117, v37
    v_add_f32 v118, v118, v38
    v_add_f32 v119, v119, v39
    v_mul_f32 v20, 0xbfb8aa3b, v116
    v_mul_f32 v21, 0xbfb8aa3b, v117
    v_mul_f32 v22, 0xbfb8aa3b, v118
    v_mul_f32 v23, 0xbfb8aa3b, v119
    v_exp_f32 v20, v20
    v_exp_f32 v21, v21
    v_exp_f32 v22, v22
    v_exp_f32 v23, v23
    v_add_f32 v16, 1.0, v16
    v_add_f32 v17, 1.0, v17
    v_add_f32 v18, 1.0, v18
    v_add_f32 v19, 1.0, v19
    v_add_f32 v20, 1.0, v20
    v_add_f32 v21, 1.0, v21
    v_add_f32 v22, 1.0, v22
    v_add_f32 v23, 1.0, v23
    v_rcp_f32 v16, v16
    v_rcp_f32 v17, v17
    v_rcp_f32 v18, v18
    v_rcp_f32 v19, v19
    v_rcp_f32 v20, v20
    v_rcp_f32 v21, v21
    v_rcp_f32 v22, v22
    v_rcp_f32 v23, v23
    v_mul_f32 v84, v84, v16
    v_mul_f32 v85, v85, v17
    v_mul_f32 v86, v86, v18
    v_mul_f32 v87, v87, v19
    v_mul_f32 v116, v116, v20
    v_mul_f32 v117, v117, v21
    v_mul_f32 v118, v118, v22
    v_mul_f32 v119, v119, v23
    v_cvt_pk_bf16_f32 v42, v84, v85
    v_cvt_pk_bf16_f32 v43, v86, v87
    v_cvt_pk_bf16_f32 v46, v116, v117
    v_cvt_pk_bf16_f32 v47, v118, v119
    buffer_store_dwordx4 v[40:43], v2, s[24:27], s44 offen offset:2048 sc1
    buffer_store_dwordx4 v[44:47], v2, s[24:27], s48 offen offset:2048 sc1
    s_nop 1
    v_lshlrev_b32 v32, 16, v60
    v_and_b32 v33, 0xffff0000, v60
    v_lshlrev_b32 v34, 16, v61
    v_and_b32 v35, 0xffff0000, v61
    v_add_f32 v88, v88, v32
    v_add_f32 v89, v89, v33
    v_add_f32 v90, v90, v34
    v_add_f32 v91, v91, v35
    v_mul_f32 v16, 0xbfb8aa3b, v88
    v_mul_f32 v17, 0xbfb8aa3b, v89
    v_mul_f32 v18, 0xbfb8aa3b, v90
    v_mul_f32 v19, 0xbfb8aa3b, v91
    v_exp_f32 v16, v16
    v_exp_f32 v17, v17
    v_exp_f32 v18, v18
    v_exp_f32 v19, v19
    v_add_f32 v120, v120, v32
    v_add_f32 v121, v121, v33
    v_add_f32 v122, v122, v34
    v_add_f32 v123, v123, v35
    v_mul_f32 v20, 0xbfb8aa3b, v120
    v_mul_f32 v21, 0xbfb8aa3b, v121
    v_mul_f32 v22, 0xbfb8aa3b, v122
    v_mul_f32 v23, 0xbfb8aa3b, v123
    v_exp_f32 v20, v20
    v_exp_f32 v21, v21
    v_exp_f32 v22, v22
    v_exp_f32 v23, v23
    v_add_f32 v16, 1.0, v16
    v_add_f32 v17, 1.0, v17
    v_add_f32 v18, 1.0, v18
    v_add_f32 v19, 1.0, v19
    v_add_f32 v20, 1.0, v20
    v_add_f32 v21, 1.0, v21
    v_add_f32 v22, 1.0, v22
    v_add_f32 v23, 1.0, v23
    v_rcp_f32 v16, v16
    v_rcp_f32 v17, v17
    v_rcp_f32 v18, v18
    v_rcp_f32 v19, v19
    v_rcp_f32 v20, v20
    v_rcp_f32 v21, v21
    v_rcp_f32 v22, v22
    v_rcp_f32 v23, v23
    v_mul_f32 v88, v88, v16
    v_mul_f32 v89, v89, v17
    v_mul_f32 v90, v90, v18
    v_mul_f32 v91, v91, v19
    v_mul_f32 v120, v120, v20
    v_mul_f32 v121, v121, v21
    v_mul_f32 v122, v122, v22
    v_mul_f32 v123, v123, v23
    v_cvt_pk_bf16_f32 v40, v88, v89
    v_cvt_pk_bf16_f32 v41, v90, v91
    v_cvt_pk_bf16_f32 v44, v120, v121
    v_cvt_pk_bf16_f32 v45, v122, v123
    v_lshlrev_b32 v36, 16, v62
    v_and_b32 v37, 0xffff0000, v62
    v_lshlrev_b32 v38, 16, v63
    v_and_b32 v39, 0xffff0000, v63
    v_add_f32 v92, v92, v36
    v_add_f32 v93, v93, v37
    v_add_f32 v94, v94, v38
    v_add_f32 v95, v95, v39
    v_mul_f32 v16, 0xbfb8aa3b, v92
    v_mul_f32 v17, 0xbfb8aa3b, v93
    v_mul_f32 v18, 0xbfb8aa3b, v94
    v_mul_f32 v19, 0xbfb8aa3b, v95
    v_exp_f32 v16, v16
    v_exp_f32 v17, v17
    v_exp_f32 v18, v18
    v_exp_f32 v19, v19
    v_add_f32 v124, v124, v36
    v_add_f32 v125, v125, v37
    v_add_f32 v126, v126, v38
    v_add_f32 v127, v127, v39
    v_mul_f32 v20, 0xbfb8aa3b, v124
    v_mul_f32 v21, 0xbfb8aa3b, v125
    v_mul_f32 v22, 0xbfb8aa3b, v126
    v_mul_f32 v23, 0xbfb8aa3b, v127
    v_exp_f32 v20, v20
    v_exp_f32 v21, v21
    v_exp_f32 v22, v22
    v_exp_f32 v23, v23
    v_add_f32 v16, 1.0, v16
    v_add_f32 v17, 1.0, v17
    v_add_f32 v18, 1.0, v18
    v_add_f32 v19, 1.0, v19
    v_add_f32 v20, 1.0, v20
    v_add_f32 v21, 1.0, v21
    v_add_f32 v22, 1.0, v22
    v_add_f32 v23, 1.0, v23
    v_rcp_f32 v16, v16
    v_rcp_f32 v17, v17
    v_rcp_f32 v18, v18
    v_rcp_f32 v19, v19
    v_rcp_f32 v20, v20
    v_rcp_f32 v21, v21
    v_rcp_f32 v22, v22
    v_rcp_f32 v23, v23
    v_mul_f32 v92, v92, v16
    v_mul_f32 v93, v93, v17
    v_mul_f32 v94, v94, v18
    v_mul_f32 v95, v95, v19
    v_mul_f32 v124, v124, v20
    v_mul_f32 v125, v125, v21
    v_mul_f32 v126, v126, v22
    v_mul_f32 v127, v127, v23
    v_cvt_pk_bf16_f32 v42, v92, v93
    v_cvt_pk_bf16_f32 v43, v94, v95
    v_cvt_pk_bf16_f32 v46, v124, v125
    v_cvt_pk_bf16_f32 v47, v126, v127
    buffer_store_dwordx4 v[40:43], v2, s[24:27], s44 offen offset:3072 sc1
    buffer_store_dwordx4 v[44:47], v2, s[24:27], s48 offen offset:3072 sc1
    s_nop 1
    s_waitcnt vmcnt(0)
    s_barrier
    s_cmp_lg_u32 s32, 0
    s_cbranch_scc1 attn_kernel_o_gdone
    v_mov_b32 v16, s3
    s_mov_b64 exec, 1
    buffer_store_dword v16, off, s[28:31], s45 sc1
    s_mov_b64 exec, -1
attn_kernel_o_gdone:
attn_kernel_o_fin:
    s_branch attn_kernel_end
attn_kernel_epoch:
    s_cmp_lg_u32 s42, 0
    s_cbranch_scc1 attn_kernel_end
    s_add_u32 s32, s20, 0x290000
    s_addc_u32 s33, s21, 0
    s_and_b32 s33, s33, 0xffff
    s_mov_b32 s34, 0x20000
    s_mov_b32 s35, 0x20000
    v_lshlrev_b32 v48, 7, v1
    v_add_u32 v48, 0x10000, v48
    v_add_u32 v49, 8192, v48
    v_add_u32 v50, 16384, v48
    v_add_u32 v51, 24576, v48
    s_mov_b32 s48, 0x4000
attn_kernel_epp:
    buffer_load_dword v52, v48, s[32:35], 0 offen sc1
    buffer_load_dword v53, v49, s[32:35], 0 offen sc1
    buffer_load_dword v54, v50, s[32:35], 0 offen sc1
    buffer_load_dword v55, v51, s[32:35], 0 offen sc1
    s_sub_u32 s48, s48, 1
    s_waitcnt vmcnt(0)
    v_xor_b32 v52, s3, v52
    v_xor_b32 v53, s3, v53
    v_xor_b32 v54, s3, v54
    v_xor_b32 v55, s3, v55
    v_or3_b32 v52, v52, v53, v54
    v_or_b32 v52, v52, v55
    v_cmp_ne_u32 vcc, 0, v52
    s_nop 1
    s_cmp_eq_u64 vcc, 0
    s_cbranch_scc1 attn_kernel_epw
    s_cmp_lg_u32 s48, 0
    s_cbranch_scc1 attn_kernel_epp
attn_kernel_epw:
    s_mov_b32 s52, 0x18040
    v_mov_b32 v48, s3
    s_mov_b64 exec, 1
    buffer_store_dword v48, off, s[32:35], s52 sc1
    s_waitcnt vmcnt(0)
attn_kernel_end:
    s_endpgm
.section .rodata,"a"
.p2align 6
.amdhsa_kernel attn_kernel
  .amdhsa_next_free_vgpr 512
  .amdhsa_next_free_sgpr 102
  .amdhsa_accum_offset 256
  .amdhsa_group_segment_fixed_size 0
  .amdhsa_kernarg_size 104
  .amdhsa_user_sgpr_count 2
  .amdhsa_user_sgpr_kernarg_segment_ptr 1
  .amdhsa_system_sgpr_workgroup_id_x 1
.end_amdhsa_kernel
```
